```python
import torch

def _softmax(x, axis=-1):
    return torch.softmax(x, dim=axis)
def _gelu(x):
    return torch.nn.functional.gelu(x, approximate="tanh")
def _silu(x):
    return torch.nn.functional.silu(x)
def _sigmoid(x):
    return torch.sigmoid(x)
def _layernorm(x, axis=-1, eps=1e-5):
    m = x.mean(dim=axis, keepdim=True)
    v = x.var(dim=axis, keepdim=True, unbiased=False)
    return (x - m) / torch.sqrt(v + eps)
def _scatter_add(tgt, idx, src, axis=0):
    return tgt.clone().index_add_(axis, idx, src)
def _segment_sum(src, seg, n):
    out = torch.zeros((n,) + src.shape[1:], dtype=src.dtype)
    return out.index_add_(0, seg, src)
def _pad(x, pw):
    flat = tuple(v for pair in reversed(pw) for v in pair)
    return torch.nn.functional.pad(x, flat)

kernel_name = 'interleave_layers__ssm_conv_h3__mixer_s_mlp__prompt'

def setup_inputs():

    _w = (lambda a: (lambda t: t.to(torch.bfloat16) if t.is_floating_point() else t)(torch.as_tensor(a)))
    def _A_setup():
        B, S, D = 1, 2048, 640
        ks = 4
        return {
            "q": _w((lambda *s: torch.randn(*s, dtype=torch.bfloat16) * 0.05)(B, S, D)),
            "k": _w((lambda *s: torch.randn(*s, dtype=torch.bfloat16) * 0.8)(B, S, D)),
            "v": _w((lambda *s: torch.randn(*s, dtype=torch.bfloat16) * 0.8)(B, S, D)),
            "shift_k": _w((lambda *s: torch.randn(*s, dtype=torch.bfloat16) * 0.8)(D, ks) * 0.5),
            "ssm_k": _w((lambda *s: torch.randn(*s, dtype=torch.bfloat16) * 0.8)(D, S) * (1.0 / S ** 0.5)),
            "ssm_D": _w((lambda *s: torch.randn(*s, dtype=torch.bfloat16) * 0.8)(D)),
        }
    _A_in = _A_setup()

    def _B_setup():
        B, S, D, F = 1, 2048, 640, 1536
        return {
            "x":  _w((lambda *s: torch.randn(*s, dtype=torch.bfloat16) * 0.05)(B, S, D)),
            "w1": _w((lambda *s: torch.randn(*s, dtype=torch.bfloat16) * 3.2)(D, D) * (D ** -0.5)),
            "w2": _w((lambda *s: torch.randn(*s, dtype=torch.bfloat16) * 3.2)(D, D) * (D ** -0.5)),
            "w3": _w((lambda *s: torch.randn(*s, dtype=torch.bfloat16) * 3.2)(D, F) * (D ** -0.5)),
            "w4": _w((lambda *s: torch.randn(*s, dtype=torch.bfloat16) * 3.2)(F, D) * (F ** -0.5)),
        }
    _B_in = _B_setup()

    return {
        "A_q": _A_in["q"],
        "A_k": _A_in["k"],
        "A_v": _A_in["v"],
        "A_shift_k": _A_in["shift_k"],
        "A_ssm_k": _A_in["ssm_k"],
        "A_ssm_D": _A_in["ssm_D"],
        "B_x": _B_in["x"],
        "B_w1": _B_in["w1"],
        "B_w2": _B_in["w2"],
        "B_w3": _B_in["w3"],
        "B_w4": _B_in["w4"],
    }

def reference(A_q, A_k, A_v, A_shift_k, A_ssm_k, A_ssm_D, B_x, B_w1, B_w2, B_w3, B_w4):
    def _A_ref(q, k, v, shift_k, ssm_k, ssm_D):
        B, S, D = q.shape
        ks = shift_k.shape[-1]
        k_pad = _pad(k, ((0, 0), (ks - 1, 0), (0, 0)))
        k_shift = torch.zeros_like(k)
        for t in range(ks):
            k_shift = k_shift + k_pad[:, t:t + S, :] * shift_k[:, ks - 1 - t][None, None, :]
        kv = k_shift * v
        L = 2 * S
        kv_pad = _pad(kv, ((0, 0), (0, S), (0, 0)))
        kf_pad = _pad(ssm_k, ((0, 0), (0, S)))
        kv_f = (lambda x, axes=(-2,-1): torch.fft.rfft2(x.float(), dim=axes))(kv_pad[:, None, :, :], axes=(1, 2))
        kf_f = (lambda x, axes=(-2,-1): torch.fft.rfft2(x.float(), dim=axes))(kf_pad[:, None, :], axes=(1, 2))
        kf_f = (lambda x, *d: x.permute(*d))(kf_f, 1, 2, 0)
        y_f = kv_f * kf_f[None, :, :, :]
        y = (lambda x, s, axes=(-2,-1): torch.fft.irfft2(x, s=s, dim=axes).to(torch.bfloat16))(y_f, (1, L), axes=(1, 2))[:, 0, :S, :]
        y = y + kv * ssm_D[None, None, :]
        return q * y

    def _B_ref(x, w1, w2, w3, w4):
        B, S, D = x.shape
        h = _gelu(_layernorm(x, axis=-1) @ w1)
        c = D // 4
        g0 = _pad(h[:, :, 0*c:1*c], ((0, 0), (1, 0), (0, 0)))[:, :S, :]
        g1 = _pad(h[:, :, 1*c:2*c], ((0, 0), (0, 1), (0, 0)))[:, 1:, :]
        g2 = _pad(h[:, :, 2*c:3*c], ((0, 0), (2, 0), (0, 0)))[:, :S, :]
        g3 = _pad(h[:, :, 3*c:   ], ((0, 0), (0, 2), (0, 0)))[:, 2:, :]
        hs = torch.concatenate([g0, g1, g2, g3], axis=-1) @ w2
        x1 = x + hs
        h2 = _gelu(_layernorm(x1, axis=-1) @ w3) @ w4
        return x1 + h2

    x = A_q
    x = x + _A_ref(_layernorm(x, axis=-1), A_k, A_v, A_shift_k, A_ssm_k, A_ssm_D)
    x = x + _B_ref(_layernorm(x, axis=-1), B_w1, B_w2, B_w3, B_w4)
    x = x + _A_ref(_layernorm(x, axis=-1), A_k, A_v, A_shift_k, A_ssm_k, A_ssm_D)
    x = x + _B_ref(_layernorm(x, axis=-1), B_w1, B_w2, B_w3, B_w4)
    return x
```

```asm
; @launch grid=(256,1,1) block=(256,1,1) lds=159808
.amdgcn_target "amdgcn-amd-amdhsa--gfx950"
.text
.globl interleave_layers__ssm_conv_h3__mixer_s_mlp__prompt_kernel
.p2align 8
.type interleave_layers__ssm_conv_h3__mixer_s_mlp__prompt_kernel,@function
interleave_layers__ssm_conv_h3__mixer_s_mlp__prompt_kernel:
s_cmp_ge_u32 s2, 256
s_cbranch_scc1 k2_exit
s_load_dwordx2 s[40:41], s[0:1], 8
s_load_dwordx2 s[44:45], s[0:1], 16
s_load_dwordx2 s[48:49], s[0:1], 24
s_load_dwordx2 s[16:17], s[0:1], 104
s_load_dwordx2 s[52:53], s[0:1], 32
s_load_dwordx8 s[88:95], s[0:1], 56
s_getpc_b64 s[68:69]
kf_pc:
s_mov_b32 s70, interleave_layers__ssm_conv_h3__mixer_s_mlp__prompt_kernel_end-kf_pc
s_mov_b32 s71, 0x20000
s_lshr_b32 s5, s2, 3
s_lshl_b32 s3, s5, 12
v_lshrrev_b32 v33, 5, v0
v_lshlrev_b32 v99, 4, v0
v_and_b32 v99, 0xf80, v99
buffer_load_dword v99, v99, s[68:71], s3 offen
s_and_b32 s4, s2, 7
v_and_b32 v32, 31, v0
s_lshl_b32 s26, s5, 6
v_lshl_add_u32 v34, v33, 3, s26
v_mul_u32_u24 v34, 1280, v34
s_lshl_b32 s26, s4, 8
v_lshl_add_u32 v35, v32, 3, s26
v_add_u32 v34, v34, v35
v_subrev_u32 v36, 3840, v34
v_lshlrev_b32 v35, 2, v35
s_mov_b32 s42, 2621440
s_mov_b32 s43, 0x20000
v_add_u32 v62, 5120, v34
s_mov_b32 s18, 33554432
s_mov_b32 s19, 0x20000
s_mov_b32 s54, 2621440
s_mov_b32 s55, 0x20000
v_lshrrev_b32 v3, 6, v0
v_and_b32 v1, 63, v0
v_readfirstlane_b32 s20, v3
v_lshlrev_b32 v2, 4, v1
v_mov_b32 v37, 10887168
s_waitcnt lgkmcnt(0)
s_cmp_ge_u32 s4, 5
s_cbranch_scc1 role_pp
global_load_dword v37, v37, s[16:17] sc1
global_load_dwordx2 v[46:47], v34, s[40:41] offset:0 nt
global_load_dwordx2 v[48:49], v34, s[40:41] offset:1280 nt
global_load_dwordx2 v[50:51], v34, s[40:41] offset:2560 nt
global_load_dwordx2 v[52:53], v34, s[40:41] offset:3840 nt
global_load_dwordx2 v[54:55], v62, s[40:41] offset:0 nt
global_load_dwordx2 v[56:57], v62, s[40:41] offset:1280 nt
global_load_dwordx2 v[58:59], v62, s[40:41] offset:2560 nt
global_load_dwordx2 v[60:61], v62, s[40:41] offset:3840 nt
buffer_load_dwordx2 v[40:41], v36, s[40:43], 0 offen offset:0 nt
buffer_load_dwordx2 v[42:43], v36, s[40:43], 0 offen offset:1280 nt
buffer_load_dwordx2 v[44:45], v36, s[40:43], 0 offen offset:2560 nt
global_load_dwordx4 v[80:83], v35, s[48:49]
global_load_dwordx4 v[84:87], v35, s[48:49] offset:16
global_load_dwordx2 v[64:65], v34, s[44:45] offset:0 nt
global_load_dwordx2 v[66:67], v34, s[44:45] offset:1280 nt
global_load_dwordx2 v[68:69], v34, s[44:45] offset:2560 nt
global_load_dwordx2 v[70:71], v34, s[44:45] offset:3840 nt
global_load_dwordx2 v[72:73], v62, s[44:45] offset:0 nt
global_load_dwordx2 v[74:75], v62, s[44:45] offset:1280 nt
global_load_dwordx2 v[76:77], v62, s[44:45] offset:2560 nt
global_load_dwordx2 v[78:79], v62, s[44:45] offset:3840 nt
s_load_dwordx2 s[8:9], s[0:1], 0
s_load_dwordx2 s[96:97], s[0:1], 88
s_load_dwordx2 s[86:87], s[0:1], 40
s_mov_b32 s10, 2621440
s_mov_b32 s11, 0x20000
s_getreg_b32 s37, hwreg(HW_REG_XCC_ID, 0, 4)
s_mov_b32 s64, 0xffff0000
s_lshl_b32 s26, s5, 2
v_mov_b32 v100, s26
v_bfrev_b32 v101, 1
v_cmp_eq_u32 vcc, 0, v0
v_lshlrev_b32 v102, 5, v100
s_nop 0
v_cndmask_b32 v100, v101, v100, vcc
v_lshl_add_u32 v102, v0, 2, v102
v_cmp_gt_u32 vcc, 32, v0
s_nop 1
v_cndmask_b32 v102, v101, v102, vcc
s_mov_b64 s[12:13], s[94:95]
s_mov_b32 s14, 1966080
s_mov_b32 s15, 0x20000
s_mov_b64 s[92:93], s[52:53]
s_mov_b32 s94, 2621440
s_mov_b32 s95, 0x20000
s_waitcnt lgkmcnt(0)
s_lshl_b32 s21, s4, 2
s_lshr_b32 s26, s2, 6
s_add_u32 s21, s21, s26
s_bfe_u32 s22, s2, 0x30003
s_lshl_b32 s25, s22, 2
s_add_u32 s25, s25, s20
s_mul_i32 s25, s25, 174080
s_add_u32 s25, s25, 5242880
s_lshl_b32 s38, s20, 12
v_and_b32 v96, 15, v1
v_lshrrev_b32 v97, 4, v1
s_lshl_b32 s26, s21, 6
v_add_u32 v98, s26, v96
v_mul_u32_u24 v98, 1280, v98
v_lshl_add_u32 v98, v97, 3, v98
s_mul_i32 s26, s22, 160
s_lshl_b32 s31, s20, 5
s_add_u32 s31, s31, s26
v_add_u32 v14, s31, v98
s_mul_i32 s31, s20, 20480
s_add_u32 s31, s31, s26
s_add_u32 s31, s31, 128
v_add_u32 v15, s31, v98
s_mov_b32 s32, 20480
s_mov_b32 s33, 40960
s_mov_b32 s34, 61440
s_mov_b32 s23, 1
s_mul_i32 s24, s21, 278528
s_add_u32 s24, s24, 12582912
s_lshl_b32 s27, s21, 7
s_add_u32 s27, s27, 10878976
s_lshl_b32 s28, s21, 13
s_add_u32 s28, s28, 10895360
s_mul_i32 s29, s21, 5120
s_add_u32 s29, s29, 11419648
s_mov_b32 s64, 0xffff0000
v_lshlrev_b32 v29, 7, v1
v_bfrev_b32 v219, 1
v_cmp_gt_u32 vcc, 20, v1
s_nop 1
v_cndmask_b32 v30, v219, v29, vcc
v_lshlrev_b32 v29, 7, v96
v_lshl_add_u32 v29, v97, 16, v29
v_cmp_gt_u32 vcc, 48, v1
s_nop 1
v_cndmask_b32 v29, v219, v29, vcc
v_lshlrev_b32 v216, 4, v96
v_lshl_add_u32 v217, v97, 10, v216
s_add_u32 s26, s20, 0
s_and_b32 s26, s26, 3
s_lshl_b32 s26, s26, 12
v_add_u32 v3, s26, v217
v_add_u32 v7, 0x10000, v3
s_cmp_eq_u32 s20, 0
s_cselect_b32 s60, 1.0, 0
s_add_u32 s26, s20, 1
s_and_b32 s26, s26, 3
s_lshl_b32 s26, s26, 12
v_add_u32 v4, s26, v217
v_add_u32 v8, 0x10000, v4
s_cmp_eq_u32 s20, 1
s_cselect_b32 s61, 1.0, 0
s_add_u32 s26, s20, 2
s_and_b32 s26, s26, 3
s_lshl_b32 s26, s26, 12
v_add_u32 v5, s26, v217
v_add_u32 v9, 0x10000, v5
s_cmp_eq_u32 s20, 2
s_cselect_b32 s62, 1.0, 0
s_add_u32 s26, s20, 3
s_and_b32 s26, s26, 3
s_lshl_b32 s26, s26, 12
v_add_u32 v6, s26, v217
v_add_u32 v10, 0x10000, v6
s_cmp_eq_u32 s20, 3
s_cselect_b32 s63, 1.0, 0
v_lshrrev_b32 v218, 1, v97
v_lshl_add_u32 v218, v218, 10, v216
v_and_b32 v219, 1, v97
v_lshl_add_u32 v218, v219, 3, v218
s_mul_i32 s26, s22, 10240
s_lshl_b32 s31, s20, 11
s_add_u32 s31, s31, s26
v_add_u32 v11, s31, v218
s_lshl_b32 s31, s20, 8
s_add_u32 s31, s31, s26
s_add_u32 s31, s31, 8192
v_add_u32 v12, s31, v218
s_lshl_b32 s26, s22, 13
s_lshl_b32 s31, s20, 11
s_add_u32 s31, s31, s26
v_add_u32 v13, s31, v218
v_and_b32 v16, 7, v1
v_lshlrev_b32 v16, 2, v16
s_lshl_b32 s26, s22, 2
v_mov_b32 v17, s26
v_bfrev_b32 v219, 1
v_cmp_eq_u32 vcc, 0, v0
s_nop 1
v_cndmask_b32 v17, v219, v17, vcc
s_lshl_b32 s26, s22, 10
v_add_u32 v220, s26, v2
s_cmp_eq_u32 s20, 1
s_cselect_b64 vcc, -1, 0
v_cndmask_b32 v220, v219, v220, vcc
s_lshl_b32 s26, s20, 8
v_lshl_add_u32 v18, v97, 11, v216
v_add_u32 v18, s26, v18
v_lshlrev_b32 v19, 3, v1
v_add_u32 v19, 155648, v19
s_lshl_b32 s31, s20, 9
v_add_u32 v20, s31, v19
v_add_u32 v22, 157696, v216
v_add_u32 v21, s26, v22
v_add_u32 v23, 32768, v2
s_lshl_b32 s26, s20, 10
v_add_u32 v24, s26, v23
v_add_u32 v23, s38, v23
s_lshl_b32 s89, s4, 5
s_add_u32 s89, s89, s5
s_lshr_b32 s80, s89, 4
s_and_b32 s78, s89, 15
s_mul_i32 s78, s78, 3
s_mov_b32 s76, 1280
s_mov_b32 s77, 110
s_add_u32 s89, s89, 176
s_lshl_b32 s81, s78, 2
s_mul_i32 s82, s20, 3
s_add_u32 s81, s81, s82
s_lshl_b32 s82, s76, 3
s_mul_i32 s81, s81, s82
s_lshl_b32 s83, s80, 7
s_add_u32 s81, s81, s83
v_lshrrev_b32 v244, 3, v1
v_mul_lo_u32 v244, v244, s76
v_and_b32 v169, 7, v1
v_lshl_add_u32 v244, v169, 4, v244
v_lshrrev_b32 v160, 4, v1
v_bfe_u32 v161, v1, 2, 2
v_lshl_add_u32 v161, v160, 3, v161
v_lshlrev_b32 v161, 7, v161
v_and_b32 v162, 3, v1
v_lshl_add_u32 v161, v162, 3, v161
s_lshl_b32 s84, s80, 2
s_add_u32 s84, s84, s20
v_mov_b32 v163, s84
v_add_u32 v164, s78, v1
s_mov_b32 s84, 0x2aaaaaab
v_mul_hi_u32 v165, v164, s84
v_mul_u32_u24 v166, 6, v165
v_sub_u32 v166, v164, v166
v_lshrrev_b32 v166, 1, v166
v_lshlrev_b32 v166, 4, v166
v_and_b32 v164, 1, v164
v_lshl_add_u32 v164, v165, 1, v164
v_add_u32 v164, v164, v166
v_lshrrev_b32 v165, 2, v164
v_and_b32 v164, 3, v164
s_mov_b32 s84, 0x33333334
v_mul_hi_u32 v166, v163, s84
v_mul_u32_u24 v245, 5, v166
v_sub_u32 v245, v163, v245
v_sub_u32 v167, v164, v245
v_and_b32 v167, 3, v167
v_add_u32 v168, 1, v167
v_cmp_eq_u32 vcc, 0, v167
s_nop 1
v_cndmask_b32 v168, v168, v167, vcc
v_cmp_eq_u32 vcc, 4, v245
s_nop 1
v_cndmask_b32 v168, v168, 1, vcc
v_cndmask_b32 v245, v245, v164, vcc
v_mad_u32_u24 v168, v165, 5, v168
v_lshl_add_u32 v245, v166, 2, v245
v_mul_u32_u24 v245, 170, v245
v_add3_u32 v245, v245, v168, s77
v_lshlrev_b32 v245, 10, v245
v_add_u32 v245, 5242880, v245
s_lshl_b32 s85, s20, 5
s_add_u32 s85, s85, 53248
v_add_u32 v246, s85, v161
s_mov_b32 s88, s81
v_and_b32 v96, 15, v1
v_lshrrev_b32 v97, 4, v1
s_lshr_b32 s26, s22, 2
s_add_u32 s26, s26, 1
s_sub_u32 s31, 0, s26
s_bitcmp1_b32 s22, 1
s_cselect_b32 s35, s31, s26
v_add_u32 v216, s35, v96
v_cmp_le_i32 s[50:51], 0, v216
v_cmp_gt_i32 s[52:53], 16, v216
s_cselect_b32 s31, 2, -16
v_add_u32 v216, s31, v216
v_lshlrev_b32 v216, 6, v216
v_lshl_add_u32 v216, v97, 4, v216
s_cselect_b32 s31, -5120, 0
s_add_u32 s30, s29, s31
s_bitcmp1_b32 s22, 1
s_cselect_b32 s31, 0, 5120
s_add_u32 s30, s30, s31
s_mul_i32 s26, s22, 640
s_add_u32 s31, s26, 512
v_add_u32 v28, s31, v216
s_lshl_b32 s31, s20, 7
s_add_u32 s26, s26, s31
v_add_u32 v27, s26, v216
s_mov_b64 s[54:55], -1
s_cmp_eq_u32 s20, 0
s_cselect_b64 s[54:55], s[50:51], s[54:55]
s_cmp_eq_u32 s20, 3
s_cselect_b64 s[54:55], s[52:53], s[54:55]
s_not_b64 s[66:67], s[50:51]
s_not_b64 s[68:69], s[52:53]
s_cmp_eq_u32 s21, 0
s_cselect_b64 s[66:67], 0, s[66:67]
s_cmp_eq_u32 s21, 31
s_cselect_b64 s[68:69], 0, s[68:69]
s_mov_b64 s[70:71], 0
s_cmp_eq_u32 s20, 0
s_cselect_b64 s[70:71], s[66:67], s[70:71]
s_cmp_eq_u32 s20, 3
s_cselect_b64 s[70:71], s[68:69], s[70:71]
s_or_b64 s[68:69], s[68:69], s[66:67]
v_bfrev_b32 v216, 1
v_cndmask_b32 v27, v216, v27, s[68:69]
v_cndmask_b32 v28, v216, v28, s[70:71]
s_bitcmp1_b32 s22, 1
s_cselect_b64 s[66:67], -1, 0
s_lshl_b32 s35, s35, 4
v_lshrrev_b32 v216, 2, v1
s_mul_i32 s26, s20, 10
v_add_u32 v216, s26, v216
v_and_b32 v217, 3, v1
v_lshlrev_b32 v25, 7, v216
v_lshl_add_u32 v25, v217, 4, v25
v_lshlrev_b32 v216, 11, v216
v_lshrrev_b32 v218, 1, v217
v_lshl_add_u32 v216, v218, 10, v216
v_and_b32 v217, 1, v217
v_lshl_add_u32 v216, v217, 3, v216
s_bitcmp1_b32 s20, 0
s_cselect_b32 s26, 992, 0
v_add_u32 v26, s26, v216
s_cselect_b32 s26, 31, 0
s_cmp_lg_u32 s21, s26
s_cselect_b32 s39, 1, 0
s_mov_b32 s56, -1
s_mov_b32 s57, 0xff
s_mov_b64 s[58:59], s[56:57]
s_cmp_eq_u32 s20, 1
s_cselect_b64 s[56:57], 0, s[56:57]
s_cmp_eq_u32 s20, 0
s_cselect_b64 s[58:59], 0, s[58:59]
v_mov_b32 v217, 159744
v_add_u32 v222, 16, v26
v_cndmask_b32 v222, v217, v222, s[58:59]
v_cndmask_b32 v26, v217, v26, s[56:57]
s_cmp_eq_u32 s39, 0
s_cselect_b64 s[56:57], 0, s[56:57]
s_cselect_b64 s[58:59], 0, s[58:59]
v_bfrev_b32 v217, 1
v_add_u32 v221, 64, v25
v_cndmask_b32 v221, v217, v221, s[58:59]
v_cndmask_b32 v25, v217, v25, s[56:57]
s_lshl_b32 s26, s20, 2
s_add_u32 s26, s26, 0
s_mul_hi_u32 s26, s26, 0xccccccd
s_lshr_b32 s31, s26, 1
s_add_u32 s31, s31, 1
s_lshl_b64 s[6:7], -1, s31
s_lshr_b64 s[40:41], -1, s31
s_bitcmp1_b32 s26, 0
s_cselect_b64 s[40:41], s[40:41], s[6:7]
s_lshl_b32 s26, s20, 2
s_add_u32 s26, s26, 16
s_mul_hi_u32 s26, s26, 0xccccccd
s_lshr_b32 s31, s26, 1
s_add_u32 s31, s31, 1
s_lshl_b64 s[6:7], -1, s31
s_lshr_b64 s[42:43], -1, s31
s_bitcmp1_b32 s26, 0
s_cselect_b64 s[42:43], s[42:43], s[6:7]
s_lshl_b32 s26, s20, 2
s_add_u32 s26, s26, 32
s_mul_hi_u32 s26, s26, 0xccccccd
s_lshr_b32 s31, s26, 1
s_add_u32 s31, s31, 1
s_lshl_b64 s[6:7], -1, s31
s_lshr_b64 s[44:45], -1, s31
s_bitcmp1_b32 s26, 0
s_cselect_b64 s[44:45], s[44:45], s[6:7]
s_lshl_b32 s26, s20, 2
s_add_u32 s26, s26, 48
s_mul_hi_u32 s26, s26, 0xccccccd
s_lshr_b32 s31, s26, 1
s_add_u32 s31, s31, 1
s_lshl_b64 s[6:7], -1, s31
s_lshr_b64 s[46:47], -1, s31
s_bitcmp1_b32 s26, 0
s_cselect_b64 s[46:47], s[46:47], s[6:7]
s_lshl_b32 s26, s20, 2
s_add_u32 s26, s26, 64
s_mul_hi_u32 s26, s26, 0xccccccd
s_lshr_b32 s31, s26, 1
s_add_u32 s31, s31, 1
s_lshl_b64 s[6:7], -1, s31
s_lshr_b64 s[48:49], -1, s31
s_bitcmp1_b32 s26, 0
s_cselect_b64 s[48:49], s[48:49], s[6:7]
v_lshrrev_b32 v236, 4, v1
v_and_b32 v237, 15, v1
v_lshlrev_b32 v238, 13, v236
v_lshl_add_u32 v238, v237, 4, v238
v_lshlrev_b32 v240, 7, v236
v_lshl_add_u32 v240, v237, 3, v240
v_lshrrev_b32 v236, 2, v1
v_and_b32 v237, 3, v1
v_lshlrev_b32 v239, 13, v236
v_lshl_add_u32 v239, v237, 4, v239
v_lshlrev_b32 v241, 5, v236
v_lshl_add_u32 v241, v237, 3, v241
s_add_u32 s26, s38, 32768
v_add_u32 v240, s26, v240
v_add_u32 v241, s26, v241
v_lshrrev_b32 v242, 4, v1
v_bfe_u32 v243, v1, 2, 2
v_lshl_add_u32 v242, v242, 2, v243
v_lshlrev_b32 v237, 3, v237
v_lshl_add_u32 v243, v242, 5, v237
v_lshl_add_u32 v242, v242, 7, v237
v_add_u32 v242, s26, v242
v_add_u32 v243, s26, v243
s_mul_i32 s26, s22, 655360
s_lshl_b32 s31, s21, 8
s_add_u32 s26, s26, s31
s_add_u32 s26, s26, 22020096
s_lshl_b32 s31, s20, 17
s_add_u32 s80, s26, s31
s_add_u32 s81, s80, 32768
s_add_u32 s82, s80, 65536
s_add_u32 s83, s80, 98304
s_lshl_b32 s31, s20, 6
s_add_u32 s84, s26, s31
s_add_u32 s84, s84, 524288
s_mul_i32 s26, s22, 5
s_lshr_b32 s26, s26, 2
s_lshl_b32 s31, s26, 2
v_and_b32 v234, 7, v1
v_add_u32 v234, s31, v234
v_add_u32 v235, 40, v234
v_cmp_le_u32 vcc, 8, v1
s_nop 1
v_cndmask_b32 v234, v234, v235, vcc
s_mul_i32 s31, s22, 12
s_add_u32 s31, s31, 56
v_min_u32 v235, 35, v1
v_add_u32 v235, s31, v235
v_cmp_le_u32 vcc, 24, v1
s_nop 1
v_cndmask_b32 v234, v234, v235, vcc
s_lshl_b32 s31, s26, 4
s_add_u32 s31, s31, 432
v_and_b32 v31, 31, v1
v_add_u32 v31, s31, v31
v_lshlrev_b32 v31, 7, v31
v_lshlrev_b32 v234, 7, v234
v_add_u32 v234, 32768, v234
s_lshl_b32 s26, s4, 5
s_lshr_b32 s31, s2, 6
s_lshl_b32 s31, s31, 3
s_add_u32 s26, s26, s31
s_sub_u32 s26, s26, 16
v_add_u32 v235, s26, v1
v_lshlrev_b32 v235, 7, v235
s_mov_b32 vcc_lo, 0x00ff0000
s_mov_b32 vcc_hi, 0
v_cndmask_b32 v234, v234, v235, vcc
s_mul_i32 s99, s20, 13056
v_and_b32 v160, 15, v1
v_lshrrev_b32 v161, 4, v1
v_add_u32 v141, s99, v2
v_add_u32 v142, 12544, v141
v_bfe_u32 v162, v1, 1, 1
v_mul_u32_u24 v162, 4160, v162
v_and_b32 v163, 1, v1
v_lshl_add_u32 v162, v163, 4, v162
v_add_u32 v162, s99, v162
v_cmp_gt_u32 vcc, 32, v1
s_nop 1
v_cndmask_b32 v142, v162, v142, vcc
v_add_u32 v162, 1, v160
v_and_b32 v163, 1, v162
v_sub_u32 v162, v162, v163
v_lshl_add_u32 v162, v161, 3, v162
v_lshlrev_b32 v162, 1, v162
v_mul_u32_u24 v163, 4160, v163
v_add3_u32 v248, v162, v163, s99
v_add_u32 v249, 1024, v248
v_add_u32 v250, 2048, v248
v_add_u32 v251, 3072, v248
v_lshlrev_b32 v162, 5, v160
v_lshlrev_b32 v163, 4, v161
v_sub_u32 v162, v163, v162
v_add_u32 v162, 8928, v162
v_add_u32 v247, s99, v162
v_lshl_add_u32 v216, v160, 2, v161
v_lshlrev_b32 v216, 4, v216
v_sub_u32 v162, 15, v160
v_and_b32 v163, 1, v162
v_lshlrev_b32 v252, 4, v163
v_lshrrev_b32 v162, 1, v162
v_lshlrev_b32 v163, 2, v161
v_sub_u32 v253, v162, v163
v_and_b32 v143, 31, v1
v_lshlrev_b32 v143, 2, v143
s_mov_b32 s26, 0x1999999a
v_mul_hi_u32 v160, v1, s26
v_mul_u32_u24 v161, 10, v160
v_sub_u32 v161, v1, v161
v_mul_u32_u24 v160, 1280, v160
v_lshl_add_u32 v224, v161, 4, v160
v_add_u32 v162, 64, v1
v_mul_hi_u32 v160, v162, s26
v_mul_u32_u24 v161, 10, v160
v_sub_u32 v161, v162, v161
v_mul_u32_u24 v160, 1280, v160
v_lshl_add_u32 v225, v161, 4, v160
v_add_u32 v162, 128, v1
v_mul_hi_u32 v160, v162, s26
v_mul_u32_u24 v161, 10, v160
v_sub_u32 v161, v162, v161
v_mul_u32_u24 v160, 1280, v160
v_lshl_add_u32 v226, v161, 4, v160
v_lshlrev_b32 v38, 12, v32
s_mul_i32 s76, s4, 1114112
s_lshl_b32 s26, s5, 7
s_sub_u32 s76, s76, s26
s_add_u32 s76, s76, 12586880
s_mul_i32 s85, s20, 278528
s_add_u32 s85, s85, s76
s_lshl_b32 s26, s4, 7
s_add_u32 s100, s26, 10885120
v_mov_b32 v39, s100
v_sub_u32 v63, 7, v33
v_and_b32 v62, 7, v32
v_xor_b32 v63, v62, v63
v_lshlrev_b32 v62, 9, v32
v_lshl_add_u32 v62, v63, 4, v62
v_add_u32 v62, 53248, v62
v_lshrrev_b32 v96, 3, v0
v_and_b32 v97, 7, v0
v_lshrrev_b32 v98, 5, v0
v_xor_b32 v98, v98, v97
v_lshlrev_b32 v98, 4, v98
v_lshl_add_u32 v98, v96, 7, v98
v_add_u32 v98, 53248, v98
v_lshlrev_b32 v96, 12, v96
v_lshl_add_u32 v96, v97, 4, v96
s_add_u32 s77, s76, 278528
s_add_u32 s78, s76, 557056
s_add_u32 s79, s76, 835584
s_lshl_b32 s98, s4, 12
s_add_u32 s98, s98, 11993088
s_waitcnt vmcnt(21)
v_readfirstlane_b32 s75, v37
s_nop 0
s_mul_i32 s75, s75, 0x9e3779b1
s_add_u32 s75, s75, 0x7f4a7c15
s_add_u32 s26, s75, s37
s_add_u32 s26, s26, 32
v_mov_b32 v101, s26
s_waitcnt vmcnt(8)
buffer_load_dword v39, v39, s[16:19], 0 offen sc1
buffer_load_dword v38, v38, s[16:19], s85 offen sc1 nt
s_lshl_b32 s72, s4, 5
s_add_u32 s72, s72, s5
s_lshl_b32 s72, s72, 2
s_add_u32 s72, s72, s20
s_lshl_b32 s3, s72, 12
v_add_u32 v140, s3, v2
global_load_dwordx4 v[104:107], v140, s[92:93] offset:0 nt
global_load_dwordx4 v[108:111], v140, s[92:93] offset:1024 nt
global_load_dwordx4 v[112:115], v140, s[92:93] offset:2048 nt
global_load_dwordx4 v[116:119], v140, s[92:93] offset:3072 nt
s_lshr_b32 s26, s72, 1
s_lshl_b32 s26, s26, 2
s_load_dword s73, s[86:87], s26
v_lshlrev_b32 v88, 16, v80
v_lshlrev_b32 v89, 16, v82
v_and_b32 v90, s64, v80
v_and_b32 v91, s64, v82
v_lshlrev_b32 v92, 16, v81
v_lshlrev_b32 v93, 16, v83
v_and_b32 v94, s64, v81
v_and_b32 v95, s64, v83
v_lshlrev_b32 v160, 16, v40
v_and_b32 v161, s64, v40
v_lshlrev_b32 v162, 16, v42
v_and_b32 v163, s64, v42
v_lshlrev_b32 v164, 16, v44
v_and_b32 v165, s64, v44
v_lshlrev_b32 v166, 16, v46
v_and_b32 v167, s64, v46
v_lshlrev_b32 v168, 16, v48
v_and_b32 v169, s64, v48
v_lshlrev_b32 v170, 16, v50
v_and_b32 v171, s64, v50
v_lshlrev_b32 v172, 16, v52
v_and_b32 v173, s64, v52
v_lshlrev_b32 v174, 16, v54
v_and_b32 v175, s64, v54
v_lshlrev_b32 v176, 16, v56
v_and_b32 v177, s64, v56
v_lshlrev_b32 v178, 16, v58
v_and_b32 v179, s64, v58
v_lshlrev_b32 v180, 16, v60
v_and_b32 v181, s64, v60
v_pk_mul_f32 v[184:185], v[160:161], v[94:95]
v_pk_mul_f32 v[186:187], v[162:163], v[94:95]
v_pk_mul_f32 v[188:189], v[164:165], v[94:95]
v_pk_mul_f32 v[190:191], v[166:167], v[94:95]
v_pk_mul_f32 v[192:193], v[168:169], v[94:95]
v_pk_mul_f32 v[194:195], v[170:171], v[94:95]
v_pk_mul_f32 v[196:197], v[172:173], v[94:95]
v_pk_mul_f32 v[198:199], v[174:175], v[94:95]
v_pk_fma_f32 v[184:185], v[162:163], v[92:93], v[184:185]
v_pk_fma_f32 v[186:187], v[164:165], v[92:93], v[186:187]
v_pk_fma_f32 v[188:189], v[166:167], v[92:93], v[188:189]
v_pk_fma_f32 v[190:191], v[168:169], v[92:93], v[190:191]
v_pk_fma_f32 v[192:193], v[170:171], v[92:93], v[192:193]
v_pk_fma_f32 v[194:195], v[172:173], v[92:93], v[194:195]
v_pk_fma_f32 v[196:197], v[174:175], v[92:93], v[196:197]
v_pk_fma_f32 v[198:199], v[176:177], v[92:93], v[198:199]
v_pk_fma_f32 v[184:185], v[164:165], v[90:91], v[184:185]
v_pk_fma_f32 v[186:187], v[166:167], v[90:91], v[186:187]
v_pk_fma_f32 v[188:189], v[168:169], v[90:91], v[188:189]
v_pk_fma_f32 v[190:191], v[170:171], v[90:91], v[190:191]
v_pk_fma_f32 v[192:193], v[172:173], v[90:91], v[192:193]
v_pk_fma_f32 v[194:195], v[174:175], v[90:91], v[194:195]
v_pk_fma_f32 v[196:197], v[176:177], v[90:91], v[196:197]
v_pk_fma_f32 v[198:199], v[178:179], v[90:91], v[198:199]
v_pk_fma_f32 v[184:185], v[166:167], v[88:89], v[184:185]
v_pk_fma_f32 v[186:187], v[168:169], v[88:89], v[186:187]
v_pk_fma_f32 v[188:189], v[170:171], v[88:89], v[188:189]
v_pk_fma_f32 v[190:191], v[172:173], v[88:89], v[190:191]
v_pk_fma_f32 v[192:193], v[174:175], v[88:89], v[192:193]
v_pk_fma_f32 v[194:195], v[176:177], v[88:89], v[194:195]
v_pk_fma_f32 v[196:197], v[178:179], v[88:89], v[196:197]
v_pk_fma_f32 v[198:199], v[180:181], v[88:89], v[198:199]
v_lshlrev_b32 v88, 16, v84
v_lshlrev_b32 v89, 16, v86
v_and_b32 v90, s64, v84
v_and_b32 v91, s64, v86
v_lshlrev_b32 v92, 16, v85
v_lshlrev_b32 v93, 16, v87
v_and_b32 v94, s64, v85
v_and_b32 v95, s64, v87
v_lshlrev_b32 v160, 16, v41
v_and_b32 v161, s64, v41
v_lshlrev_b32 v162, 16, v43
v_and_b32 v163, s64, v43
v_lshlrev_b32 v164, 16, v45
v_and_b32 v165, s64, v45
v_lshlrev_b32 v166, 16, v47
v_and_b32 v167, s64, v47
v_lshlrev_b32 v168, 16, v49
v_and_b32 v169, s64, v49
v_lshlrev_b32 v170, 16, v51
v_and_b32 v171, s64, v51
v_lshlrev_b32 v172, 16, v53
v_and_b32 v173, s64, v53
v_lshlrev_b32 v174, 16, v55
v_and_b32 v175, s64, v55
v_lshlrev_b32 v176, 16, v57
v_and_b32 v177, s64, v57
v_lshlrev_b32 v178, 16, v59
v_and_b32 v179, s64, v59
v_lshlrev_b32 v180, 16, v61
v_and_b32 v181, s64, v61
v_pk_mul_f32 v[144:145], v[160:161], v[94:95]
v_pk_mul_f32 v[146:147], v[162:163], v[94:95]
v_pk_mul_f32 v[148:149], v[164:165], v[94:95]
v_pk_mul_f32 v[150:151], v[166:167], v[94:95]
v_pk_mul_f32 v[152:153], v[168:169], v[94:95]
v_pk_mul_f32 v[154:155], v[170:171], v[94:95]
v_pk_mul_f32 v[156:157], v[172:173], v[94:95]
v_pk_mul_f32 v[158:159], v[174:175], v[94:95]
v_pk_fma_f32 v[144:145], v[162:163], v[92:93], v[144:145]
v_pk_fma_f32 v[146:147], v[164:165], v[92:93], v[146:147]
v_pk_fma_f32 v[148:149], v[166:167], v[92:93], v[148:149]
v_pk_fma_f32 v[150:151], v[168:169], v[92:93], v[150:151]
v_pk_fma_f32 v[152:153], v[170:171], v[92:93], v[152:153]
v_pk_fma_f32 v[154:155], v[172:173], v[92:93], v[154:155]
v_pk_fma_f32 v[156:157], v[174:175], v[92:93], v[156:157]
v_pk_fma_f32 v[158:159], v[176:177], v[92:93], v[158:159]
v_pk_fma_f32 v[144:145], v[164:165], v[90:91], v[144:145]
v_pk_fma_f32 v[146:147], v[166:167], v[90:91], v[146:147]
v_pk_fma_f32 v[148:149], v[168:169], v[90:91], v[148:149]
v_pk_fma_f32 v[150:151], v[170:171], v[90:91], v[150:151]
v_pk_fma_f32 v[152:153], v[172:173], v[90:91], v[152:153]
v_pk_fma_f32 v[154:155], v[174:175], v[90:91], v[154:155]
v_pk_fma_f32 v[156:157], v[176:177], v[90:91], v[156:157]
v_pk_fma_f32 v[158:159], v[178:179], v[90:91], v[158:159]
v_pk_fma_f32 v[144:145], v[166:167], v[88:89], v[144:145]
v_pk_fma_f32 v[146:147], v[168:169], v[88:89], v[146:147]
v_pk_fma_f32 v[148:149], v[170:171], v[88:89], v[148:149]
v_pk_fma_f32 v[150:151], v[172:173], v[88:89], v[150:151]
v_pk_fma_f32 v[152:153], v[174:175], v[88:89], v[152:153]
v_pk_fma_f32 v[154:155], v[176:177], v[88:89], v[154:155]
v_pk_fma_f32 v[156:157], v[178:179], v[88:89], v[156:157]
v_pk_fma_f32 v[158:159], v[180:181], v[88:89], v[158:159]
s_waitcnt vmcnt(6)
v_lshlrev_b32 v160, 16, v64
v_and_b32 v161, s64, v64
v_lshlrev_b32 v162, 16, v66
v_and_b32 v163, s64, v66
v_lshlrev_b32 v164, 16, v68
v_and_b32 v165, s64, v68
v_lshlrev_b32 v166, 16, v70
v_and_b32 v167, s64, v70
v_lshlrev_b32 v168, 16, v72
v_and_b32 v169, s64, v72
v_lshlrev_b32 v170, 16, v74
v_and_b32 v171, s64, v74
v_lshlrev_b32 v172, 16, v76
v_and_b32 v173, s64, v76
v_lshlrev_b32 v174, 16, v78
v_and_b32 v175, s64, v78
v_pk_mul_f32 v[184:185], v[184:185], v[160:161]
v_pk_mul_f32 v[186:187], v[186:187], v[162:163]
v_pk_mul_f32 v[188:189], v[188:189], v[164:165]
v_pk_mul_f32 v[190:191], v[190:191], v[166:167]
v_pk_mul_f32 v[192:193], v[192:193], v[168:169]
v_pk_mul_f32 v[194:195], v[194:195], v[170:171]
v_pk_mul_f32 v[196:197], v[196:197], v[172:173]
v_pk_mul_f32 v[198:199], v[198:199], v[174:175]
v_cvt_pk_bf16_f32 v200, v198, v196
v_cvt_pk_bf16_f32 v201, v194, v192
v_cvt_pk_bf16_f32 v202, v190, v188
v_cvt_pk_bf16_f32 v203, v186, v184
ds_write_b128 v62, v[200:203] offset:0
v_cvt_pk_bf16_f32 v204, v199, v197
v_cvt_pk_bf16_f32 v205, v195, v193
v_cvt_pk_bf16_f32 v206, v191, v189
v_cvt_pk_bf16_f32 v207, v187, v185
ds_write_b128 v62, v[204:207] offset:128
v_lshlrev_b32 v160, 16, v65
v_and_b32 v161, s64, v65
v_lshlrev_b32 v162, 16, v67
v_and_b32 v163, s64, v67
v_lshlrev_b32 v164, 16, v69
v_and_b32 v165, s64, v69
v_lshlrev_b32 v166, 16, v71
v_and_b32 v167, s64, v71
v_lshlrev_b32 v168, 16, v73
v_and_b32 v169, s64, v73
v_lshlrev_b32 v170, 16, v75
v_and_b32 v171, s64, v75
v_lshlrev_b32 v172, 16, v77
v_and_b32 v173, s64, v77
v_lshlrev_b32 v174, 16, v79
v_and_b32 v175, s64, v79
v_pk_mul_f32 v[144:145], v[144:145], v[160:161]
v_pk_mul_f32 v[146:147], v[146:147], v[162:163]
v_pk_mul_f32 v[148:149], v[148:149], v[164:165]
v_pk_mul_f32 v[150:151], v[150:151], v[166:167]
v_pk_mul_f32 v[152:153], v[152:153], v[168:169]
v_pk_mul_f32 v[154:155], v[154:155], v[170:171]
v_pk_mul_f32 v[156:157], v[156:157], v[172:173]
v_pk_mul_f32 v[158:159], v[158:159], v[174:175]
v_cvt_pk_bf16_f32 v208, v158, v156
v_cvt_pk_bf16_f32 v209, v154, v152
v_cvt_pk_bf16_f32 v210, v150, v148
v_cvt_pk_bf16_f32 v211, v146, v144
ds_write_b128 v62, v[208:211] offset:256
v_cvt_pk_bf16_f32 v212, v159, v157
v_cvt_pk_bf16_f32 v213, v155, v153
v_cvt_pk_bf16_f32 v214, v151, v149
v_cvt_pk_bf16_f32 v215, v147, v145
ds_write_b128 v62, v[212:215] offset:384
s_waitcnt lgkmcnt(0)
s_barrier
ds_read_b128 v[200:203], v98 offset:0
ds_read_b128 v[204:207], v98 offset:4096
ds_read_b128 v[208:211], v98 offset:8192
ds_read_b128 v[212:215], v98 offset:12288
s_waitcnt lgkmcnt(3)
buffer_store_dwordx4 v[200:203], v96, s[16:19], s76 offen
s_waitcnt lgkmcnt(2)
buffer_store_dwordx4 v[204:207], v96, s[16:19], s77 offen
s_waitcnt lgkmcnt(1)
buffer_store_dwordx4 v[208:211], v96, s[16:19], s78 offen
s_waitcnt lgkmcnt(0)
buffer_store_dwordx4 v[212:215], v96, s[16:19], s79 offen
s_waitcnt vmcnt(0)
s_barrier
buffer_store_dword v101, v100, s[16:19], s100 offen
v_mov_b32 v219, v96
v_mov_b32 v56, 0
v_mov_b32 v57, 0
v_mov_b32 v58, 0
v_mov_b32 v59, 0
s_mov_b32 exec_hi, 0xf
ds_write_b128 v142, v[56:59]
s_mov_b32 exec_hi, -1
ds_write_b128 v141, v[104:107] offset:32
v_readlane_b32 s91, v108, 0
s_nop 1
v_mov_b32 v60, s91
s_nop 1
v_mov_b32_dpp v60, v104 wave_shl:1 row_mask:0xf bank_mask:0xf
v_alignbit_b32 v40, v105, v104, 16
v_alignbit_b32 v41, v106, v105, 16
v_alignbit_b32 v42, v107, v106, 16
v_alignbit_b32 v43, v60, v107, 16
ds_write_b128 v141, v[40:43] offset:4192
v_lshlrev_b32 v37, 16, v104
s_mov_b64 exec, 1
ds_write_b32 v141, v37 offset:4188
s_mov_b64 exec, -1
ds_write_b128 v141, v[108:111] offset:1056
v_readlane_b32 s91, v112, 0
s_nop 1
v_mov_b32 v61, s91
s_nop 1
v_mov_b32_dpp v61, v108 wave_shl:1 row_mask:0xf bank_mask:0xf
v_alignbit_b32 v44, v109, v108, 16
v_alignbit_b32 v45, v110, v109, 16
v_alignbit_b32 v46, v111, v110, 16
v_alignbit_b32 v47, v61, v111, 16
ds_write_b128 v141, v[44:47] offset:5216
ds_write_b128 v141, v[112:115] offset:2080
v_readlane_b32 s91, v116, 0
s_nop 1
v_mov_b32 v62, s91
s_nop 1
v_mov_b32_dpp v62, v112 wave_shl:1 row_mask:0xf bank_mask:0xf
v_alignbit_b32 v48, v113, v112, 16
v_alignbit_b32 v49, v114, v113, 16
v_alignbit_b32 v50, v115, v114, 16
v_alignbit_b32 v51, v62, v115, 16
ds_write_b128 v141, v[48:51] offset:6240
ds_write_b128 v141, v[116:119] offset:3104
v_mov_b32_dpp v63, v116 wave_shl:1 row_mask:0xf bank_mask:0xf
v_alignbit_b32 v52, v117, v116, 16
v_alignbit_b32 v53, v118, v117, 16
v_alignbit_b32 v54, v119, v118, 16
v_alignbit_b32 v55, v63, v119, 16
ds_write_b128 v141, v[52:55] offset:7264
s_and_b32 s26, s72, 1
s_lshl_b32 s26, s26, 4
s_lshr_b32 s73, s73, s26
s_and_b32 s73, s73, 0xffff
v_lshlrev_b32 v37, v252, s73
v_mov_b32 v36, v253
v_cmp_eq_u32 vcc, 0, v36
s_nop 1
v_cndmask_b32 v252, 0, v37, vcc
v_cmp_eq_u32 vcc, 1, v36
s_nop 1
v_cndmask_b32 v253, 0, v37, vcc
v_cmp_eq_u32 vcc, 2, v36
s_nop 1
v_cndmask_b32 v254, 0, v37, vcc
v_cmp_eq_u32 vcc, 3, v36
s_nop 1
v_cndmask_b32 v255, 0, v37, vcc
s_waitcnt lgkmcnt(0)
v_mov_b32 v217, v101
v_mov_b32 v218, v102
ds_read2_b32 v[88:89], v248 offset0:0 offset1:1
ds_read2_b32 v[90:91], v248 offset0:2 offset1:3
ds_read2_b32 v[92:93], v248 offset0:128 offset1:129
ds_read2_b32 v[94:95], v248 offset0:130 offset1:131
ds_read2_b32 v[96:97], v249 offset0:0 offset1:1
ds_read2_b32 v[98:99], v249 offset0:2 offset1:3
ds_read2_b32 v[100:101], v249 offset0:128 offset1:129
ds_read2_b32 v[102:103], v249 offset0:130 offset1:131
ds_read2_b32 v[104:105], v250 offset0:0 offset1:1
ds_read2_b32 v[106:107], v250 offset0:2 offset1:3
ds_read2_b32 v[108:109], v250 offset0:128 offset1:129
ds_read2_b32 v[110:111], v250 offset0:130 offset1:131
ds_read2_b32 v[112:113], v251 offset0:0 offset1:1
ds_read2_b32 v[114:115], v251 offset0:2 offset1:3
ds_read2_b32 v[116:117], v251 offset0:128 offset1:129
ds_read2_b32 v[118:119], v251 offset0:130 offset1:131
s_mov_b32 s36, 0
s_add_u32 s31, s75, 32
s_add_u32 s91, s31, s37
s_and_b32 s26, s72, 31
s_lshl_b32 s26, s26, 12
s_add_u32 s74, s26, s24
v_add_u32 v49, s74, v2
v_add_u32 v143, s100, v143
s_add_u32 m0, s99, 8448
tp_2:
global_load_dword v50, v143, s[16:17] sc1
s_add_u32 s36, s36, 1
s_cmp_gt_u32 s36, 0x200000
s_cbranch_scc1 k2_bail
s_waitcnt vmcnt(0)
v_cmp_ne_u32 vcc, s91, v50
s_cbranch_vccz tp_3
s_cmp_lt_u32 s36, 48
s_cbranch_scc1 tp_2
s_branch tp_2f
tp_3:
global_load_lds_dwordx4 v49, s[16:17] offset:3072 sc1
global_load_lds_dwordx4 v49, s[16:17] offset:2048 sc1
global_load_lds_dwordx4 v49, s[16:17] offset:1024 sc1
global_load_lds_dwordx4 v49, s[16:17] offset:0 sc1
buffer_store_dword v217, v218, s[16:19], s98 offen sc1
s_waitcnt vmcnt(1) lgkmcnt(0)
ds_read_b128 v[152:155], v247 offset:3584
ds_read_b128 v[156:159], v247 offset:3072
ds_read_b128 v[160:163], v247 offset:2560
ds_read_b128 v[164:167], v247 offset:2048
ds_read_b128 v[168:171], v247 offset:1536
ds_read_b128 v[172:175], v247 offset:1024
ds_read_b128 v[176:179], v247 offset:512
ds_read_b128 v[180:183], v247 offset:0
s_add_u32 s31, s25, 4096
v_add_u32 v53, s31, v2
v_add_u32 v55, 8192, v53
s_mov_b64 vcc, 0
s_mov_b32 s90, 0
s_mov_b32 s91, 11993088
s_add_u32 s92, s75, 32
s_lshl_b32 s93, s3, 1
s_add_u32 s93, s93, 22020096
s_add_u32 s79, s93, 4096
v_add_u32 v216, s79, v216
s_add_u32 s26, s75, 28
v_mov_b32 v33, s26
v_mov_b32 v35, s26
v_mov_b32 v37, s26
v_mov_b32 v39, s26
v_mov_b32 v41, s26
v_mov_b32 v43, s26
s_mul_i32 s26, s20, 3072
s_add_u32 m0, s26, 53248
s_nop 0
buffer_load_dwordx4 v244, s[12:15], s88 offen nt lds
s_add_u32 s88, s88, 10240
s_add_u32 m0, m0, 1024
s_nop 0
buffer_load_dwordx4 v244, s[12:15], s88 offen nt lds
s_add_u32 s88, s88, 10240
s_add_u32 m0, m0, 1024
s_nop 0
buffer_load_dwordx4 v244, s[12:15], s88 offen nt lds
s_add_u32 s88, s88, 10240
s_add_u32 m0, m0, 1024
s_lshl_b32 s26, s21, 2
s_add_u32 s26, s26, s20
s_mul_i32 s26, s26, 20480
s_mul_i32 s31, s22, 160
s_add_u32 s26, s26, s31
s_mul_i32 s31, s20, 2560
s_add_u32 m0, s31, 65536
s_nop 0
buffer_load_dwordx4 v224, s[8:11], s26 offen nt lds
s_add_u32 m0, m0, 1024
s_nop 0
buffer_load_dwordx4 v225, s[8:11], s26 offen nt lds
s_add_u32 m0, m0, 1024
s_mov_b32 exec_hi, 0
buffer_load_dwordx4 v226, s[8:11], s26 offen nt lds
s_mov_b32 exec_hi, -1
v_and_b32 v46, 7, v1
v_lshlrev_b32 v46, 7, v46
v_bfe_u32 v47, v1, 3, 1
v_lshl_add_u32 v46, v47, 18, v46
s_lshl_b32 s26, s22, 10
s_add_u32 s26, s26, s28
v_add_u32 v46, s26, v46
v_mov_b32 v47, s27
v_cmp_gt_u32 s[6:7], 16, v1
s_nop 1
v_cndmask_b32 v46, v47, v46, s[6:7]
buffer_load_dword v46, v46, s[16:19], 0 offen sc1
s_add_u32 s26, s29, 0
buffer_load_dword v54, v25, s[16:19], s26 offen sc1
buffer_load_dword v54, v221, s[16:19], s26 offen sc1
s_add_u32 s26, s29, 163840
buffer_load_dword v54, v25, s[16:19], s26 offen sc1
buffer_load_dword v54, v221, s[16:19], s26 offen sc1
s_waitcnt lgkmcnt(7)
v_mfma_f32_16x16x32_bf16 v[56:59], v[88:91], v[152:155], 0
v_mfma_f32_16x16x32_bf16 v[56:59], v[252:255], v[152:155], v[56:59]
ds_read2_b32 v[120:121], v248 offset0:16 offset1:17
v_mfma_f32_16x16x32_bf16 v[60:63], v[92:95], v[152:155], 0
ds_read2_b32 v[122:123], v248 offset0:18 offset1:19
v_mfma_f32_16x16x32_bf16 v[64:67], v[96:99], v[152:155], 0
ds_read_b128 v[184:187], v247 offset:3648
v_mfma_f32_16x16x32_bf16 v[68:71], v[100:103], v[152:155], 0
ds_read2_b32 v[124:125], v248 offset0:144 offset1:145
v_mfma_f32_16x16x32_bf16 v[72:75], v[104:107], v[152:155], 0
ds_read2_b32 v[126:127], v248 offset0:146 offset1:147
v_mfma_f32_16x16x32_bf16 v[76:79], v[108:111], v[152:155], 0
ds_read_b128 v[188:191], v247 offset:3136
v_mfma_f32_16x16x32_bf16 v[80:83], v[112:115], v[152:155], 0
ds_read2_b32 v[128:129], v249 offset0:16 offset1:17
v_mfma_f32_16x16x32_bf16 v[84:87], v[116:119], v[152:155], 0
ds_read2_b32 v[130:131], v249 offset0:18 offset1:19
s_waitcnt lgkmcnt(14)
v_mfma_f32_16x16x32_bf16 v[60:63], v[88:91], v[156:159], v[60:63]
v_mfma_f32_16x16x32_bf16 v[60:63], v[252:255], v[156:159], v[60:63]
ds_read_b128 v[192:195], v247 offset:2624
v_mfma_f32_16x16x32_bf16 v[64:67], v[92:95], v[156:159], v[64:67]
ds_read2_b32 v[132:133], v249 offset0:144 offset1:145
v_mfma_f32_16x16x32_bf16 v[68:71], v[96:99], v[156:159], v[68:71]
ds_read2_b32 v[134:135], v249 offset0:146 offset1:147
v_mfma_f32_16x16x32_bf16 v[72:75], v[100:103], v[156:159], v[72:75]
ds_read_b128 v[196:199], v247 offset:2112
v_mfma_f32_16x16x32_bf16 v[76:79], v[104:107], v[156:159], v[76:79]
ds_read2_b32 v[136:137], v250 offset0:16 offset1:17
v_mfma_f32_16x16x32_bf16 v[80:83], v[108:111], v[156:159], v[80:83]
ds_read2_b32 v[138:139], v250 offset0:18 offset1:19
v_mfma_f32_16x16x32_bf16 v[84:87], v[112:115], v[156:159], v[84:87]
ds_read_b128 v[200:203], v247 offset:1600
s_waitcnt lgkmcnt(15)
v_mfma_f32_16x16x32_bf16 v[64:67], v[88:91], v[160:163], v[64:67]
v_mfma_f32_16x16x32_bf16 v[64:67], v[252:255], v[160:163], v[64:67]
ds_read2_b32 v[140:141], v250 offset0:144 offset1:145
v_mfma_f32_16x16x32_bf16 v[68:71], v[92:95], v[160:163], v[68:71]
ds_read2_b32 v[142:143], v250 offset0:146 offset1:147
v_mfma_f32_16x16x32_bf16 v[72:75], v[96:99], v[160:163], v[72:75]
ds_read_b128 v[204:207], v247 offset:1088
v_mfma_f32_16x16x32_bf16 v[76:79], v[100:103], v[160:163], v[76:79]
ds_read2_b32 v[144:145], v251 offset0:16 offset1:17
v_mfma_f32_16x16x32_bf16 v[80:83], v[104:107], v[160:163], v[80:83]
ds_read2_b32 v[146:147], v251 offset0:18 offset1:19
v_mfma_f32_16x16x32_bf16 v[84:87], v[108:111], v[160:163], v[84:87]
ds_read_b128 v[208:211], v247 offset:576
v_mfma_f32_16x16x32_bf16 v[68:71], v[88:91], v[164:167], v[68:71]
v_mfma_f32_16x16x32_bf16 v[68:71], v[252:255], v[164:167], v[68:71]
ds_read2_b32 v[148:149], v251 offset0:144 offset1:145
v_mfma_f32_16x16x32_bf16 v[72:75], v[92:95], v[164:167], v[72:75]
ds_read2_b32 v[150:151], v251 offset0:146 offset1:147
v_mfma_f32_16x16x32_bf16 v[76:79], v[96:99], v[164:167], v[76:79]
ds_read_b128 v[212:215], v247 offset:64
v_mfma_f32_16x16x32_bf16 v[80:83], v[100:103], v[164:167], v[80:83]
v_mfma_f32_16x16x32_bf16 v[84:87], v[104:107], v[164:167], v[84:87]
v_mfma_f32_16x16x32_bf16 v[72:75], v[88:91], v[168:171], v[72:75]
v_mfma_f32_16x16x32_bf16 v[72:75], v[252:255], v[168:171], v[72:75]
v_mfma_f32_16x16x32_bf16 v[76:79], v[92:95], v[168:171], v[76:79]
v_mfma_f32_16x16x32_bf16 v[80:83], v[96:99], v[168:171], v[80:83]
v_mfma_f32_16x16x32_bf16 v[84:87], v[100:103], v[168:171], v[84:87]
v_mfma_f32_16x16x32_bf16 v[76:79], v[88:91], v[172:175], v[76:79]
v_mfma_f32_16x16x32_bf16 v[76:79], v[252:255], v[172:175], v[76:79]
v_mfma_f32_16x16x32_bf16 v[80:83], v[92:95], v[172:175], v[80:83]
v_mfma_f32_16x16x32_bf16 v[84:87], v[96:99], v[172:175], v[84:87]
v_mfma_f32_16x16x32_bf16 v[80:83], v[88:91], v[176:179], v[80:83]
v_mfma_f32_16x16x32_bf16 v[80:83], v[252:255], v[176:179], v[80:83]
v_mfma_f32_16x16x32_bf16 v[84:87], v[92:95], v[176:179], v[84:87]
v_mfma_f32_16x16x32_bf16 v[84:87], v[88:91], v[180:183], v[84:87]
v_mfma_f32_16x16x32_bf16 v[84:87], v[252:255], v[180:183], v[84:87]
s_waitcnt lgkmcnt(15)
v_mfma_f32_16x16x32_bf16 v[56:59], v[120:123], v[184:187], v[56:59]
ds_read2_b32 v[88:89], v248 offset0:32 offset1:33
v_mfma_f32_16x16x32_bf16 v[60:63], v[120:123], v[188:191], v[60:63]
ds_read2_b32 v[90:91], v248 offset0:34 offset1:35
v_mfma_f32_16x16x32_bf16 v[60:63], v[124:127], v[184:187], v[60:63]
ds_read_b128 v[152:155], v247 offset:3712
v_mfma_f32_16x16x32_bf16 v[64:67], v[124:127], v[188:191], v[64:67]
ds_read2_b32 v[92:93], v248 offset0:160 offset1:161
v_mfma_f32_16x16x32_bf16 v[64:67], v[120:123], v[192:195], v[64:67]
ds_read2_b32 v[94:95], v248 offset0:162 offset1:163
v_mfma_f32_16x16x32_bf16 v[68:71], v[124:127], v[192:195], v[68:71]
ds_read_b128 v[156:159], v247 offset:3200
v_mfma_f32_16x16x32_bf16 v[64:67], v[128:131], v[184:187], v[64:67]
ds_read2_b32 v[96:97], v249 offset0:32 offset1:33
v_mfma_f32_16x16x32_bf16 v[68:71], v[128:131], v[188:191], v[68:71]
ds_read2_b32 v[98:99], v249 offset0:34 offset1:35
v_mfma_f32_16x16x32_bf16 v[72:75], v[128:131], v[192:195], v[72:75]
ds_read_b128 v[160:163], v247 offset:2688
s_waitcnt lgkmcnt(15)
v_mfma_f32_16x16x32_bf16 v[68:71], v[120:123], v[196:199], v[68:71]
ds_read2_b32 v[100:101], v249 offset0:160 offset1:161
v_mfma_f32_16x16x32_bf16 v[72:75], v[124:127], v[196:199], v[72:75]
ds_read2_b32 v[102:103], v249 offset0:162 offset1:163
v_mfma_f32_16x16x32_bf16 v[76:79], v[128:131], v[196:199], v[76:79]
ds_read_b128 v[164:167], v247 offset:2176
v_mfma_f32_16x16x32_bf16 v[68:71], v[132:135], v[184:187], v[68:71]
ds_read2_b32 v[104:105], v250 offset0:32 offset1:33
v_mfma_f32_16x16x32_bf16 v[72:75], v[132:135], v[188:191], v[72:75]
ds_read2_b32 v[106:107], v250 offset0:34 offset1:35
v_mfma_f32_16x16x32_bf16 v[76:79], v[132:135], v[192:195], v[76:79]
ds_read_b128 v[168:171], v247 offset:1664
v_mfma_f32_16x16x32_bf16 v[80:83], v[132:135], v[196:199], v[80:83]
ds_read2_b32 v[108:109], v250 offset0:160 offset1:161
v_mfma_f32_16x16x32_bf16 v[72:75], v[120:123], v[200:203], v[72:75]
ds_read2_b32 v[110:111], v250 offset0:162 offset1:163
v_mfma_f32_16x16x32_bf16 v[76:79], v[124:127], v[200:203], v[76:79]
ds_read_b128 v[172:175], v247 offset:1152
v_mfma_f32_16x16x32_bf16 v[80:83], v[128:131], v[200:203], v[80:83]
ds_read2_b32 v[112:113], v251 offset0:32 offset1:33
v_mfma_f32_16x16x32_bf16 v[84:87], v[132:135], v[200:203], v[84:87]
ds_read2_b32 v[114:115], v251 offset0:34 offset1:35
v_mfma_f32_16x16x32_bf16 v[72:75], v[136:139], v[184:187], v[72:75]
ds_read_b128 v[176:179], v247 offset:640
v_mfma_f32_16x16x32_bf16 v[76:79], v[136:139], v[188:191], v[76:79]
ds_read2_b32 v[116:117], v251 offset0:160 offset1:161
v_mfma_f32_16x16x32_bf16 v[80:83], v[136:139], v[192:195], v[80:83]
ds_read2_b32 v[118:119], v251 offset0:162 offset1:163
v_mfma_f32_16x16x32_bf16 v[84:87], v[136:139], v[196:199], v[84:87]
ds_read_b128 v[180:183], v247 offset:128
v_mfma_f32_16x16x32_bf16 v[76:79], v[120:123], v[204:207], v[76:79]
v_mfma_f32_16x16x32_bf16 v[80:83], v[124:127], v[204:207], v[80:83]
v_mfma_f32_16x16x32_bf16 v[84:87], v[128:131], v[204:207], v[84:87]
v_mfma_f32_16x16x32_bf16 v[76:79], v[140:143], v[184:187], v[76:79]
v_mfma_f32_16x16x32_bf16 v[80:83], v[140:143], v[188:191], v[80:83]
v_mfma_f32_16x16x32_bf16 v[84:87], v[140:143], v[192:195], v[84:87]
s_waitcnt lgkmcnt(15)
v_mfma_f32_16x16x32_bf16 v[80:83], v[120:123], v[208:211], v[80:83]
v_mfma_f32_16x16x32_bf16 v[84:87], v[124:127], v[208:211], v[84:87]
v_mfma_f32_16x16x32_bf16 v[80:83], v[144:147], v[184:187], v[80:83]
v_mfma_f32_16x16x32_bf16 v[84:87], v[144:147], v[188:191], v[84:87]
v_mfma_f32_16x16x32_bf16 v[84:87], v[120:123], v[212:215], v[84:87]
v_mfma_f32_16x16x32_bf16 v[84:87], v[148:151], v[184:187], v[84:87]
v_mfma_f32_16x16x32_bf16 v[56:59], v[88:91], v[152:155], v[56:59]
ds_read2_b32 v[120:121], v248 offset0:48 offset1:49
v_mfma_f32_16x16x32_bf16 v[60:63], v[88:91], v[156:159], v[60:63]
ds_read2_b32 v[122:123], v248 offset0:50 offset1:51
v_mfma_f32_16x16x32_bf16 v[60:63], v[92:95], v[152:155], v[60:63]
ds_read_b128 v[184:187], v247 offset:3776
v_mfma_f32_16x16x32_bf16 v[64:67], v[92:95], v[156:159], v[64:67]
ds_read2_b32 v[124:125], v248 offset0:176 offset1:177
v_mfma_f32_16x16x32_bf16 v[64:67], v[88:91], v[160:163], v[64:67]
ds_read2_b32 v[126:127], v248 offset0:178 offset1:179
v_mfma_f32_16x16x32_bf16 v[68:71], v[92:95], v[160:163], v[68:71]
ds_read_b128 v[188:191], v247 offset:3264
v_mfma_f32_16x16x32_bf16 v[64:67], v[96:99], v[152:155], v[64:67]
ds_read2_b32 v[128:129], v249 offset0:48 offset1:49
v_mfma_f32_16x16x32_bf16 v[68:71], v[96:99], v[156:159], v[68:71]
ds_read2_b32 v[130:131], v249 offset0:50 offset1:51
v_mfma_f32_16x16x32_bf16 v[72:75], v[96:99], v[160:163], v[72:75]
ds_read_b128 v[192:195], v247 offset:2752
s_waitcnt lgkmcnt(15)
v_mfma_f32_16x16x32_bf16 v[68:71], v[88:91], v[164:167], v[68:71]
ds_read2_b32 v[132:133], v249 offset0:176 offset1:177
v_mfma_f32_16x16x32_bf16 v[72:75], v[92:95], v[164:167], v[72:75]
ds_read2_b32 v[134:135], v249 offset0:178 offset1:179
v_mfma_f32_16x16x32_bf16 v[76:79], v[96:99], v[164:167], v[76:79]
ds_read_b128 v[196:199], v247 offset:2240
v_mfma_f32_16x16x32_bf16 v[68:71], v[100:103], v[152:155], v[68:71]
ds_read2_b32 v[136:137], v250 offset0:48 offset1:49
v_mfma_f32_16x16x32_bf16 v[72:75], v[100:103], v[156:159], v[72:75]
ds_read2_b32 v[138:139], v250 offset0:50 offset1:51
v_mfma_f32_16x16x32_bf16 v[76:79], v[100:103], v[160:163], v[76:79]
ds_read_b128 v[200:203], v247 offset:1728
v_mfma_f32_16x16x32_bf16 v[80:83], v[100:103], v[164:167], v[80:83]
ds_read2_b32 v[140:141], v250 offset0:176 offset1:177
v_mfma_f32_16x16x32_bf16 v[72:75], v[88:91], v[168:171], v[72:75]
ds_read2_b32 v[142:143], v250 offset0:178 offset1:179
v_mfma_f32_16x16x32_bf16 v[76:79], v[92:95], v[168:171], v[76:79]
ds_read_b128 v[204:207], v247 offset:1216
v_mfma_f32_16x16x32_bf16 v[80:83], v[96:99], v[168:171], v[80:83]
ds_read2_b32 v[144:145], v251 offset0:48 offset1:49
v_mfma_f32_16x16x32_bf16 v[84:87], v[100:103], v[168:171], v[84:87]
ds_read2_b32 v[146:147], v251 offset0:50 offset1:51
v_mfma_f32_16x16x32_bf16 v[72:75], v[104:107], v[152:155], v[72:75]
ds_read_b128 v[208:211], v247 offset:704
v_mfma_f32_16x16x32_bf16 v[76:79], v[104:107], v[156:159], v[76:79]
ds_read2_b32 v[148:149], v251 offset0:176 offset1:177
v_mfma_f32_16x16x32_bf16 v[80:83], v[104:107], v[160:163], v[80:83]
ds_read2_b32 v[150:151], v251 offset0:178 offset1:179
v_mfma_f32_16x16x32_bf16 v[84:87], v[104:107], v[164:167], v[84:87]
ds_read_b128 v[212:215], v247 offset:192
v_mfma_f32_16x16x32_bf16 v[76:79], v[88:91], v[172:175], v[76:79]
v_mfma_f32_16x16x32_bf16 v[80:83], v[92:95], v[172:175], v[80:83]
v_mfma_f32_16x16x32_bf16 v[84:87], v[96:99], v[172:175], v[84:87]
v_mfma_f32_16x16x32_bf16 v[76:79], v[108:111], v[152:155], v[76:79]
v_mfma_f32_16x16x32_bf16 v[80:83], v[108:111], v[156:159], v[80:83]
v_mfma_f32_16x16x32_bf16 v[84:87], v[108:111], v[160:163], v[84:87]
s_waitcnt lgkmcnt(15)
v_mfma_f32_16x16x32_bf16 v[80:83], v[88:91], v[176:179], v[80:83]
v_mfma_f32_16x16x32_bf16 v[84:87], v[92:95], v[176:179], v[84:87]
v_mfma_f32_16x16x32_bf16 v[80:83], v[112:115], v[152:155], v[80:83]
v_mfma_f32_16x16x32_bf16 v[84:87], v[112:115], v[156:159], v[84:87]
v_mfma_f32_16x16x32_bf16 v[84:87], v[88:91], v[180:183], v[84:87]
v_mfma_f32_16x16x32_bf16 v[84:87], v[116:119], v[152:155], v[84:87]
v_mfma_f32_16x16x32_bf16 v[56:59], v[120:123], v[184:187], v[56:59]
ds_read2_b32 v[88:89], v248 offset0:64 offset1:65
v_mfma_f32_16x16x32_bf16 v[60:63], v[120:123], v[188:191], v[60:63]
ds_read2_b32 v[90:91], v248 offset0:66 offset1:67
v_mfma_f32_16x16x32_bf16 v[60:63], v[124:127], v[184:187], v[60:63]
ds_read_b128 v[152:155], v247 offset:3840
v_mfma_f32_16x16x32_bf16 v[64:67], v[124:127], v[188:191], v[64:67]
ds_read2_b32 v[92:93], v248 offset0:192 offset1:193
v_mfma_f32_16x16x32_bf16 v[64:67], v[120:123], v[192:195], v[64:67]
ds_read2_b32 v[94:95], v248 offset0:194 offset1:195
v_mfma_f32_16x16x32_bf16 v[68:71], v[124:127], v[192:195], v[68:71]
ds_read_b128 v[156:159], v247 offset:3328
v_mfma_f32_16x16x32_bf16 v[64:67], v[128:131], v[184:187], v[64:67]
ds_read2_b32 v[96:97], v249 offset0:64 offset1:65
v_mfma_f32_16x16x32_bf16 v[68:71], v[128:131], v[188:191], v[68:71]
ds_read2_b32 v[98:99], v249 offset0:66 offset1:67
v_mfma_f32_16x16x32_bf16 v[72:75], v[128:131], v[192:195], v[72:75]
ds_read_b128 v[160:163], v247 offset:2816
s_waitcnt lgkmcnt(15)
v_mfma_f32_16x16x32_bf16 v[68:71], v[120:123], v[196:199], v[68:71]
ds_read2_b32 v[100:101], v249 offset0:192 offset1:193
v_mfma_f32_16x16x32_bf16 v[72:75], v[124:127], v[196:199], v[72:75]
ds_read2_b32 v[102:103], v249 offset0:194 offset1:195
v_mfma_f32_16x16x32_bf16 v[76:79], v[128:131], v[196:199], v[76:79]
ds_read_b128 v[164:167], v247 offset:2304
v_mfma_f32_16x16x32_bf16 v[68:71], v[132:135], v[184:187], v[68:71]
ds_read2_b32 v[104:105], v250 offset0:64 offset1:65
v_mfma_f32_16x16x32_bf16 v[72:75], v[132:135], v[188:191], v[72:75]
ds_read2_b32 v[106:107], v250 offset0:66 offset1:67
v_mfma_f32_16x16x32_bf16 v[76:79], v[132:135], v[192:195], v[76:79]
ds_read_b128 v[168:171], v247 offset:1792
v_mfma_f32_16x16x32_bf16 v[80:83], v[132:135], v[196:199], v[80:83]
ds_read2_b32 v[108:109], v250 offset0:192 offset1:193
v_mfma_f32_16x16x32_bf16 v[72:75], v[120:123], v[200:203], v[72:75]
ds_read2_b32 v[110:111], v250 offset0:194 offset1:195
v_mfma_f32_16x16x32_bf16 v[76:79], v[124:127], v[200:203], v[76:79]
ds_read_b128 v[172:175], v247 offset:1280
v_mfma_f32_16x16x32_bf16 v[80:83], v[128:131], v[200:203], v[80:83]
ds_read2_b32 v[112:113], v251 offset0:64 offset1:65
v_mfma_f32_16x16x32_bf16 v[84:87], v[132:135], v[200:203], v[84:87]
ds_read2_b32 v[114:115], v251 offset0:66 offset1:67
v_mfma_f32_16x16x32_bf16 v[72:75], v[136:139], v[184:187], v[72:75]
ds_read_b128 v[176:179], v247 offset:768
v_mfma_f32_16x16x32_bf16 v[76:79], v[136:139], v[188:191], v[76:79]
ds_read2_b32 v[116:117], v251 offset0:192 offset1:193
v_mfma_f32_16x16x32_bf16 v[80:83], v[136:139], v[192:195], v[80:83]
ds_read2_b32 v[118:119], v251 offset0:194 offset1:195
v_mfma_f32_16x16x32_bf16 v[84:87], v[136:139], v[196:199], v[84:87]
ds_read_b128 v[180:183], v247 offset:256
v_mfma_f32_16x16x32_bf16 v[76:79], v[120:123], v[204:207], v[76:79]
v_mfma_f32_16x16x32_bf16 v[80:83], v[124:127], v[204:207], v[80:83]
v_mfma_f32_16x16x32_bf16 v[84:87], v[128:131], v[204:207], v[84:87]
v_mfma_f32_16x16x32_bf16 v[76:79], v[140:143], v[184:187], v[76:79]
v_mfma_f32_16x16x32_bf16 v[80:83], v[140:143], v[188:191], v[80:83]
v_mfma_f32_16x16x32_bf16 v[84:87], v[140:143], v[192:195], v[84:87]
s_waitcnt lgkmcnt(15)
v_mfma_f32_16x16x32_bf16 v[80:83], v[120:123], v[208:211], v[80:83]
v_mfma_f32_16x16x32_bf16 v[84:87], v[124:127], v[208:211], v[84:87]
v_mfma_f32_16x16x32_bf16 v[80:83], v[144:147], v[184:187], v[80:83]
v_mfma_f32_16x16x32_bf16 v[84:87], v[144:147], v[188:191], v[84:87]
v_mfma_f32_16x16x32_bf16 v[84:87], v[120:123], v[212:215], v[84:87]
v_mfma_f32_16x16x32_bf16 v[84:87], v[148:151], v[184:187], v[84:87]
buffer_load_dword v50, v234, s[16:19], s91 offen sc1
v_mfma_f32_16x16x32_bf16 v[56:59], v[88:91], v[152:155], v[56:59]
ds_read2_b32 v[120:121], v248 offset0:80 offset1:81
v_mfma_f32_16x16x32_bf16 v[60:63], v[88:91], v[156:159], v[60:63]
ds_read2_b32 v[122:123], v248 offset0:82 offset1:83
v_mfma_f32_16x16x32_bf16 v[60:63], v[92:95], v[152:155], v[60:63]
ds_read_b128 v[184:187], v247 offset:3904
v_mfma_f32_16x16x32_bf16 v[64:67], v[92:95], v[156:159], v[64:67]
ds_read2_b32 v[124:125], v248 offset0:208 offset1:209
v_mfma_f32_16x16x32_bf16 v[64:67], v[88:91], v[160:163], v[64:67]
ds_read2_b32 v[126:127], v248 offset0:210 offset1:211
v_mfma_f32_16x16x32_bf16 v[68:71], v[92:95], v[160:163], v[68:71]
ds_read_b128 v[188:191], v247 offset:3392
v_mfma_f32_16x16x32_bf16 v[64:67], v[96:99], v[152:155], v[64:67]
ds_read2_b32 v[128:129], v249 offset0:80 offset1:81
v_mfma_f32_16x16x32_bf16 v[68:71], v[96:99], v[156:159], v[68:71]
ds_read2_b32 v[130:131], v249 offset0:82 offset1:83
v_mfma_f32_16x16x32_bf16 v[72:75], v[96:99], v[160:163], v[72:75]
ds_read_b128 v[192:195], v247 offset:2880
s_waitcnt lgkmcnt(15)
v_mfma_f32_16x16x32_bf16 v[68:71], v[88:91], v[164:167], v[68:71]
ds_read2_b32 v[132:133], v249 offset0:208 offset1:209
v_mfma_f32_16x16x32_bf16 v[72:75], v[92:95], v[164:167], v[72:75]
ds_read2_b32 v[134:135], v249 offset0:210 offset1:211
v_mfma_f32_16x16x32_bf16 v[76:79], v[96:99], v[164:167], v[76:79]
ds_read_b128 v[196:199], v247 offset:2368
v_mfma_f32_16x16x32_bf16 v[68:71], v[100:103], v[152:155], v[68:71]
ds_read2_b32 v[136:137], v250 offset0:80 offset1:81
v_mfma_f32_16x16x32_bf16 v[72:75], v[100:103], v[156:159], v[72:75]
ds_read2_b32 v[138:139], v250 offset0:82 offset1:83
v_mfma_f32_16x16x32_bf16 v[76:79], v[100:103], v[160:163], v[76:79]
ds_read_b128 v[200:203], v247 offset:1856
v_mfma_f32_16x16x32_bf16 v[80:83], v[100:103], v[164:167], v[80:83]
ds_read2_b32 v[140:141], v250 offset0:208 offset1:209
v_mfma_f32_16x16x32_bf16 v[72:75], v[88:91], v[168:171], v[72:75]
ds_read2_b32 v[142:143], v250 offset0:210 offset1:211
v_mfma_f32_16x16x32_bf16 v[76:79], v[92:95], v[168:171], v[76:79]
ds_read_b128 v[204:207], v247 offset:1344
v_mfma_f32_16x16x32_bf16 v[80:83], v[96:99], v[168:171], v[80:83]
ds_read2_b32 v[144:145], v251 offset0:80 offset1:81
v_mfma_f32_16x16x32_bf16 v[84:87], v[100:103], v[168:171], v[84:87]
ds_read2_b32 v[146:147], v251 offset0:82 offset1:83
v_mfma_f32_16x16x32_bf16 v[72:75], v[104:107], v[152:155], v[72:75]
ds_read_b128 v[208:211], v247 offset:832
v_mfma_f32_16x16x32_bf16 v[76:79], v[104:107], v[156:159], v[76:79]
ds_read2_b32 v[148:149], v251 offset0:208 offset1:209
v_mfma_f32_16x16x32_bf16 v[80:83], v[104:107], v[160:163], v[80:83]
ds_read2_b32 v[150:151], v251 offset0:210 offset1:211
v_mfma_f32_16x16x32_bf16 v[84:87], v[104:107], v[164:167], v[84:87]
ds_read_b128 v[212:215], v247 offset:320
v_mfma_f32_16x16x32_bf16 v[76:79], v[88:91], v[172:175], v[76:79]
v_mfma_f32_16x16x32_bf16 v[80:83], v[92:95], v[172:175], v[80:83]
v_mfma_f32_16x16x32_bf16 v[84:87], v[96:99], v[172:175], v[84:87]
v_mfma_f32_16x16x32_bf16 v[76:79], v[108:111], v[152:155], v[76:79]
v_mfma_f32_16x16x32_bf16 v[80:83], v[108:111], v[156:159], v[80:83]
v_mfma_f32_16x16x32_bf16 v[84:87], v[108:111], v[160:163], v[84:87]
s_waitcnt lgkmcnt(15)
v_mfma_f32_16x16x32_bf16 v[80:83], v[88:91], v[176:179], v[80:83]
v_mfma_f32_16x16x32_bf16 v[84:87], v[92:95], v[176:179], v[84:87]
v_mfma_f32_16x16x32_bf16 v[80:83], v[112:115], v[152:155], v[80:83]
v_mfma_f32_16x16x32_bf16 v[84:87], v[112:115], v[156:159], v[84:87]
v_mfma_f32_16x16x32_bf16 v[84:87], v[88:91], v[180:183], v[84:87]
v_mfma_f32_16x16x32_bf16 v[84:87], v[116:119], v[152:155], v[84:87]
s_cbranch_vccnz rdy_4
s_waitcnt vmcnt(0)
v_subrev_u32 v50, s92, v50
v_cmp_lt_u32 s[6:7], 15, v50
v_cmp_ne_u32 s[94:95], s37, v50
s_nop 0
s_and_b32 s94, s94, 0x00ff0000
s_cselect_b32 s23, 1, 0
s_and_b32 s6, s6, 0x00ffffff
s_cselect_b64 vcc, 0, -1
s_cbranch_scc0 rdy_4
s_mov_b32 s23, 1
s_mov_b32 s90, 2
rdy_4:
v_mfma_f32_16x16x32_bf16 v[56:59], v[120:123], v[184:187], v[56:59]
ds_read2_b32 v[88:89], v248 offset0:96 offset1:97
v_mfma_f32_16x16x32_bf16 v[60:63], v[120:123], v[188:191], v[60:63]
ds_read2_b32 v[90:91], v248 offset0:98 offset1:99
v_mfma_f32_16x16x32_bf16 v[60:63], v[124:127], v[184:187], v[60:63]
ds_read_b128 v[152:155], v247 offset:3968
s_cbranch_vccz sk_5
global_load_dwordx4 a[0:3], v53, s[16:17] offset:-4096
sk_5:
v_mfma_f32_16x16x32_bf16 v[64:67], v[124:127], v[188:191], v[64:67]
ds_read2_b32 v[92:93], v248 offset0:224 offset1:225
v_mfma_f32_16x16x32_bf16 v[64:67], v[120:123], v[192:195], v[64:67]
ds_read2_b32 v[94:95], v248 offset0:226 offset1:227
v_mfma_f32_16x16x32_bf16 v[68:71], v[124:127], v[192:195], v[68:71]
ds_read_b128 v[156:159], v247 offset:3456
v_mfma_f32_16x16x32_bf16 v[64:67], v[128:131], v[184:187], v[64:67]
ds_read2_b32 v[96:97], v249 offset0:96 offset1:97
v_mfma_f32_16x16x32_bf16 v[68:71], v[128:131], v[188:191], v[68:71]
ds_read2_b32 v[98:99], v249 offset0:98 offset1:99
s_cbranch_vccz sk_6
global_load_dwordx4 a[4:7], v53, s[16:17] offset:-3072
sk_6:
v_mfma_f32_16x16x32_bf16 v[72:75], v[128:131], v[192:195], v[72:75]
ds_read_b128 v[160:163], v247 offset:2944
s_waitcnt lgkmcnt(15)
v_mfma_f32_16x16x32_bf16 v[68:71], v[120:123], v[196:199], v[68:71]
ds_read2_b32 v[100:101], v249 offset0:224 offset1:225
v_mfma_f32_16x16x32_bf16 v[72:75], v[124:127], v[196:199], v[72:75]
ds_read2_b32 v[102:103], v249 offset0:226 offset1:227
v_mfma_f32_16x16x32_bf16 v[76:79], v[128:131], v[196:199], v[76:79]
ds_read_b128 v[164:167], v247 offset:2432
v_mfma_f32_16x16x32_bf16 v[68:71], v[132:135], v[184:187], v[68:71]
ds_read2_b32 v[104:105], v250 offset0:96 offset1:97
s_cbranch_vccz sk_7
global_load_dwordx4 a[8:11], v53, s[16:17] offset:-2048
sk_7:
v_mfma_f32_16x16x32_bf16 v[72:75], v[132:135], v[188:191], v[72:75]
ds_read2_b32 v[106:107], v250 offset0:98 offset1:99
v_mfma_f32_16x16x32_bf16 v[76:79], v[132:135], v[192:195], v[76:79]
ds_read_b128 v[168:171], v247 offset:1920
v_mfma_f32_16x16x32_bf16 v[80:83], v[132:135], v[196:199], v[80:83]
ds_read2_b32 v[108:109], v250 offset0:224 offset1:225
v_mfma_f32_16x16x32_bf16 v[72:75], v[120:123], v[200:203], v[72:75]
ds_read2_b32 v[110:111], v250 offset0:226 offset1:227
v_mfma_f32_16x16x32_bf16 v[76:79], v[124:127], v[200:203], v[76:79]
ds_read_b128 v[172:175], v247 offset:1408
s_cbranch_vccz sk_8
global_load_dwordx4 a[12:15], v53, s[16:17] offset:-1024
sk_8:
v_mfma_f32_16x16x32_bf16 v[80:83], v[128:131], v[200:203], v[80:83]
ds_read2_b32 v[112:113], v251 offset0:96 offset1:97
v_mfma_f32_16x16x32_bf16 v[84:87], v[132:135], v[200:203], v[84:87]
ds_read2_b32 v[114:115], v251 offset0:98 offset1:99
v_mfma_f32_16x16x32_bf16 v[72:75], v[136:139], v[184:187], v[72:75]
ds_read_b128 v[176:179], v247 offset:896
v_mfma_f32_16x16x32_bf16 v[76:79], v[136:139], v[188:191], v[76:79]
ds_read2_b32 v[116:117], v251 offset0:224 offset1:225
v_mfma_f32_16x16x32_bf16 v[80:83], v[136:139], v[192:195], v[80:83]
ds_read2_b32 v[118:119], v251 offset0:226 offset1:227
v_mfma_f32_16x16x32_bf16 v[84:87], v[136:139], v[196:199], v[84:87]
ds_read_b128 v[180:183], v247 offset:384
v_mfma_f32_16x16x32_bf16 v[76:79], v[120:123], v[204:207], v[76:79]
v_mfma_f32_16x16x32_bf16 v[80:83], v[124:127], v[204:207], v[80:83]
v_mfma_f32_16x16x32_bf16 v[84:87], v[128:131], v[204:207], v[84:87]
v_mfma_f32_16x16x32_bf16 v[76:79], v[140:143], v[184:187], v[76:79]
v_mfma_f32_16x16x32_bf16 v[80:83], v[140:143], v[188:191], v[80:83]
v_mfma_f32_16x16x32_bf16 v[84:87], v[140:143], v[192:195], v[84:87]
s_waitcnt lgkmcnt(15)
v_mfma_f32_16x16x32_bf16 v[80:83], v[120:123], v[208:211], v[80:83]
v_mfma_f32_16x16x32_bf16 v[84:87], v[124:127], v[208:211], v[84:87]
v_mfma_f32_16x16x32_bf16 v[80:83], v[144:147], v[184:187], v[80:83]
v_mfma_f32_16x16x32_bf16 v[84:87], v[144:147], v[188:191], v[84:87]
v_mfma_f32_16x16x32_bf16 v[84:87], v[120:123], v[212:215], v[84:87]
v_mfma_f32_16x16x32_bf16 v[84:87], v[148:151], v[184:187], v[84:87]
v_mfma_f32_16x16x32_bf16 v[56:59], v[88:91], v[152:155], v[56:59]
ds_read2_b32 v[120:121], v248 offset0:112 offset1:113
v_mfma_f32_16x16x32_bf16 v[60:63], v[88:91], v[156:159], v[60:63]
ds_read2_b32 v[122:123], v248 offset0:114 offset1:115
v_mfma_f32_16x16x32_bf16 v[60:63], v[92:95], v[152:155], v[60:63]
ds_read_b128 v[184:187], v247 offset:4032
s_cbranch_vccz sk_10
global_load_dwordx4 a[16:19], v53, s[16:17] offset:0
sk_10:
v_mfma_f32_16x16x32_bf16 v[64:67], v[92:95], v[156:159], v[64:67]
ds_read2_b32 v[124:125], v248 offset0:240 offset1:241
v_mfma_f32_16x16x32_bf16 v[64:67], v[88:91], v[160:163], v[64:67]
ds_read2_b32 v[126:127], v248 offset0:242 offset1:243
v_mfma_f32_16x16x32_bf16 v[68:71], v[92:95], v[160:163], v[68:71]
ds_read_b128 v[188:191], v247 offset:3520
v_mfma_f32_16x16x32_bf16 v[64:67], v[96:99], v[152:155], v[64:67]
ds_read2_b32 v[128:129], v249 offset0:112 offset1:113
v_mfma_f32_16x16x32_bf16 v[68:71], v[96:99], v[156:159], v[68:71]
ds_read2_b32 v[130:131], v249 offset0:114 offset1:115
s_cbranch_vccz sk_11
global_load_dwordx4 a[20:23], v53, s[16:17] offset:1024
sk_11:
v_mfma_f32_16x16x32_bf16 v[72:75], v[96:99], v[160:163], v[72:75]
ds_read_b128 v[192:195], v247 offset:3008
s_waitcnt lgkmcnt(15)
v_mfma_f32_16x16x32_bf16 v[68:71], v[88:91], v[164:167], v[68:71]
ds_read2_b32 v[132:133], v249 offset0:240 offset1:241
v_mfma_f32_16x16x32_bf16 v[72:75], v[92:95], v[164:167], v[72:75]
ds_read2_b32 v[134:135], v249 offset0:242 offset1:243
v_mfma_f32_16x16x32_bf16 v[76:79], v[96:99], v[164:167], v[76:79]
ds_read_b128 v[196:199], v247 offset:2496
v_mfma_f32_16x16x32_bf16 v[68:71], v[100:103], v[152:155], v[68:71]
ds_read2_b32 v[136:137], v250 offset0:112 offset1:113
s_cbranch_vccz sk_12
global_load_dwordx4 a[24:27], v53, s[16:17] offset:2048
sk_12:
v_mfma_f32_16x16x32_bf16 v[72:75], v[100:103], v[156:159], v[72:75]
ds_read2_b32 v[138:139], v250 offset0:114 offset1:115
v_mfma_f32_16x16x32_bf16 v[76:79], v[100:103], v[160:163], v[76:79]
ds_read_b128 v[200:203], v247 offset:1984
v_mfma_f32_16x16x32_bf16 v[80:83], v[100:103], v[164:167], v[80:83]
ds_read2_b32 v[140:141], v250 offset0:240 offset1:241
v_mfma_f32_16x16x32_bf16 v[72:75], v[88:91], v[168:171], v[72:75]
ds_read2_b32 v[142:143], v250 offset0:242 offset1:243
v_mfma_f32_16x16x32_bf16 v[76:79], v[92:95], v[168:171], v[76:79]
ds_read_b128 v[204:207], v247 offset:1472
s_cbranch_vccz sk_13
global_load_dwordx4 a[28:31], v53, s[16:17] offset:3072
sk_13:
v_mfma_f32_16x16x32_bf16 v[80:83], v[96:99], v[168:171], v[80:83]
ds_read2_b32 v[144:145], v251 offset0:112 offset1:113
v_mfma_f32_16x16x32_bf16 v[84:87], v[100:103], v[168:171], v[84:87]
ds_read2_b32 v[146:147], v251 offset0:114 offset1:115
v_mfma_f32_16x16x32_bf16 v[72:75], v[104:107], v[152:155], v[72:75]
ds_read_b128 v[208:211], v247 offset:960
v_mfma_f32_16x16x32_bf16 v[76:79], v[104:107], v[156:159], v[76:79]
ds_read2_b32 v[148:149], v251 offset0:240 offset1:241
v_mfma_f32_16x16x32_bf16 v[80:83], v[104:107], v[160:163], v[80:83]
ds_read2_b32 v[150:151], v251 offset0:242 offset1:243
v_mfma_f32_16x16x32_bf16 v[84:87], v[104:107], v[164:167], v[84:87]
ds_read_b128 v[212:215], v247 offset:448
v_mfma_f32_16x16x32_bf16 v[76:79], v[88:91], v[172:175], v[76:79]
v_mfma_f32_16x16x32_bf16 v[80:83], v[92:95], v[172:175], v[80:83]
v_mfma_f32_16x16x32_bf16 v[84:87], v[96:99], v[172:175], v[84:87]
v_mfma_f32_16x16x32_bf16 v[76:79], v[108:111], v[152:155], v[76:79]
v_mfma_f32_16x16x32_bf16 v[80:83], v[108:111], v[156:159], v[80:83]
v_mfma_f32_16x16x32_bf16 v[84:87], v[108:111], v[160:163], v[84:87]
s_waitcnt lgkmcnt(15)
v_mfma_f32_16x16x32_bf16 v[80:83], v[88:91], v[176:179], v[80:83]
v_mfma_f32_16x16x32_bf16 v[84:87], v[92:95], v[176:179], v[84:87]
v_mfma_f32_16x16x32_bf16 v[80:83], v[112:115], v[152:155], v[80:83]
v_mfma_f32_16x16x32_bf16 v[84:87], v[112:115], v[156:159], v[84:87]
v_mfma_f32_16x16x32_bf16 v[84:87], v[88:91], v[180:183], v[84:87]
v_mfma_f32_16x16x32_bf16 v[84:87], v[116:119], v[152:155], v[84:87]
v_mfma_f32_16x16x32_bf16 v[56:59], v[120:123], v[184:187], v[56:59]
v_mfma_f32_16x16x32_bf16 v[60:63], v[120:123], v[188:191], v[60:63]
v_mfma_f32_16x16x32_bf16 v[60:63], v[124:127], v[184:187], v[60:63]
v_mfma_f32_16x16x32_bf16 v[64:67], v[124:127], v[188:191], v[64:67]
v_mfma_f32_16x16x32_bf16 v[64:67], v[120:123], v[192:195], v[64:67]
s_nop 3
v_cvt_pk_bf16_f32 v32, v56, v57
v_cvt_pk_bf16_f32 v34, v58, v59
v_mfma_f32_16x16x32_bf16 v[64:67], v[128:131], v[184:187], v[64:67]
global_store_dwordx4 v216, v[32:35], s[16:17] offset:-4096 sc1
v_mfma_f32_16x16x32_bf16 v[68:71], v[124:127], v[192:195], v[68:71]
v_cvt_pk_bf16_f32 v36, v60, v61
v_cvt_pk_bf16_f32 v38, v62, v63
v_mfma_f32_16x16x32_bf16 v[68:71], v[128:131], v[188:191], v[68:71]
global_store_dwordx4 v216, v[36:39], s[16:17] offset:-3072 sc1
s_waitcnt lgkmcnt(12)
v_mfma_f32_16x16x32_bf16 v[68:71], v[120:123], v[196:199], v[68:71]
v_mfma_f32_16x16x32_bf16 v[68:71], v[132:135], v[184:187], v[68:71]
v_cvt_pk_bf16_f32 v40, v64, v65
v_cvt_pk_bf16_f32 v42, v66, v67
v_mfma_f32_16x16x32_bf16 v[72:75], v[128:131], v[192:195], v[72:75]
global_store_dwordx4 v216, v[40:43], s[16:17] offset:-2048 sc1
v_mfma_f32_16x16x32_bf16 v[72:75], v[124:127], v[196:199], v[72:75]
v_mfma_f32_16x16x32_bf16 v[72:75], v[132:135], v[188:191], v[72:75]
s_waitcnt lgkmcnt(9)
v_mfma_f32_16x16x32_bf16 v[72:75], v[120:123], v[200:203], v[72:75]
v_cvt_pk_bf16_f32 v32, v68, v69
v_cvt_pk_bf16_f32 v34, v70, v71
v_mfma_f32_16x16x32_bf16 v[72:75], v[136:139], v[184:187], v[72:75]
global_store_dwordx4 v216, v[32:35], s[16:17] offset:-1024 sc1
v_mfma_f32_16x16x32_bf16 v[76:79], v[128:131], v[196:199], v[76:79]
v_mfma_f32_16x16x32_bf16 v[76:79], v[132:135], v[192:195], v[76:79]
v_mfma_f32_16x16x32_bf16 v[76:79], v[124:127], v[200:203], v[76:79]
v_mfma_f32_16x16x32_bf16 v[76:79], v[136:139], v[188:191], v[76:79]
s_nop 2
v_cvt_pk_bf16_f32 v36, v72, v73
v_cvt_pk_bf16_f32 v38, v74, v75
s_waitcnt lgkmcnt(6)
v_mfma_f32_16x16x32_bf16 v[76:79], v[120:123], v[204:207], v[76:79]
global_store_dwordx4 v216, v[36:39], s[16:17] offset:0 sc1
v_mfma_f32_16x16x32_bf16 v[76:79], v[140:143], v[184:187], v[76:79]
v_mfma_f32_16x16x32_bf16 v[80:83], v[132:135], v[196:199], v[80:83]
v_mfma_f32_16x16x32_bf16 v[80:83], v[128:131], v[200:203], v[80:83]
v_mfma_f32_16x16x32_bf16 v[80:83], v[136:139], v[192:195], v[80:83]
v_mfma_f32_16x16x32_bf16 v[80:83], v[124:127], v[204:207], v[80:83]
s_nop 3
v_cvt_pk_bf16_f32 v40, v76, v77
v_cvt_pk_bf16_f32 v42, v78, v79
v_mfma_f32_16x16x32_bf16 v[80:83], v[140:143], v[188:191], v[80:83]
global_store_dwordx4 v216, v[40:43], s[16:17] offset:1024 sc1
s_waitcnt lgkmcnt(3)
v_mfma_f32_16x16x32_bf16 v[80:83], v[120:123], v[208:211], v[80:83]
v_mfma_f32_16x16x32_bf16 v[80:83], v[144:147], v[184:187], v[80:83]
v_mfma_f32_16x16x32_bf16 v[84:87], v[132:135], v[200:203], v[84:87]
v_mfma_f32_16x16x32_bf16 v[84:87], v[136:139], v[196:199], v[84:87]
v_mfma_f32_16x16x32_bf16 v[84:87], v[128:131], v[204:207], v[84:87]
v_mfma_f32_16x16x32_bf16 v[84:87], v[140:143], v[192:195], v[84:87]
s_nop 3
v_cvt_pk_bf16_f32 v32, v80, v81
v_cvt_pk_bf16_f32 v34, v82, v83
v_mfma_f32_16x16x32_bf16 v[84:87], v[124:127], v[208:211], v[84:87]
global_store_dwordx4 v216, v[32:35], s[16:17] offset:2048 sc1
v_mfma_f32_16x16x32_bf16 v[84:87], v[144:147], v[188:191], v[84:87]
s_waitcnt lgkmcnt(0)
v_mfma_f32_16x16x32_bf16 v[84:87], v[120:123], v[212:215], v[84:87]
v_mfma_f32_16x16x32_bf16 v[84:87], v[148:151], v[184:187], v[84:87]
s_nop 7
v_cvt_pk_bf16_f32 v36, v84, v85
v_cvt_pk_bf16_f32 v38, v86, v87
global_store_dwordx4 v216, v[36:39], s[16:17] offset:3072 sc1
s_cmp_eq_u32 s90, 0
s_cbranch_scc1 cu_14
s_mov_b32 s36, 0
s_add_u32 s26, s75, 32
s_mov_b32 s31, 11993088
wp_15:
buffer_load_dword v50, v234, s[16:19], s31 offen sc1
s_add_u32 s36, s36, 1
s_cmp_gt_u32 s36, 0x200000
s_cbranch_scc1 k2_bail
s_waitcnt vmcnt(0)
v_subrev_u32 v50, s26, v50
v_cmp_lt_u32 vcc, 15, v50
s_nop 0
s_and_b32 vcc_lo, vcc_lo, 0xffffff
s_cbranch_scc1 wp_15
v_cmp_ne_u32 vcc, s37, v50
s_nop 0
s_and_b32 vcc_lo, vcc_lo, 0x00ff0000
s_cselect_b32 s23, 1, 0
s_cmp_gt_u32 s90, 0
s_cbranch_scc0 cu_14
global_load_dwordx4 a[0:3], v53, s[16:17] offset:-4096
global_load_dwordx4 a[4:7], v53, s[16:17] offset:-3072
global_load_dwordx4 a[8:11], v53, s[16:17] offset:-2048
global_load_dwordx4 a[12:15], v53, s[16:17] offset:-1024
s_cmp_gt_u32 s90, 1
s_cbranch_scc0 cu_14
global_load_dwordx4 a[16:19], v53, s[16:17] offset:0
global_load_dwordx4 a[20:23], v53, s[16:17] offset:1024
global_load_dwordx4 a[24:27], v53, s[16:17] offset:2048
global_load_dwordx4 a[28:31], v53, s[16:17] offset:3072
cu_14:
s_add_u32 s25, s25, 4096
s_waitcnt vmcnt(8)
s_barrier
v_and_b32 v48, 15, v1
v_mul_u32_u24 v48, 160, v48
v_lshrrev_b32 v49, 4, v1
v_lshl_add_u32 v48, v49, 3, v48
s_lshl_b32 s26, s20, 5
s_add_u32 s26, s26, 65536
v_add_u32 v49, s26, v48
s_mul_i32 s26, s20, 2560
s_add_u32 s26, s26, 65664
v_add_u32 v48, s26, v48
ds_read_b64 v[224:225], v49 offset:0
ds_read_b64 v[226:227], v49 offset:2560
ds_read_b64 v[228:229], v49 offset:5120
ds_read_b64 v[230:231], v49 offset:7680
ds_read_b64 v[232:233], v48
s_waitcnt lgkmcnt(0)
v_lshlrev_b32 v104, 16, v224
v_and_b32 v105, s64, v224
v_lshlrev_b32 v106, 16, v225
v_and_b32 v107, s64, v225
v_lshlrev_b32 v108, 16, v226
v_and_b32 v109, s64, v226
v_lshlrev_b32 v110, 16, v227
v_and_b32 v111, s64, v227
v_lshlrev_b32 v112, 16, v228
v_and_b32 v113, s64, v228
v_lshlrev_b32 v114, 16, v229
v_and_b32 v115, s64, v229
v_lshlrev_b32 v116, 16, v230
v_and_b32 v117, s64, v230
v_lshlrev_b32 v118, 16, v231
v_and_b32 v119, s64, v231
v_lshlrev_b32 v120, 16, v232
v_and_b32 v121, s64, v232
v_lshlrev_b32 v122, 16, v233
v_and_b32 v123, s64, v233
v_pk_add_f32 v[152:153], v[104:105], v[106:107]
v_pk_mul_f32 v[154:155], v[104:105], v[104:105]
v_pk_add_f32 v[156:157], v[108:109], v[110:111]
v_pk_mul_f32 v[158:159], v[108:109], v[108:109]
v_pk_add_f32 v[160:161], v[112:113], v[114:115]
v_pk_mul_f32 v[162:163], v[112:113], v[112:113]
v_pk_add_f32 v[164:165], v[116:117], v[118:119]
v_pk_mul_f32 v[166:167], v[116:117], v[116:117]
v_pk_add_f32 v[168:169], v[120:121], v[122:123]
v_pk_mul_f32 v[170:171], v[120:121], v[120:121]
v_pk_fma_f32 v[154:155], v[106:107], v[106:107], v[154:155]
v_add_f32 v152, v152, v153
v_pk_fma_f32 v[158:159], v[110:111], v[110:111], v[158:159]
v_add_f32 v156, v156, v157
v_pk_fma_f32 v[162:163], v[114:115], v[114:115], v[162:163]
v_add_f32 v160, v160, v161
v_pk_fma_f32 v[166:167], v[118:119], v[118:119], v[166:167]
v_add_f32 v164, v164, v165
v_pk_fma_f32 v[170:171], v[122:123], v[122:123], v[170:171]
v_add_f32 v168, v168, v169
v_add_f32 v153, v154, v155
v_add_f32 v157, v158, v159
v_add_f32 v161, v162, v163
v_add_f32 v165, v166, v167
v_add_f32 v169, v170, v171
v_fmac_f32 v152, s60, v168
v_fmac_f32 v153, s60, v169
v_fmac_f32 v156, s61, v168
v_fmac_f32 v157, s61, v169
v_fmac_f32 v160, s62, v168
v_fmac_f32 v161, s62, v169
v_fmac_f32 v164, s63, v168
v_fmac_f32 v165, s63, v169
v_permlane32_swap_b32 v152, v160
v_permlane32_swap_b32 v156, v164
v_permlane32_swap_b32 v153, v161
v_permlane32_swap_b32 v157, v165
v_pk_add_f32 v[152:153], v[152:153], v[160:161]
v_pk_add_f32 v[156:157], v[156:157], v[164:165]
s_nop 1
v_permlane16_swap_b32 v152, v156
v_permlane16_swap_b32 v153, v157
v_pk_add_f32 v[152:153], v[152:153], v[156:157]
ds_write_b64 v20, v[152:153]
s_waitcnt lgkmcnt(0)
s_barrier
ds_read_b64 v[152:153], v19 offset:0
ds_read_b64 v[154:155], v19 offset:512
ds_read_b64 v[156:157], v19 offset:1024
ds_read_b64 v[158:159], v19 offset:1536
s_add_u32 s74, s28, 0
s_add_u32 s65, s75, 16
v_mov_b32 v161, s65
v_mov_b32 v163, s65
s_waitcnt lgkmcnt(0)
v_pk_add_f32 v[152:153], v[152:153], v[154:155]
v_pk_add_f32 v[156:157], v[156:157], v[158:159]
v_add_f32 v160, v152, v156
v_add_f32 v162, v153, v157
s_cmp_lg_u32 s23, 0
s_cbranch_scc1 slow_16
buffer_store_dwordx4 v[160:163], v220, s[16:19], s74 offen
back_17:
s_add_u32 s25, s25, 4096
buffer_load_dwordx4 a[32:35], v2, s[16:19], s25 offen offset:0
buffer_load_dwordx4 a[36:39], v2, s[16:19], s25 offen offset:1024
buffer_load_dwordx4 a[40:43], v2, s[16:19], s25 offen offset:2048
buffer_load_dwordx4 a[44:47], v2, s[16:19], s25 offen offset:3072
s_add_u32 s25, s25, 4096
buffer_load_dwordx4 a[48:51], v2, s[16:19], s25 offen offset:0
buffer_load_dwordx4 a[52:55], v2, s[16:19], s25 offen offset:1024
buffer_load_dwordx4 a[56:59], v2, s[16:19], s25 offen offset:2048
buffer_load_dwordx4 a[60:63], v2, s[16:19], s25 offen offset:3072
s_add_u32 s25, s25, 4096
buffer_load_dwordx4 a[64:67], v2, s[16:19], s25 offen offset:0
buffer_load_dwordx4 a[68:71], v2, s[16:19], s25 offen offset:1024
buffer_load_dwordx4 a[72:75], v2, s[16:19], s25 offen offset:2048
buffer_load_dwordx4 a[76:79], v2, s[16:19], s25 offen offset:3072
s_add_u32 s25, s25, 4096
buffer_load_dwordx4 a[80:83], v2, s[16:19], s25 offen offset:0
s_branch joined_1
role_pp:
buffer_load_dword v37, v37, s[16:19], 0 offen sc1
s_mul_i32 s3, s5, 3
s_add_u32 s3, s3, s4
s_sub_u32 s3, s3, 5
s_cmp_lt_u32 s3, 80
s_cselect_b32 s101, 1, 0
s_cmp_eq_u32 s101, 1
s_cbranch_scc0 idle_18
s_cmp_ge_u32 s3, 40
s_cselect_b64 s[52:53], s[90:91], s[88:89]
s_cselect_b32 s77, 25, 0
s_cselect_b32 s80, 40, 0
s_cselect_b32 s79, 0, 1
s_mov_b32 s54, 819200
s_mov_b32 s76, 1280
s_sub_u32 s80, s3, s80
s_and_b32 s78, s80, 3
s_lshr_b32 s80, s80, 2
s_mul_i32 s81, s78, 2560
s_add_u32 s81, s81, 10813440
s_mul_i32 s79, s79, s81
s_mul_i32 s78, s78, 5
s_lshl_b32 s81, s78, 2
s_mul_i32 s82, s20, 5
s_add_u32 s81, s81, s82
s_lshl_b32 s82, s76, 3
s_mul_i32 s81, s81, s82
s_lshl_b32 s83, s80, 7
s_add_u32 s81, s81, s83
v_lshrrev_b32 v104, 3, v1
v_mul_lo_u32 v104, v104, s76
v_and_b32 v105, 7, v1
v_lshl_add_u32 v104, v105, 4, v104
s_mul_i32 s26, s20, 5120
s_add_u32 m0, s26, 0
s_nop 0
buffer_load_dwordx4 v104, s[52:55], s81 offen nt lds
s_add_u32 s81, s81, s82
s_add_u32 m0, m0, 1024
s_nop 0
buffer_load_dwordx4 v104, s[52:55], s81 offen nt lds
s_add_u32 s81, s81, s82
s_add_u32 m0, m0, 1024
s_nop 0
buffer_load_dwordx4 v104, s[52:55], s81 offen nt lds
s_add_u32 s81, s81, s82
s_add_u32 m0, m0, 1024
s_nop 0
buffer_load_dwordx4 v104, s[52:55], s81 offen nt lds
s_add_u32 s81, s81, s82
s_add_u32 m0, m0, 1024
s_nop 0
buffer_load_dwordx4 v104, s[52:55], s81 offen nt lds
s_add_u32 s81, s81, s82
s_add_u32 m0, m0, 1024
idle_18:
s_load_dwordx2 s[8:9], s[0:1], 0
s_load_dwordx2 s[96:97], s[0:1], 88
s_load_dwordx2 s[86:87], s[0:1], 40
s_mov_b32 s10, 2621440
s_mov_b32 s11, 0x20000
s_getreg_b32 s37, hwreg(HW_REG_XCC_ID, 0, 4)
s_mov_b32 s64, 0xffff0000
s_lshl_b32 s26, s5, 2
v_mov_b32 v100, s26
v_bfrev_b32 v101, 1
v_cmp_eq_u32 vcc, 0, v0
v_lshlrev_b32 v102, 5, v100
s_nop 0
v_cndmask_b32 v100, v101, v100, vcc
v_lshl_add_u32 v102, v0, 2, v102
v_cmp_gt_u32 vcc, 32, v0
s_nop 1
v_cndmask_b32 v102, v101, v102, vcc
s_lshl_b32 s98, s4, 12
s_add_u32 s98, s98, 11993088
s_cmp_eq_u32 s101, 1
s_cbranch_scc0 idle_18a
s_waitcnt vmcnt(5)
s_branch idle_18b
idle_18a:
s_waitcnt vmcnt(0)
idle_18b:
v_readfirstlane_b32 s75, v37
s_nop 0
s_mul_i32 s75, s75, 0x9e3779b1
s_add_u32 s75, s75, 0x7f4a7c15
s_add_u32 s26, s75, s37
s_add_u32 s26, s26, 32
v_mov_b32 v101, s26
buffer_store_dword v101, v102, s[16:19], s98 offen sc1
s_waitcnt lgkmcnt(0)
v_lshrrev_b32 v33, 4, v1
v_bfe_u32 v34, v1, 2, 2
v_lshl_add_u32 v34, v33, 3, v34
v_lshlrev_b32 v34, 7, v34
v_and_b32 v35, 3, v1
v_lshl_add_u32 v34, v35, 3, v34
v_mov_b32 v36, 0x3f803f80
v_mov_b32 v37, 0x3f803f80
v_mov_b32 v38, 0x3f803f80
v_mov_b32 v39, 0x3f803f80
s_lshl_b32 s21, s4, 2
s_lshr_b32 s26, s2, 6
s_add_u32 s21, s21, s26
s_bfe_u32 s22, s2, 0x30003
s_lshl_b32 s25, s22, 2
s_add_u32 s25, s25, s20
s_mul_i32 s25, s25, 174080
s_add_u32 s25, s25, 5242880
s_lshl_b32 s38, s20, 12
v_and_b32 v96, 15, v1
v_lshrrev_b32 v97, 4, v1
s_lshl_b32 s26, s21, 6
v_add_u32 v98, s26, v96
v_mul_u32_u24 v98, 1280, v98
v_lshl_add_u32 v98, v97, 3, v98
s_mul_i32 s26, s22, 160
s_lshl_b32 s31, s20, 5
s_add_u32 s31, s31, s26
v_add_u32 v14, s31, v98
s_mul_i32 s31, s20, 20480
s_add_u32 s31, s31, s26
s_add_u32 s31, s31, 128
v_add_u32 v15, s31, v98
s_mov_b32 s32, 20480
s_mov_b32 s33, 40960
s_mov_b32 s34, 61440
s_mov_b32 s23, 1
s_mul_i32 s24, s21, 278528
s_add_u32 s24, s24, 12582912
s_lshl_b32 s27, s21, 7
s_add_u32 s27, s27, 10878976
s_lshl_b32 s28, s21, 13
s_add_u32 s28, s28, 10895360
s_mul_i32 s29, s21, 5120
s_add_u32 s29, s29, 11419648
s_mov_b32 s64, 0xffff0000
v_lshlrev_b32 v29, 7, v1
v_bfrev_b32 v219, 1
v_cmp_gt_u32 vcc, 20, v1
s_nop 1
v_cndmask_b32 v30, v219, v29, vcc
v_lshlrev_b32 v29, 7, v96
v_lshl_add_u32 v29, v97, 16, v29
v_cmp_gt_u32 vcc, 48, v1
s_nop 1
v_cndmask_b32 v29, v219, v29, vcc
v_lshlrev_b32 v216, 4, v96
v_lshl_add_u32 v217, v97, 10, v216
s_add_u32 s26, s20, 0
s_and_b32 s26, s26, 3
s_lshl_b32 s26, s26, 12
v_add_u32 v3, s26, v217
v_add_u32 v7, 0x10000, v3
s_cmp_eq_u32 s20, 0
s_cselect_b32 s60, 1.0, 0
s_add_u32 s26, s20, 1
s_and_b32 s26, s26, 3
s_lshl_b32 s26, s26, 12
v_add_u32 v4, s26, v217
v_add_u32 v8, 0x10000, v4
s_cmp_eq_u32 s20, 1
s_cselect_b32 s61, 1.0, 0
s_add_u32 s26, s20, 2
s_and_b32 s26, s26, 3
s_lshl_b32 s26, s26, 12
v_add_u32 v5, s26, v217
v_add_u32 v9, 0x10000, v5
s_cmp_eq_u32 s20, 2
s_cselect_b32 s62, 1.0, 0
s_add_u32 s26, s20, 3
s_and_b32 s26, s26, 3
s_lshl_b32 s26, s26, 12
v_add_u32 v6, s26, v217
v_add_u32 v10, 0x10000, v6
s_cmp_eq_u32 s20, 3
s_cselect_b32 s63, 1.0, 0
v_lshrrev_b32 v218, 1, v97
v_lshl_add_u32 v218, v218, 10, v216
v_and_b32 v219, 1, v97
v_lshl_add_u32 v218, v219, 3, v218
s_mul_i32 s26, s22, 10240
s_lshl_b32 s31, s20, 11
s_add_u32 s31, s31, s26
v_add_u32 v11, s31, v218
s_lshl_b32 s31, s20, 8
s_add_u32 s31, s31, s26
s_add_u32 s31, s31, 8192
v_add_u32 v12, s31, v218
s_lshl_b32 s26, s22, 13
s_lshl_b32 s31, s20, 11
s_add_u32 s31, s31, s26
v_add_u32 v13, s31, v218
v_and_b32 v16, 7, v1
v_lshlrev_b32 v16, 2, v16
s_lshl_b32 s26, s22, 2
v_mov_b32 v17, s26
v_bfrev_b32 v219, 1
v_cmp_eq_u32 vcc, 0, v0
s_nop 1
v_cndmask_b32 v17, v219, v17, vcc
s_lshl_b32 s26, s22, 10
v_add_u32 v220, s26, v2
s_cmp_eq_u32 s20, 1
s_cselect_b64 vcc, -1, 0
v_cndmask_b32 v220, v219, v220, vcc
s_lshl_b32 s26, s20, 8
v_lshl_add_u32 v18, v97, 11, v216
v_add_u32 v18, s26, v18
v_lshlrev_b32 v19, 3, v1
v_add_u32 v19, 155648, v19
s_lshl_b32 s31, s20, 9
v_add_u32 v20, s31, v19
v_add_u32 v22, 157696, v216
v_add_u32 v21, s26, v22
v_add_u32 v23, 32768, v2
s_lshl_b32 s26, s20, 10
v_add_u32 v24, s26, v23
v_add_u32 v23, s38, v23
s_mov_b32 s26, 0x1999999a
v_mul_hi_u32 v52, v1, s26
v_mul_u32_u24 v53, 10, v52
v_sub_u32 v53, v1, v53
v_mul_u32_u24 v52, 1280, v52
v_lshl_add_u32 v224, v53, 4, v52
v_add_u32 v54, 64, v1
v_mul_hi_u32 v52, v54, s26
v_mul_u32_u24 v53, 10, v52
v_sub_u32 v53, v54, v53
v_mul_u32_u24 v52, 1280, v52
v_lshl_add_u32 v225, v53, 4, v52
v_add_u32 v54, 128, v1
v_mul_hi_u32 v52, v54, s26
v_mul_u32_u24 v53, 10, v52
v_sub_u32 v53, v54, v53
v_mul_u32_u24 v52, 1280, v52
v_lshl_add_u32 v226, v53, 4, v52
s_cmp_eq_u32 s101, 1
s_cbranch_scc0 idle_18c
s_lshl_b32 s84, s80, 2
s_add_u32 s84, s84, s20
v_mov_b32 v40, s84
v_add_u32 v41, s78, v1
v_lshrrev_b32 v42, 2, v41
v_and_b32 v41, 3, v41
s_mov_b32 s84, 0x33333334
v_mul_hi_u32 v43, v40, s84
v_mul_u32_u24 v44, 5, v43
v_sub_u32 v44, v40, v44
v_sub_u32 v45, v41, v44
v_and_b32 v45, 3, v45
v_add_u32 v46, 1, v45
v_cmp_eq_u32 vcc, 0, v45
s_nop 1
v_cndmask_b32 v46, v46, v45, vcc
v_cmp_eq_u32 vcc, 4, v44
s_nop 1
v_cndmask_b32 v46, v46, 1, vcc
v_cndmask_b32 v44, v44, v41, vcc
v_mad_u32_u24 v46, v42, 5, v46
v_lshl_add_u32 v44, v43, 2, v44
v_mul_u32_u24 v44, 170, v44
v_add3_u32 v44, v44, v46, s77
v_lshlrev_b32 v44, 10, v44
v_add_u32 v44, 5242880, v44
s_lshl_b32 s85, s20, 5
s_add_u32 s85, s85, 0
v_add_u32 v47, s85, v34
s_lshl_b32 s85, s80, 8
s_lshl_b32 s86, s20, 6
s_add_u32 s85, s85, s86
s_add_u32 s85, s85, s79
v_lshlrev_b32 v45, 4, v33
v_bfrev_b32 v46, 1
v_and_b32 v43, 15, v1
v_cmp_eq_u32 vcc, 0, v43
s_cmp_lg_u32 s79, 0
s_cselect_b64 vcc, vcc, 0
v_cndmask_b32 v45, v46, v45, vcc
s_waitcnt vmcnt(1)
s_barrier
ds_read_b64_tr_b16 v[64:65], v47 offset:0
ds_read_b64_tr_b16 v[66:67], v47 offset:512
ds_read_b64_tr_b16 v[68:69], v47 offset:4096
ds_read_b64_tr_b16 v[70:71], v47 offset:4608
ds_read_b64_tr_b16 v[72:73], v47 offset:8192
ds_read_b64_tr_b16 v[74:75], v47 offset:8704
ds_read_b64_tr_b16 v[76:77], v47 offset:12288
ds_read_b64_tr_b16 v[78:79], v47 offset:12800
ds_read_b64_tr_b16 v[80:81], v47 offset:16384
ds_read_b64_tr_b16 v[82:83], v47 offset:16896
v_readlane_b32 s40, v44, 0
v_readlane_b32 s41, v44, 1
v_readlane_b32 s42, v44, 2
v_readlane_b32 s43, v44, 3
v_readlane_b32 s44, v44, 4
s_waitcnt lgkmcnt(8)
buffer_store_dwordx4 v[64:67], v2, s[16:19], s40 offen sc1
v_mfma_f32_16x16x32_bf16 v[48:51], v[64:67], v[36:39], 0
s_waitcnt lgkmcnt(6)
buffer_store_dwordx4 v[68:71], v2, s[16:19], s41 offen sc1
v_mfma_f32_16x16x32_bf16 v[48:51], v[68:71], v[36:39], v[48:51]
s_waitcnt lgkmcnt(4)
buffer_store_dwordx4 v[72:75], v2, s[16:19], s42 offen sc1
v_mfma_f32_16x16x32_bf16 v[48:51], v[72:75], v[36:39], v[48:51]
s_waitcnt lgkmcnt(2)
buffer_store_dwordx4 v[76:79], v2, s[16:19], s43 offen sc1
v_mfma_f32_16x16x32_bf16 v[48:51], v[76:79], v[36:39], v[48:51]
s_waitcnt lgkmcnt(0)
buffer_store_dwordx4 v[80:83], v2, s[16:19], s44 offen sc1
v_mfma_f32_16x16x32_bf16 v[48:51], v[80:83], v[36:39], v[48:51]
s_nop 7
buffer_store_dwordx4 v[48:51], v45, s[16:19], s85 offen sc1
s_lshl_b32 s84, s3, 7
v_lshl_add_u32 v62, v0, 2, s84
v_bfrev_b32 v63, 1
v_cmp_gt_u32 vcc, 32, v0
s_nop 1
v_cndmask_b32 v62, v63, v62, vcc
s_add_u32 s26, s75, 32
v_mov_b32 v63, s26
s_mov_b32 s84, 12025856
s_waitcnt vmcnt(0)
s_barrier
buffer_store_dword v63, v62, s[16:19], s84 offen sc1
idle_18c:
s_mov_b32 s94, 1966080
s_mov_b32 s95, 0x20000
s_mov_b32 s76, 3072
s_mov_b32 s77, 50
s_lshr_b32 s90, s3, 2
s_and_b32 s78, s3, 3
s_mul_i32 s79, s78, 6144
s_add_u32 s79, s79, 10829824
s_mul_i32 s78, s78, 5
s_add_u32 s89, s3, 80
s_lshl_b32 s91, s78, 2
s_mul_i32 s87, s20, 5
s_add_u32 s91, s91, s87
s_lshl_b32 s87, s76, 3
s_mul_i32 s91, s91, s87
s_lshl_b32 s88, s90, 7
s_add_u32 s91, s91, s88
v_lshrrev_b32 v104, 3, v1
v_mul_lo_u32 v104, v104, s76
v_and_b32 v105, 7, v1
v_lshl_add_u32 v104, v105, 4, v104
s_mul_i32 s26, s20, 5120
s_add_u32 m0, s26, 0
s_nop 0
buffer_load_dwordx4 v104, s[92:95], s91 offen nt lds
s_add_u32 s91, s91, s87
s_add_u32 m0, m0, 1024
s_nop 0
buffer_load_dwordx4 v104, s[92:95], s91 offen nt lds
s_add_u32 s91, s91, s87
s_add_u32 m0, m0, 1024
s_nop 0
buffer_load_dwordx4 v104, s[92:95], s91 offen nt lds
s_add_u32 s91, s91, s87
s_add_u32 m0, m0, 1024
s_nop 0
buffer_load_dwordx4 v104, s[92:95], s91 offen nt lds
s_add_u32 s91, s91, s87
s_add_u32 m0, m0, 1024
s_nop 0
buffer_load_dwordx4 v104, s[92:95], s91 offen nt lds
s_add_u32 s91, s91, s87
s_add_u32 m0, m0, 1024
s_lshl_b32 s26, s21, 2
s_add_u32 s26, s26, s20
s_mul_i32 s26, s26, 20480
s_mul_i32 s31, s22, 160
s_add_u32 s26, s26, s31
s_mul_i32 s31, s20, 2560
s_add_u32 m0, s31, 65536
s_nop 0
buffer_load_dwordx4 v224, s[8:11], s26 offen nt lds
s_add_u32 m0, m0, 1024
s_nop 0
buffer_load_dwordx4 v225, s[8:11], s26 offen nt lds
s_add_u32 m0, m0, 1024
s_mov_b32 exec_hi, 0
buffer_load_dwordx4 v226, s[8:11], s26 offen nt lds
s_mov_b32 exec_hi, -1
s_mul_i32 s26, s22, 10240
s_mul_i32 s31, s20, 2560
s_add_u32 s26, s26, s31
s_add_u32 s26, s26, s24
s_add_u32 s26, s26, 0
buffer_load_dword v217, v30, s[16:19], s26 offen sc1
v_and_b32 v60, 15, v1
v_lshrrev_b32 v61, 4, v1
s_lshr_b32 s26, s22, 2
s_add_u32 s26, s26, 1
s_sub_u32 s31, 0, s26
s_bitcmp1_b32 s22, 1
s_cselect_b32 s35, s31, s26
v_add_u32 v62, s35, v60
v_cmp_le_i32 s[50:51], 0, v62
v_cmp_gt_i32 s[52:53], 16, v62
s_cselect_b32 s31, 2, -16
v_add_u32 v62, s31, v62
v_lshlrev_b32 v62, 6, v62
v_lshl_add_u32 v62, v61, 4, v62
s_cselect_b32 s31, -5120, 0
s_add_u32 s30, s29, s31
s_bitcmp1_b32 s22, 1
s_cselect_b32 s31, 0, 5120
s_add_u32 s30, s30, s31
s_mul_i32 s26, s22, 640
s_add_u32 s31, s26, 512
v_add_u32 v28, s31, v62
s_lshl_b32 s31, s20, 7
s_add_u32 s26, s26, s31
v_add_u32 v27, s26, v62
s_mov_b64 s[54:55], -1
s_cmp_eq_u32 s20, 0
s_cselect_b64 s[54:55], s[50:51], s[54:55]
s_cmp_eq_u32 s20, 3
s_cselect_b64 s[54:55], s[52:53], s[54:55]
s_not_b64 s[66:67], s[50:51]
s_not_b64 s[68:69], s[52:53]
s_cmp_eq_u32 s21, 0
s_cselect_b64 s[66:67], 0, s[66:67]
s_cmp_eq_u32 s21, 31
s_cselect_b64 s[68:69], 0, s[68:69]
s_mov_b64 s[70:71], 0
s_cmp_eq_u32 s20, 0
s_cselect_b64 s[70:71], s[66:67], s[70:71]
s_cmp_eq_u32 s20, 3
s_cselect_b64 s[70:71], s[68:69], s[70:71]
s_or_b64 s[68:69], s[68:69], s[66:67]
v_bfrev_b32 v62, 1
v_cndmask_b32 v27, v62, v27, s[68:69]
v_cndmask_b32 v28, v62, v28, s[70:71]
s_bitcmp1_b32 s22, 1
s_cselect_b64 s[66:67], -1, 0
s_lshl_b32 s35, s35, 4
v_lshrrev_b32 v62, 2, v1
s_mul_i32 s26, s20, 10
v_add_u32 v62, s26, v62
v_and_b32 v63, 3, v1
v_lshlrev_b32 v25, 7, v62
v_lshl_add_u32 v25, v63, 4, v25
v_lshlrev_b32 v62, 11, v62
v_lshrrev_b32 v64, 1, v63
v_lshl_add_u32 v62, v64, 10, v62
v_and_b32 v63, 1, v63
v_lshl_add_u32 v62, v63, 3, v62
s_bitcmp1_b32 s20, 0
s_cselect_b32 s26, 992, 0
v_add_u32 v26, s26, v62
s_cselect_b32 s26, 31, 0
s_cmp_lg_u32 s21, s26
s_cselect_b32 s39, 1, 0
s_mov_b32 s56, -1
s_mov_b32 s57, 0xff
s_mov_b64 s[58:59], s[56:57]
s_cmp_eq_u32 s20, 1
s_cselect_b64 s[56:57], 0, s[56:57]
s_cmp_eq_u32 s20, 0
s_cselect_b64 s[58:59], 0, s[58:59]
v_mov_b32 v63, 159744
v_add_u32 v222, 16, v26
v_cndmask_b32 v222, v63, v222, s[58:59]
v_cndmask_b32 v26, v63, v26, s[56:57]
s_cmp_eq_u32 s39, 0
s_cselect_b64 s[56:57], 0, s[56:57]
s_cselect_b64 s[58:59], 0, s[58:59]
v_bfrev_b32 v63, 1
v_add_u32 v221, 64, v25
v_cndmask_b32 v221, v63, v221, s[58:59]
v_cndmask_b32 v25, v63, v25, s[56:57]
s_lshl_b32 s26, s20, 2
s_add_u32 s26, s26, 0
s_mul_hi_u32 s26, s26, 0xccccccd
s_lshr_b32 s31, s26, 1
s_add_u32 s31, s31, 1
s_lshl_b64 s[6:7], -1, s31
s_lshr_b64 s[40:41], -1, s31
s_bitcmp1_b32 s26, 0
s_cselect_b64 s[40:41], s[40:41], s[6:7]
s_lshl_b32 s26, s20, 2
s_add_u32 s26, s26, 16
s_mul_hi_u32 s26, s26, 0xccccccd
s_lshr_b32 s31, s26, 1
s_add_u32 s31, s31, 1
s_lshl_b64 s[6:7], -1, s31
s_lshr_b64 s[42:43], -1, s31
s_bitcmp1_b32 s26, 0
s_cselect_b64 s[42:43], s[42:43], s[6:7]
s_lshl_b32 s26, s20, 2
s_add_u32 s26, s26, 32
s_mul_hi_u32 s26, s26, 0xccccccd
s_lshr_b32 s31, s26, 1
s_add_u32 s31, s31, 1
s_lshl_b64 s[6:7], -1, s31
s_lshr_b64 s[44:45], -1, s31
s_bitcmp1_b32 s26, 0
s_cselect_b64 s[44:45], s[44:45], s[6:7]
s_lshl_b32 s26, s20, 2
s_add_u32 s26, s26, 48
s_mul_hi_u32 s26, s26, 0xccccccd
s_lshr_b32 s31, s26, 1
s_add_u32 s31, s31, 1
s_lshl_b64 s[6:7], -1, s31
s_lshr_b64 s[46:47], -1, s31
s_bitcmp1_b32 s26, 0
s_cselect_b64 s[46:47], s[46:47], s[6:7]
s_lshl_b32 s26, s20, 2
s_add_u32 s26, s26, 64
s_mul_hi_u32 s26, s26, 0xccccccd
s_lshr_b32 s31, s26, 1
s_add_u32 s31, s31, 1
s_lshl_b64 s[6:7], -1, s31
s_lshr_b64 s[48:49], -1, s31
s_bitcmp1_b32 s26, 0
s_cselect_b64 s[48:49], s[48:49], s[6:7]
v_lshrrev_b32 v236, 4, v1
v_and_b32 v237, 15, v1
v_lshlrev_b32 v238, 13, v236
v_lshl_add_u32 v238, v237, 4, v238
v_lshlrev_b32 v240, 7, v236
v_lshl_add_u32 v240, v237, 3, v240
v_lshrrev_b32 v236, 2, v1
v_and_b32 v237, 3, v1
v_lshlrev_b32 v239, 13, v236
v_lshl_add_u32 v239, v237, 4, v239
v_lshlrev_b32 v241, 5, v236
v_lshl_add_u32 v241, v237, 3, v241
s_add_u32 s26, s38, 32768
v_add_u32 v240, s26, v240
v_add_u32 v241, s26, v241
v_lshrrev_b32 v242, 4, v1
v_bfe_u32 v243, v1, 2, 2
v_lshl_add_u32 v242, v242, 2, v243
v_lshlrev_b32 v237, 3, v237
v_lshl_add_u32 v243, v242, 5, v237
v_lshl_add_u32 v242, v242, 7, v237
v_add_u32 v242, s26, v242
v_add_u32 v243, s26, v243
s_mul_i32 s26, s22, 655360
s_lshl_b32 s31, s21, 8
s_add_u32 s26, s26, s31
s_add_u32 s26, s26, 22020096
s_lshl_b32 s31, s20, 17
s_add_u32 s80, s26, s31
s_add_u32 s81, s80, 32768
s_add_u32 s82, s80, 65536
s_add_u32 s83, s80, 98304
s_lshl_b32 s31, s20, 6
s_add_u32 s84, s26, s31
s_add_u32 s84, s84, 524288
s_mul_i32 s26, s22, 5
s_lshr_b32 s26, s26, 2
s_lshl_b32 s31, s26, 2
v_and_b32 v234, 7, v1
v_add_u32 v234, s31, v234
v_add_u32 v235, 40, v234
v_cmp_le_u32 vcc, 8, v1
s_nop 1
v_cndmask_b32 v234, v234, v235, vcc
s_mul_i32 s31, s22, 12
s_add_u32 s31, s31, 56
v_min_u32 v235, 35, v1
v_add_u32 v235, s31, v235
v_cmp_le_u32 vcc, 24, v1
s_nop 1
v_cndmask_b32 v234, v234, v235, vcc
s_lshl_b32 s31, s26, 4
s_add_u32 s31, s31, 432
v_and_b32 v31, 31, v1
v_add_u32 v31, s31, v31
v_lshlrev_b32 v31, 7, v31
v_lshlrev_b32 v234, 7, v234
v_add_u32 v234, 32768, v234
s_lshl_b32 s26, s4, 5
s_lshr_b32 s31, s2, 6
s_lshl_b32 s31, s31, 3
s_add_u32 s26, s26, s31
s_sub_u32 s26, s26, 16
v_add_u32 v235, s26, v1
v_lshlrev_b32 v235, 7, v235
s_mov_b32 vcc_lo, 0x00ff0000
s_mov_b32 vcc_hi, 0
v_cndmask_b32 v234, v234, v235, vcc
v_and_b32 v54, 7, v1
v_lshlrev_b32 v54, 7, v54
v_bfe_u32 v55, v1, 3, 1
v_lshl_add_u32 v54, v55, 18, v54
s_lshl_b32 s26, s22, 10
s_add_u32 s26, s26, s28
v_add_u32 v54, s26, v54
v_mov_b32 v55, s27
v_cmp_gt_u32 s[6:7], 16, v1
s_nop 1
v_cndmask_b32 v54, v55, v54, s[6:7]
buffer_load_dword v54, v54, s[16:19], 0 offen sc1
s_add_u32 s26, s29, 0
buffer_load_dword v56, v25, s[16:19], s26 offen sc1
buffer_load_dword v56, v221, s[16:19], s26 offen sc1
s_add_u32 s26, s29, 163840
buffer_load_dword v56, v25, s[16:19], s26 offen sc1
buffer_load_dword v56, v221, s[16:19], s26 offen sc1
s_lshl_b32 s98, s90, 2
s_add_u32 s98, s98, s20
v_mov_b32 v40, s98
v_add_u32 v41, s78, v1
v_lshrrev_b32 v42, 2, v41
v_and_b32 v41, 3, v41
s_mov_b32 s98, 0x15555556
v_mul_hi_u32 v43, v40, s98
v_mul_u32_u24 v44, 12, v43
v_sub_u32 v45, v40, v44
v_and_b32 v44, 3, v45
v_lshrrev_b32 v46, 2, v45
v_sub_u32 v45, v41, v44
v_and_b32 v45, 3, v45
v_mad_u32_u24 v46, v45, 3, v46
v_mad_u32_u24 v46, v42, 12, v46
v_lshl_add_u32 v44, v43, 2, v44
v_mul_u32_u24 v44, 170, v44
v_add3_u32 v44, v44, v46, s77
v_lshlrev_b32 v44, 10, v44
v_add_u32 v44, 5242880, v44
s_lshl_b32 s85, s20, 5
s_add_u32 s85, s85, 0
v_add_u32 v47, s85, v34
s_lshl_b32 s85, s90, 8
s_lshl_b32 s86, s20, 6
s_add_u32 s85, s85, s86
s_add_u32 s85, s85, s79
v_lshlrev_b32 v45, 4, v33
v_bfrev_b32 v46, 1
v_and_b32 v43, 15, v1
v_cmp_eq_u32 vcc, 0, v43
s_cmp_lg_u32 s79, 0
s_cselect_b64 vcc, vcc, 0
v_cndmask_b32 v45, v46, v45, vcc
s_waitcnt vmcnt(9)
s_barrier
ds_read_b64_tr_b16 v[64:65], v47 offset:0
ds_read_b64_tr_b16 v[66:67], v47 offset:512
ds_read_b64_tr_b16 v[68:69], v47 offset:4096
ds_read_b64_tr_b16 v[70:71], v47 offset:4608
ds_read_b64_tr_b16 v[72:73], v47 offset:8192
ds_read_b64_tr_b16 v[74:75], v47 offset:8704
ds_read_b64_tr_b16 v[76:77], v47 offset:12288
ds_read_b64_tr_b16 v[78:79], v47 offset:12800
ds_read_b64_tr_b16 v[80:81], v47 offset:16384
ds_read_b64_tr_b16 v[82:83], v47 offset:16896
v_readlane_b32 s76, v44, 0
v_readlane_b32 s78, v44, 1
v_readlane_b32 s88, v44, 2
v_readlane_b32 s86, v44, 3
v_readlane_b32 s90, v44, 4
s_waitcnt lgkmcnt(8)
buffer_store_dwordx4 v[64:67], v2, s[16:19], s76 offen sc1
v_mfma_f32_16x16x32_bf16 v[48:51], v[64:67], v[36:39], 0
s_waitcnt lgkmcnt(6)
buffer_store_dwordx4 v[68:71], v2, s[16:19], s78 offen sc1
v_mfma_f32_16x16x32_bf16 v[48:51], v[68:71], v[36:39], v[48:51]
s_waitcnt lgkmcnt(4)
buffer_store_dwordx4 v[72:75], v2, s[16:19], s88 offen sc1
v_mfma_f32_16x16x32_bf16 v[48:51], v[72:75], v[36:39], v[48:51]
s_waitcnt lgkmcnt(2)
buffer_store_dwordx4 v[76:79], v2, s[16:19], s86 offen sc1
v_mfma_f32_16x16x32_bf16 v[48:51], v[76:79], v[36:39], v[48:51]
s_waitcnt lgkmcnt(0)
buffer_store_dwordx4 v[80:83], v2, s[16:19], s90 offen sc1
v_mfma_f32_16x16x32_bf16 v[48:51], v[80:83], v[36:39], v[48:51]
s_nop 7
buffer_store_dwordx4 v[48:51], v45, s[16:19], s85 offen sc1
s_lshl_b32 s98, s89, 7
v_lshl_add_u32 v62, v0, 2, s98
v_bfrev_b32 v63, 1
v_cmp_gt_u32 vcc, 32, v0
s_nop 1
v_cndmask_b32 v62, v63, v62, vcc
s_add_u32 s26, s75, 32
v_mov_b32 v63, s26
s_mov_b32 s98, 12025856
s_waitcnt vmcnt(0)
s_barrier
buffer_store_dword v63, v62, s[16:19], s98 offen sc1
s_mov_b32 s36, 0
s_add_u32 s26, s75, 32
s_mov_b32 s31, 11993088
wp_20:
buffer_load_dword v50, v234, s[16:19], s31 offen sc1
s_add_u32 s36, s36, 1
s_cmp_gt_u32 s36, 0x200000
s_cbranch_scc1 k2_bail
s_waitcnt vmcnt(0)
v_subrev_u32 v50, s26, v50
v_cmp_lt_u32 vcc, 15, v50
s_nop 0
s_and_b32 vcc_lo, vcc_lo, 0xffffff
s_cbranch_scc1 wp_20
v_cmp_ne_u32 vcc, s37, v50
s_nop 0
s_and_b32 vcc_lo, vcc_lo, 0x00ff0000
s_cselect_b32 s23, 1, 0
s_barrier
v_and_b32 v48, 15, v1
v_mul_u32_u24 v48, 160, v48
v_lshrrev_b32 v49, 4, v1
v_lshl_add_u32 v48, v49, 3, v48
s_lshl_b32 s26, s20, 5
s_add_u32 s26, s26, 65536
v_add_u32 v49, s26, v48
s_mul_i32 s26, s20, 2560
s_add_u32 s26, s26, 65664
v_add_u32 v48, s26, v48
ds_read_b64 v[224:225], v49 offset:0
ds_read_b64 v[226:227], v49 offset:2560
ds_read_b64 v[228:229], v49 offset:5120
ds_read_b64 v[230:231], v49 offset:7680
ds_read_b64 v[232:233], v48
s_waitcnt lgkmcnt(0)
v_lshlrev_b32 v104, 16, v224
v_and_b32 v105, s64, v224
v_lshlrev_b32 v106, 16, v225
v_and_b32 v107, s64, v225
v_lshlrev_b32 v108, 16, v226
v_and_b32 v109, s64, v226
v_lshlrev_b32 v110, 16, v227
v_and_b32 v111, s64, v227
v_lshlrev_b32 v112, 16, v228
v_and_b32 v113, s64, v228
v_lshlrev_b32 v114, 16, v229
v_and_b32 v115, s64, v229
v_lshlrev_b32 v116, 16, v230
v_and_b32 v117, s64, v230
v_lshlrev_b32 v118, 16, v231
v_and_b32 v119, s64, v231
v_lshlrev_b32 v120, 16, v232
v_and_b32 v121, s64, v232
v_lshlrev_b32 v122, 16, v233
v_and_b32 v123, s64, v233
v_pk_add_f32 v[152:153], v[104:105], v[106:107]
v_pk_mul_f32 v[154:155], v[104:105], v[104:105]
v_pk_add_f32 v[156:157], v[108:109], v[110:111]
v_pk_mul_f32 v[158:159], v[108:109], v[108:109]
v_pk_add_f32 v[160:161], v[112:113], v[114:115]
v_pk_mul_f32 v[162:163], v[112:113], v[112:113]
v_pk_add_f32 v[164:165], v[116:117], v[118:119]
v_pk_mul_f32 v[166:167], v[116:117], v[116:117]
v_pk_add_f32 v[168:169], v[120:121], v[122:123]
v_pk_mul_f32 v[170:171], v[120:121], v[120:121]
v_pk_fma_f32 v[154:155], v[106:107], v[106:107], v[154:155]
v_add_f32 v152, v152, v153
v_pk_fma_f32 v[158:159], v[110:111], v[110:111], v[158:159]
v_add_f32 v156, v156, v157
v_pk_fma_f32 v[162:163], v[114:115], v[114:115], v[162:163]
v_add_f32 v160, v160, v161
v_pk_fma_f32 v[166:167], v[118:119], v[118:119], v[166:167]
v_add_f32 v164, v164, v165
v_pk_fma_f32 v[170:171], v[122:123], v[122:123], v[170:171]
v_add_f32 v168, v168, v169
v_add_f32 v153, v154, v155
v_add_f32 v157, v158, v159
v_add_f32 v161, v162, v163
v_add_f32 v165, v166, v167
v_add_f32 v169, v170, v171
v_fmac_f32 v152, s60, v168
v_fmac_f32 v153, s60, v169
v_fmac_f32 v156, s61, v168
v_fmac_f32 v157, s61, v169
v_fmac_f32 v160, s62, v168
v_fmac_f32 v161, s62, v169
v_fmac_f32 v164, s63, v168
v_fmac_f32 v165, s63, v169
v_permlane32_swap_b32 v152, v160
v_permlane32_swap_b32 v156, v164
v_permlane32_swap_b32 v153, v161
v_permlane32_swap_b32 v157, v165
v_pk_add_f32 v[152:153], v[152:153], v[160:161]
v_pk_add_f32 v[156:157], v[156:157], v[164:165]
s_nop 1
v_permlane16_swap_b32 v152, v156
v_permlane16_swap_b32 v153, v157
v_pk_add_f32 v[152:153], v[152:153], v[156:157]
ds_write_b64 v20, v[152:153]
s_waitcnt lgkmcnt(0)
s_barrier
ds_read_b64 v[152:153], v19 offset:0
ds_read_b64 v[154:155], v19 offset:512
ds_read_b64 v[156:157], v19 offset:1024
ds_read_b64 v[158:159], v19 offset:1536
s_add_u32 s74, s28, 0
s_add_u32 s65, s75, 16
v_mov_b32 v161, s65
v_mov_b32 v163, s65
s_waitcnt lgkmcnt(0)
v_pk_add_f32 v[152:153], v[152:153], v[154:155]
v_pk_add_f32 v[156:157], v[156:157], v[158:159]
v_add_f32 v160, v152, v156
v_add_f32 v162, v153, v157
s_cmp_lg_u32 s23, 0
s_cbranch_scc1 slow_21
buffer_store_dwordx4 v[160:163], v220, s[16:19], s74 offen
back_22:
buffer_load_dwordx4 a[0:3], v2, s[16:19], s25 offen offset:0
buffer_load_dwordx4 a[4:7], v2, s[16:19], s25 offen offset:1024
buffer_load_dwordx4 a[8:11], v2, s[16:19], s25 offen offset:2048
buffer_load_dwordx4 a[12:15], v2, s[16:19], s25 offen offset:3072
s_add_u32 s25, s25, 4096
buffer_load_dwordx4 a[16:19], v2, s[16:19], s25 offen offset:0
buffer_load_dwordx4 a[20:23], v2, s[16:19], s25 offen offset:1024
buffer_load_dwordx4 a[24:27], v2, s[16:19], s25 offen offset:2048
buffer_load_dwordx4 a[28:31], v2, s[16:19], s25 offen offset:3072
s_add_u32 s25, s25, 4096
buffer_load_dwordx4 a[32:35], v2, s[16:19], s25 offen offset:0
buffer_load_dwordx4 a[36:39], v2, s[16:19], s25 offen offset:1024
buffer_load_dwordx4 a[40:43], v2, s[16:19], s25 offen offset:2048
buffer_load_dwordx4 a[44:47], v2, s[16:19], s25 offen offset:3072
s_add_u32 s25, s25, 4096
buffer_load_dwordx4 a[48:51], v2, s[16:19], s25 offen offset:0
buffer_load_dwordx4 a[52:55], v2, s[16:19], s25 offen offset:1024
buffer_load_dwordx4 a[56:59], v2, s[16:19], s25 offen offset:2048
buffer_load_dwordx4 a[60:63], v2, s[16:19], s25 offen offset:3072
s_add_u32 s25, s25, 4096
buffer_load_dwordx4 a[64:67], v2, s[16:19], s25 offen offset:0
buffer_load_dwordx4 a[68:71], v2, s[16:19], s25 offen offset:1024
buffer_load_dwordx4 a[72:75], v2, s[16:19], s25 offen offset:2048
buffer_load_dwordx4 a[76:79], v2, s[16:19], s25 offen offset:3072
s_add_u32 s25, s25, 4096
buffer_load_dwordx4 a[80:83], v2, s[16:19], s25 offen offset:0
buffer_load_dwordx4 a[84:87], v2, s[16:19], s25 offen offset:1024
buffer_load_dwordx4 a[88:91], v2, s[16:19], s25 offen offset:2048
buffer_load_dwordx4 a[92:95], v2, s[16:19], s25 offen offset:3072
s_add_u32 s25, s25, 4096
buffer_load_dwordx4 a[96:99], v2, s[16:19], s25 offen offset:0
s_sub_u32 s25, s25, 4096
s_mov_b32 s91, 11993088
joined_1:
s_add_u32 s92, s16, s25
s_addc_u32 s93, s17, 0
v_add_u32 v18, s28, v18
s_add_u32 s8, s16, 0x40000
s_addc_u32 s9, s17, 0
global_load_dwordx4 v[184:187], v18, s[16:17] offset:0 sc1
global_load_dwordx4 v[188:191], v18, s[16:17] offset:1024 sc1
buffer_load_dwordx4 v[152:155], v238, s[16:19], s80 offen sc1
buffer_load_dwordx4 v[156:159], v238, s[16:19], s81 offen sc1
buffer_load_dwordx4 v[160:163], v238, s[16:19], s82 offen sc1
buffer_load_dwordx4 v[164:167], v238, s[16:19], s83 offen sc1
buffer_load_dwordx4 v[168:171], v239, s[16:19], s84 offen sc1
s_mov_b64 s[12:13], s[96:97]
s_mov_b32 s14, 2621440
s_mov_b32 s15, 0x20000
s_lshl_b32 s26, s89, 7
v_lshl_add_u32 v58, v0, 2, s26
v_bfrev_b32 v59, 1
v_cmp_gt_u32 vcc, 32, v0
s_cmp_lt_u32 s4, 5
s_cselect_b64 vcc, vcc, 0
v_cndmask_b32 v58, v59, v58, vcc
s_add_u32 s26, s75, 32
v_mov_b32 v59, s26
s_mov_b32 s89, 12025856
s_mul_i32 s31, s20, 18432
s_add_u32 s31, s31, 81920
v_add_u32 v0, s31, v2
s_add_u32 s87, s75, 28
s_waitcnt vmcnt(5)
v_xor_b32 v192, v185, v187
v_xor_b32 v193, v189, v191
v_xor_b32 v194, s65, v185
v_xor_b32 v195, s65, v189
v_or3_b32 v192, v192, v193, v194
v_or_b32 v192, v192, v195
v_cmp_ne_u32 vcc, 0, v192
s_cbranch_vccnz retry_23
got_24:
v_add_f32 v184, v184, v188
v_add_f32 v185, v186, v190
v_mov_b32 v186, v184
v_mov_b32 v187, v185
s_nop 0
v_permlane32_swap_b32 v184, v186
v_permlane32_swap_b32 v185, v187
v_pk_add_f32 v[184:185], v[184:185], v[186:187]
v_mov_b32 v186, v184
v_mov_b32 v187, v185
s_nop 0
v_permlane16_swap_b32 v184, v186
v_permlane16_swap_b32 v185, v187
v_pk_add_f32 v[184:185], v[184:185], v[186:187]
v_mul_f32 v184, 0x3acccccd, v184
v_mul_f32 v185, 0x3acccccd, v185
v_fma_f32 v188, -v184, v184, v185
v_max_f32 v188, 0, v188
v_add_f32 v189, 0x3727c5ac, v188
v_rsq_f32 v185, v189
s_nop 0
ds_write_b64 v21, v[184:185]
s_waitcnt vmcnt(0)
v_xor_b32 v172, s87, v153
v_xor_b32 v173, s87, v155
v_xor_b32 v174, s87, v157
v_xor_b32 v175, s87, v159
v_xor_b32 v176, s87, v161
v_xor_b32 v177, s87, v163
v_xor_b32 v178, s87, v165
v_xor_b32 v179, s87, v167
v_xor_b32 v180, s87, v169
v_xor_b32 v181, s87, v171
v_or3_b32 v172, v172, v173, v174
v_or3_b32 v175, v175, v176, v177
v_or3_b32 v178, v178, v179, v180
v_or3_b32 v172, v172, v175, v178
v_or_b32 v172, v172, v181
v_cmp_ne_u32 vcc, 0, v172
s_cbranch_vccnz ypoll_25
ypoll_25d:
v_mov_b32 v153, v154
ds_write_b64 v240, v[152:153] offset:0
v_mov_b32 v157, v158
ds_write_b64 v240, v[156:157] offset:512
v_mov_b32 v161, v162
ds_write_b64 v240, v[160:161] offset:1024
v_mov_b32 v165, v166
ds_write_b64 v240, v[164:165] offset:1536
v_mov_b32 v169, v170
ds_write_b64 v241, v[168:169] offset:2048
ds_read_b64_tr_b16 v[32:33], v242 offset:0
ds_read_b64_tr_b16 v[34:35], v242 offset:32
ds_read_b64_tr_b16 v[36:37], v242 offset:64
ds_read_b64_tr_b16 v[38:39], v242 offset:96
ds_read_b64_tr_b16 v[40:41], v243 offset:2048
s_waitcnt lgkmcnt(10)
s_barrier
ds_read_b64 v[200:201], v22 offset:0
ds_read_b64 v[204:205], v22 offset:256
ds_read_b64 v[208:209], v22 offset:512
ds_read_b64 v[212:213], v22 offset:768
ds_read_b64 v[216:217], v21 offset:0
v_add_u32 v11, s24, v11
v_add_u32 v12, s24, v12
s_add_u32 s26, s24, 81920
v_add_u32 v13, s26, v13
v_add_u32 v16, s27, v16
s_add_u32 s26, s35, 81920
s_add_u32 s82, s16, s26
s_addc_u32 s83, s17, 0
s_add_u32 s84, s16, 0x10000
s_addc_u32 s85, s17, 0
s_add_u32 s10, s16, 0x20000
s_addc_u32 s11, s17, 0
s_waitcnt lgkmcnt(5)
v_lshlrev_b32 v64, 16, v32
v_and_b32 v65, s64, v32
v_lshlrev_b32 v66, 16, v33
v_and_b32 v67, s64, v33
v_lshlrev_b32 v68, 16, v34
v_and_b32 v69, s64, v34
v_lshlrev_b32 v70, 16, v35
v_and_b32 v71, s64, v35
v_lshlrev_b32 v72, 16, v36
v_and_b32 v73, s64, v36
v_lshlrev_b32 v74, 16, v37
v_and_b32 v75, s64, v37
v_lshlrev_b32 v76, 16, v38
v_and_b32 v77, s64, v38
v_lshlrev_b32 v78, 16, v39
v_and_b32 v79, s64, v39
v_lshlrev_b32 v80, 16, v40
v_and_b32 v81, s64, v40
v_lshlrev_b32 v82, 16, v41
v_and_b32 v83, s64, v41
s_waitcnt lgkmcnt(4)
v_pk_add_f32 v[192:193], v[104:105], v[200:201] op_sel_hi:[1,0] neg_lo:[0,1] neg_hi:[0,1]
v_pk_add_f32 v[194:195], v[106:107], v[200:201] op_sel_hi:[1,0] neg_lo:[0,1] neg_hi:[0,1]
v_pk_mul_f32 v[192:193], v[192:193], v[200:201] op_sel:[0,1] op_sel_hi:[1,1]
v_pk_mul_f32 v[194:195], v[194:195], v[200:201] op_sel:[0,1] op_sel_hi:[1,1]
v_pk_fma_f32 v[104:105], v[192:193], v[64:65], v[104:105]
v_pk_fma_f32 v[106:107], v[194:195], v[66:67], v[106:107]
v_cvt_pk_bf16_f32 v42, v104, v105
v_cvt_pk_bf16_f32 v43, v106, v107
s_cmp_lg_u32 s23, 0
s_cbranch_scc1 slow_26
global_store_dwordx2 v11, v[42:43], s[16:17] offset:0
back_27:
s_waitcnt lgkmcnt(3)
v_pk_add_f32 v[192:193], v[108:109], v[204:205] op_sel_hi:[1,0] neg_lo:[0,1] neg_hi:[0,1]
v_pk_add_f32 v[194:195], v[110:111], v[204:205] op_sel_hi:[1,0] neg_lo:[0,1] neg_hi:[0,1]
v_pk_mul_f32 v[192:193], v[192:193], v[204:205] op_sel:[0,1] op_sel_hi:[1,1]
v_pk_mul_f32 v[194:195], v[194:195], v[204:205] op_sel:[0,1] op_sel_hi:[1,1]
v_pk_fma_f32 v[108:109], v[192:193], v[68:69], v[108:109]
v_pk_fma_f32 v[110:111], v[194:195], v[70:71], v[110:111]
v_cvt_pk_bf16_f32 v44, v108, v109
v_cvt_pk_bf16_f32 v45, v110, v111
s_cbranch_scc1 slow_28
global_store_dwordx2 v11, v[44:45], s[16:17] offset:256
back_29:
s_waitcnt lgkmcnt(2)
v_pk_add_f32 v[192:193], v[112:113], v[208:209] op_sel_hi:[1,0] neg_lo:[0,1] neg_hi:[0,1]
v_pk_add_f32 v[194:195], v[114:115], v[208:209] op_sel_hi:[1,0] neg_lo:[0,1] neg_hi:[0,1]
v_pk_mul_f32 v[192:193], v[192:193], v[208:209] op_sel:[0,1] op_sel_hi:[1,1]
v_pk_mul_f32 v[194:195], v[194:195], v[208:209] op_sel:[0,1] op_sel_hi:[1,1]
v_pk_fma_f32 v[112:113], v[192:193], v[72:73], v[112:113]
v_pk_fma_f32 v[114:115], v[194:195], v[74:75], v[114:115]
v_cvt_pk_bf16_f32 v46, v112, v113
v_cvt_pk_bf16_f32 v47, v114, v115
s_cbranch_scc1 slow_30
global_store_dwordx2 v11, v[46:47], s[16:17] offset:512
back_31:
s_waitcnt lgkmcnt(1)
v_pk_add_f32 v[192:193], v[116:117], v[212:213] op_sel_hi:[1,0] neg_lo:[0,1] neg_hi:[0,1]
v_pk_add_f32 v[194:195], v[118:119], v[212:213] op_sel_hi:[1,0] neg_lo:[0,1] neg_hi:[0,1]
v_pk_mul_f32 v[192:193], v[192:193], v[212:213] op_sel:[0,1] op_sel_hi:[1,1]
v_pk_mul_f32 v[194:195], v[194:195], v[212:213] op_sel:[0,1] op_sel_hi:[1,1]
v_pk_fma_f32 v[116:117], v[192:193], v[76:77], v[116:117]
v_pk_fma_f32 v[118:119], v[194:195], v[78:79], v[118:119]
v_cvt_pk_bf16_f32 v48, v116, v117
v_cvt_pk_bf16_f32 v49, v118, v119
s_cbranch_scc1 slow_32
global_store_dwordx2 v11, v[48:49], s[16:17] offset:768
back_33:
s_waitcnt lgkmcnt(0)
v_pk_add_f32 v[192:193], v[120:121], v[216:217] op_sel_hi:[1,0] neg_lo:[0,1] neg_hi:[0,1]
v_pk_add_f32 v[194:195], v[122:123], v[216:217] op_sel_hi:[1,0] neg_lo:[0,1] neg_hi:[0,1]
v_pk_mul_f32 v[192:193], v[192:193], v[216:217] op_sel:[0,1] op_sel_hi:[1,1]
v_pk_mul_f32 v[194:195], v[194:195], v[216:217] op_sel:[0,1] op_sel_hi:[1,1]
v_pk_fma_f32 v[120:121], v[192:193], v[80:81], v[120:121]
v_pk_fma_f32 v[122:123], v[194:195], v[82:83], v[122:123]
v_cvt_pk_bf16_f32 v50, v120, v121
v_cvt_pk_bf16_f32 v51, v122, v123
s_cbranch_scc1 slow_34
global_store_dwordx2 v12, v[50:51], s[16:17] offset:0
back_35:
v_pk_add_f32 v[152:153], v[104:105], v[106:107]
v_pk_mul_f32 v[154:155], v[104:105], v[104:105]
v_pk_add_f32 v[156:157], v[108:109], v[110:111]
v_pk_mul_f32 v[158:159], v[108:109], v[108:109]
v_pk_add_f32 v[160:161], v[112:113], v[114:115]
v_pk_mul_f32 v[162:163], v[112:113], v[112:113]
v_pk_add_f32 v[164:165], v[116:117], v[118:119]
v_pk_mul_f32 v[166:167], v[116:117], v[116:117]
v_pk_add_f32 v[168:169], v[120:121], v[122:123]
v_pk_mul_f32 v[170:171], v[120:121], v[120:121]
v_pk_fma_f32 v[154:155], v[106:107], v[106:107], v[154:155]
v_add_f32 v152, v152, v153
v_pk_fma_f32 v[158:159], v[110:111], v[110:111], v[158:159]
v_add_f32 v156, v156, v157
v_pk_fma_f32 v[162:163], v[114:115], v[114:115], v[162:163]
v_add_f32 v160, v160, v161
v_pk_fma_f32 v[166:167], v[118:119], v[118:119], v[166:167]
v_add_f32 v164, v164, v165
v_pk_fma_f32 v[170:171], v[122:123], v[122:123], v[170:171]
v_add_f32 v168, v168, v169
v_add_f32 v153, v154, v155
v_add_f32 v157, v158, v159
v_add_f32 v161, v162, v163
v_add_f32 v165, v166, v167
v_add_f32 v169, v170, v171
v_fmac_f32 v152, s60, v168
v_fmac_f32 v153, s60, v169
v_fmac_f32 v156, s61, v168
v_fmac_f32 v157, s61, v169
v_fmac_f32 v160, s62, v168
v_fmac_f32 v161, s62, v169
v_fmac_f32 v164, s63, v168
v_fmac_f32 v165, s63, v169
v_permlane32_swap_b32 v152, v160
v_permlane32_swap_b32 v156, v164
v_permlane32_swap_b32 v153, v161
v_permlane32_swap_b32 v157, v165
v_pk_add_f32 v[152:153], v[152:153], v[160:161]
v_pk_add_f32 v[156:157], v[156:157], v[164:165]
s_nop 1
v_permlane16_swap_b32 v152, v156
v_permlane16_swap_b32 v153, v157
v_pk_add_f32 v[152:153], v[152:153], v[156:157]
ds_write_b64 v20, v[152:153]
s_waitcnt lgkmcnt(0)
s_barrier
ds_read_b64 v[184:185], v19 offset:0
ds_read_b64 v[186:187], v19 offset:512
ds_read_b64 v[188:189], v19 offset:1024
ds_read_b64 v[190:191], v19 offset:1536
s_add_u32 s74, s28, 262144
s_add_u32 s65, s75, 17
v_mov_b32 v193, s65
v_mov_b32 v195, s65
s_waitcnt lgkmcnt(0)
v_pk_add_f32 v[184:185], v[184:185], v[186:187]
v_pk_add_f32 v[188:189], v[188:189], v[190:191]
v_add_f32 v192, v184, v188
v_add_f32 v194, v185, v189
s_cmp_lg_u32 s23, 0
s_cbranch_scc1 slow_36
buffer_store_dwordx4 v[192:195], v220, s[16:19], s74 offen
back_37:
v_lshrrev_b32 v60, 4, v1
v_lshlrev_b32 v60, 4, v60
s_mul_i32 s26, s22, 320
s_lshl_b32 s31, s20, 6
s_add_u32 s94, s26, 10813696
s_add_u32 s95, s26, s31
s_add_u32 s95, s95, 10813440
buffer_load_dwordx4 v[84:87], v60, s[16:19], s95 offen sc1
buffer_load_dwordx4 v[88:91], v60, s[16:19], s94 offen sc1
s_add_u32 s94, s94, 2560
s_add_u32 s95, s95, 2560
buffer_load_dwordx4 v[136:139], v60, s[16:19], s95 offen sc1
buffer_load_dwordx4 v[140:143], v60, s[16:19], s94 offen sc1
s_add_u32 s94, s94, 2560
s_add_u32 s95, s95, 2560
buffer_load_dwordx4 v[144:147], v60, s[16:19], s95 offen sc1
buffer_load_dwordx4 v[148:151], v60, s[16:19], s94 offen sc1
s_add_u32 s94, s94, 2560
s_add_u32 s95, s95, 2560
buffer_load_dwordx4 v[64:67], v60, s[16:19], s95 offen sc1
buffer_load_dwordx4 v[68:71], v60, s[16:19], s94 offen sc1
s_add_u32 s26, s75, 1
v_mov_b32 v63, s26
s_waitcnt vmcnt(9) lgkmcnt(0)
s_barrier
s_cmp_lg_u32 s23, 0
s_cbranch_scc1 slow_38
buffer_store_dword v63, v17, s[16:19], s27 offen
back_39:
s_cmp_ge_u32 s4, 5
s_cbranch_scc1 have_40
ds_read_b64_tr_b16 v[152:153], v246 offset:0
ds_read_b64_tr_b16 v[154:155], v246 offset:512
ds_read_b64_tr_b16 v[156:157], v246 offset:4096
ds_read_b64_tr_b16 v[158:159], v246 offset:4608
ds_read_b64_tr_b16 v[160:161], v246 offset:8192
ds_read_b64_tr_b16 v[162:163], v246 offset:8704
v_readlane_b32 s76, v245, 0
v_readlane_b32 s77, v245, 1
v_readlane_b32 s78, v245, 2
s_waitcnt lgkmcnt(4)
s_nop 1
buffer_store_dwordx4 v[152:155], v2, s[16:19], s76 offen sc1
s_waitcnt lgkmcnt(2)
buffer_store_dwordx4 v[156:159], v2, s[16:19], s77 offen sc1
s_waitcnt lgkmcnt(0)
buffer_store_dwordx4 v[160:163], v2, s[16:19], s78 offen sc1
global_load_dwordx4 a[84:87], v2, s[92:93] offset:1024
global_load_dwordx4 a[88:91], v2, s[92:93] offset:2048
global_load_dwordx4 a[92:95], v2, s[92:93] offset:3072
s_add_u32 s92, s92, 4096
s_addc_u32 s93, s93, 0
global_load_dwordx4 a[96:99], v2, s[92:93] offset:0
s_branch have_40b
have_40:
s_add_u32 s92, s92, 4096
s_addc_u32 s93, s93, 0
have_40b:
s_add_u32 s73, s38, 0
s_add_u32 s73, s73, s24
s_add_u32 s90, s16, s73
s_addc_u32 s91, s17, 0
s_mov_b32 m0, s38
s_mov_b32 s36, 0
s_add_u32 s26, s75, 1
poll_41:
global_load_dword v63, v16, s[16:17] sc1
global_load_dwordx4 v[184:187], v18, s[8:9] offset:0 sc1
global_load_dwordx4 v[188:191], v18, s[8:9] offset:1024 sc1
s_add_u32 s36, s36, 1
s_cmp_gt_u32 s36, 0x200000
s_cbranch_scc1 k2_bail
s_waitcnt vmcnt(2)
v_subrev_u32 v63, s26, v63
v_cmp_lt_u32 vcc, 15, v63
s_cbranch_vccnz poll_41
global_load_lds_dwordx4 v2, s[90:91] offset:0 sc1
global_load_lds_dwordx4 v2, s[90:91] offset:1024 sc1
global_load_lds_dwordx4 v2, s[90:91] offset:2048 sc1
global_load_lds_dwordx4 v2, s[90:91] offset:3072 sc1
s_waitcnt vmcnt(4)
v_xor_b32 v192, v185, v187
v_xor_b32 v193, v189, v191
v_xor_b32 v194, s65, v185
v_xor_b32 v195, s65, v189
v_or3_b32 v192, v192, v193, v194
v_or_b32 v192, v192, v195
s_add_u32 s90, s90, 16384
s_addc_u32 s91, s91, 0
s_add_u32 m0, m0, 16384
s_nop 0
global_load_lds_dwordx4 v2, s[90:91] offset:0 sc1
v_cmp_ne_u32 vcc, 0, v192
s_cbranch_vccnz retry_42
got_43:
v_add_f32 v184, v184, v188
v_add_f32 v185, v186, v190
v_mov_b32 v186, v184
v_mov_b32 v187, v185
s_nop 0
v_permlane32_swap_b32 v184, v186
global_load_lds_dwordx4 v2, s[90:91] offset:1024 sc1
v_permlane32_swap_b32 v185, v187
v_pk_add_f32 v[184:185], v[184:185], v[186:187]
v_mov_b32 v186, v184
v_mov_b32 v187, v185
s_nop 0
v_permlane16_swap_b32 v184, v186
v_permlane16_swap_b32 v185, v187
v_pk_add_f32 v[184:185], v[184:185], v[186:187]
global_load_lds_dwordx4 v2, s[90:91] offset:2048 sc1
v_mul_f32 v184, 0x3acccccd, v184
v_mul_f32 v185, 0x3acccccd, v185
v_fma_f32 v188, -v184, v184, v185
v_max_f32 v188, 0, v188
v_add_f32 v189, 0x3727c5ac, v188
v_rsq_f32 v190, v189
v_fmamk_f32 v189, v189, 0x3727c5ac, v188
global_load_lds_dwordx4 v2, s[90:91] offset:3072 sc1
ds_write_b32 v21, v190 offset:1024
v_rsq_f32 v188, v189
s_nop 0
v_mul_f32 v185, v189, v188
v_mul_f32 v186, 0xc0135761, v188
v_mul_f32 v187, 0xbdd2d3e8, v188
v_mul_f32 v188, v188, v188
v_mul_f32 v187, v187, v188
ds_write_b128 v21, v[184:187]
s_waitcnt vmcnt(4) lgkmcnt(0)
s_barrier
buffer_store_dword v59, v58, s[16:19], s89 offen sc1
ds_read_b128 v[152:155], v3 offset:0
ds_read_b128 v[156:159], v3 offset:256
ds_read_b128 v[160:163], v3 offset:512
ds_read_b128 v[164:167], v3 offset:768
ds_read_b128 v[168:171], v4 offset:0
ds_read_b128 v[172:175], v4 offset:256
ds_read_b128 v[176:179], v4 offset:512
ds_read_b128 v[180:183], v4 offset:768
s_waitcnt lgkmcnt(4)
v_mfma_f32_16x16x32_bf16 v[104:107], a[0:3], v[152:155], 0
ds_read_b128 v[184:187], v5 offset:0
v_mfma_f32_16x16x32_bf16 v[108:111], a[0:3], v[156:159], 0
ds_read_b128 v[188:191], v5 offset:256
s_add_u32 s90, s90, 16384
s_addc_u32 s91, s91, 0
s_add_u32 m0, m0, 16384
s_nop 0
global_load_lds_dwordx4 v2, s[90:91] offset:0 sc1
v_mfma_f32_16x16x32_bf16 v[112:115], a[0:3], v[160:163], 0
ds_read_b128 v[192:195], v5 offset:512
v_mfma_f32_16x16x32_bf16 v[116:119], a[0:3], v[164:167], 0
ds_read_b128 v[196:199], v5 offset:768
global_load_lds_dwordx4 v2, s[90:91] offset:1024 sc1
v_mfma_f32_16x16x32_bf16 v[120:123], a[4:7], v[152:155], 0
v_mfma_f32_16x16x32_bf16 v[124:127], a[4:7], v[156:159], 0
v_mfma_f32_16x16x32_bf16 v[128:131], a[4:7], v[160:163], 0
v_mfma_f32_16x16x32_bf16 v[132:135], a[4:7], v[164:167], 0
s_waitcnt lgkmcnt(4)
v_mfma_f32_16x16x32_bf16 v[104:107], a[8:11], v[168:171], v[104:107]
ds_read_b128 v[152:155], v6 offset:0
v_mfma_f32_16x16x32_bf16 v[108:111], a[8:11], v[172:175], v[108:111]
ds_read_b128 v[156:159], v6 offset:256
global_load_lds_dwordx4 v2, s[90:91] offset:2048 sc1
v_mfma_f32_16x16x32_bf16 v[112:115], a[8:11], v[176:179], v[112:115]
ds_read_b128 v[160:163], v6 offset:512
v_mfma_f32_16x16x32_bf16 v[116:119], a[8:11], v[180:183], v[116:119]
ds_read_b128 v[164:167], v6 offset:768
global_load_lds_dwordx4 v2, s[90:91] offset:3072 sc1
s_waitcnt vmcnt(5)
s_barrier
s_waitcnt lgkmcnt(4)
v_mfma_f32_16x16x32_bf16 v[104:107], a[12:15], v[184:187], v[104:107]
ds_read_b128 v[168:171], v3 offset:16384
v_mfma_f32_16x16x32_bf16 v[108:111], a[12:15], v[188:191], v[108:111]
ds_read_b128 v[172:175], v3 offset:16640
s_add_u32 s90, s90, 16384
s_addc_u32 s91, s91, 0
s_add_u32 m0, m0, 16384
s_nop 0
global_load_lds_dwordx4 v2, s[90:91] offset:0 sc1
v_mfma_f32_16x16x32_bf16 v[112:115], a[12:15], v[192:195], v[112:115]
ds_read_b128 v[176:179], v3 offset:16896
v_mfma_f32_16x16x32_bf16 v[116:119], a[12:15], v[196:199], v[116:119]
ds_read_b128 v[180:183], v3 offset:17152
global_load_lds_dwordx4 v2, s[90:91] offset:1024 sc1
s_waitcnt lgkmcnt(4)
v_mfma_f32_16x16x32_bf16 v[104:107], a[16:19], v[152:155], v[104:107]
ds_read_b128 v[184:187], v4 offset:16384
v_mfma_f32_16x16x32_bf16 v[108:111], a[16:19], v[156:159], v[108:111]
ds_read_b128 v[188:191], v4 offset:16640
global_load_lds_dwordx4 v2, s[90:91] offset:2048 sc1
v_mfma_f32_16x16x32_bf16 v[112:115], a[16:19], v[160:163], v[112:115]
ds_read_b128 v[192:195], v4 offset:16896
v_mfma_f32_16x16x32_bf16 v[116:119], a[16:19], v[164:167], v[116:119]
ds_read_b128 v[196:199], v4 offset:17152
global_load_lds_dwordx4 v2, s[90:91] offset:3072 sc1
s_waitcnt lgkmcnt(4)
v_mfma_f32_16x16x32_bf16 v[104:107], a[20:23], v[168:171], v[104:107]
ds_read_b128 v[152:155], v5 offset:16384
v_mfma_f32_16x16x32_bf16 v[108:111], a[20:23], v[172:175], v[108:111]
ds_read_b128 v[156:159], v5 offset:16640
s_add_u32 s90, s90, 16384
s_addc_u32 s91, s91, 0
s_add_u32 m0, m0, 16384
s_nop 0
global_load_lds_dwordx4 v2, s[90:91] offset:0 sc1
v_mfma_f32_16x16x32_bf16 v[112:115], a[20:23], v[176:179], v[112:115]
ds_read_b128 v[160:163], v5 offset:16896
v_mfma_f32_16x16x32_bf16 v[116:119], a[20:23], v[180:183], v[116:119]
ds_read_b128 v[164:167], v5 offset:17152
global_load_lds_dwordx4 v2, s[90:91] offset:1024 sc1
v_mfma_f32_16x16x32_bf16 v[120:123], a[24:27], v[168:171], v[120:123]
v_mfma_f32_16x16x32_bf16 v[124:127], a[24:27], v[172:175], v[124:127]
v_mfma_f32_16x16x32_bf16 v[128:131], a[24:27], v[176:179], v[128:131]
v_mfma_f32_16x16x32_bf16 v[132:135], a[24:27], v[180:183], v[132:135]
s_waitcnt lgkmcnt(4)
v_mfma_f32_16x16x32_bf16 v[104:107], a[28:31], v[184:187], v[104:107]
ds_read_b128 v[168:171], v6 offset:16384
v_mfma_f32_16x16x32_bf16 v[108:111], a[28:31], v[188:191], v[108:111]
ds_read_b128 v[172:175], v6 offset:16640
global_load_lds_dwordx4 v2, s[90:91] offset:2048 sc1
v_mfma_f32_16x16x32_bf16 v[112:115], a[28:31], v[192:195], v[112:115]
ds_read_b128 v[176:179], v6 offset:16896
v_mfma_f32_16x16x32_bf16 v[116:119], a[28:31], v[196:199], v[116:119]
ds_read_b128 v[180:183], v6 offset:17152
global_load_lds_dwordx4 v2, s[90:91] offset:3072 sc1
s_waitcnt vmcnt(8)
s_barrier
s_waitcnt lgkmcnt(4)
v_mfma_f32_16x16x32_bf16 v[104:107], a[32:35], v[152:155], v[104:107]
ds_read_b128 v[184:187], v3 offset:32768
v_mfma_f32_16x16x32_bf16 v[108:111], a[32:35], v[156:159], v[108:111]
ds_read_b128 v[188:191], v3 offset:33024
v_mfma_f32_16x16x32_bf16 v[112:115], a[32:35], v[160:163], v[112:115]
ds_read_b128 v[192:195], v3 offset:33280
v_mfma_f32_16x16x32_bf16 v[116:119], a[32:35], v[164:167], v[116:119]
ds_read_b128 v[196:199], v3 offset:33536
s_waitcnt lgkmcnt(4)
v_mfma_f32_16x16x32_bf16 v[104:107], a[36:39], v[168:171], v[104:107]
ds_read_b128 v[152:155], v4 offset:32768
v_mfma_f32_16x16x32_bf16 v[108:111], a[36:39], v[172:175], v[108:111]
ds_read_b128 v[156:159], v4 offset:33024
v_mfma_f32_16x16x32_bf16 v[112:115], a[36:39], v[176:179], v[112:115]
ds_read_b128 v[160:163], v4 offset:33280
v_mfma_f32_16x16x32_bf16 v[116:119], a[36:39], v[180:183], v[116:119]
ds_read_b128 v[164:167], v4 offset:33536
s_waitcnt lgkmcnt(4)
v_mfma_f32_16x16x32_bf16 v[104:107], a[40:43], v[184:187], v[104:107]
ds_read_b128 v[168:171], v5 offset:32768
global_load_dwordx4 a[100:103], v2, s[92:93] offset:1024
v_mfma_f32_16x16x32_bf16 v[108:111], a[40:43], v[188:191], v[108:111]
ds_read_b128 v[172:175], v5 offset:33024
v_mfma_f32_16x16x32_bf16 v[112:115], a[40:43], v[192:195], v[112:115]
ds_read_b128 v[176:179], v5 offset:33280
v_mfma_f32_16x16x32_bf16 v[116:119], a[40:43], v[196:199], v[116:119]
ds_read_b128 v[180:183], v5 offset:33536
v_mfma_f32_16x16x32_bf16 v[120:123], a[44:47], v[184:187], v[120:123]
v_mfma_f32_16x16x32_bf16 v[124:127], a[44:47], v[188:191], v[124:127]
v_mfma_f32_16x16x32_bf16 v[128:131], a[44:47], v[192:195], v[128:131]
v_mfma_f32_16x16x32_bf16 v[132:135], a[44:47], v[196:199], v[132:135]
s_waitcnt lgkmcnt(4)
v_mfma_f32_16x16x32_bf16 v[104:107], a[48:51], v[152:155], v[104:107]
ds_read_b128 v[184:187], v6 offset:32768
global_load_dwordx4 a[104:107], v2, s[92:93] offset:2048
v_mfma_f32_16x16x32_bf16 v[108:111], a[48:51], v[156:159], v[108:111]
ds_read_b128 v[188:191], v6 offset:33024
v_mfma_f32_16x16x32_bf16 v[112:115], a[48:51], v[160:163], v[112:115]
ds_read_b128 v[192:195], v6 offset:33280
v_mfma_f32_16x16x32_bf16 v[116:119], a[48:51], v[164:167], v[116:119]
ds_read_b128 v[196:199], v6 offset:33536
s_waitcnt vmcnt(6)
s_barrier
s_waitcnt lgkmcnt(4)
v_mfma_f32_16x16x32_bf16 v[104:107], a[52:55], v[168:171], v[104:107]
ds_read_b128 v[152:155], v3 offset:49152
global_load_dwordx4 a[108:111], v2, s[92:93] offset:3072
v_mfma_f32_16x16x32_bf16 v[108:111], a[52:55], v[172:175], v[108:111]
ds_read_b128 v[156:159], v3 offset:49408
v_mfma_f32_16x16x32_bf16 v[112:115], a[52:55], v[176:179], v[112:115]
ds_read_b128 v[160:163], v3 offset:49664
v_mfma_f32_16x16x32_bf16 v[116:119], a[52:55], v[180:183], v[116:119]
ds_read_b128 v[164:167], v3 offset:49920
s_waitcnt lgkmcnt(4)
v_mfma_f32_16x16x32_bf16 v[104:107], a[56:59], v[184:187], v[104:107]
ds_read_b128 v[168:171], v4 offset:49152
s_add_u32 s92, s92, 4096
s_addc_u32 s93, s93, 0
s_mul_i32 s3, s20, 18432
s_add_u32 m0, s3, 81920
s_nop 0
global_load_lds_dwordx4 v2, s[92:93] offset:0
v_mfma_f32_16x16x32_bf16 v[108:111], a[56:59], v[188:191], v[108:111]
ds_read_b128 v[172:175], v4 offset:49408
s_mul_i32 s3, s20, 18432
s_add_u32 m0, s3, 81920
s_nop 0
global_load_lds_dwordx4 v2, s[92:93] offset:1024
v_mfma_f32_16x16x32_bf16 v[112:115], a[56:59], v[192:195], v[112:115]
ds_read_b128 v[176:179], v4 offset:49664
v_mfma_f32_16x16x32_bf16 v[116:119], a[56:59], v[196:199], v[116:119]
ds_read_b128 v[180:183], v4 offset:49920
s_waitcnt lgkmcnt(4)
v_mfma_f32_16x16x32_bf16 v[104:107], a[60:63], v[152:155], v[104:107]
ds_read_b128 v[184:187], v5 offset:49152
s_mul_i32 s26, s22, 10240
v_mfma_f32_16x16x32_bf16 v[108:111], a[60:63], v[156:159], v[108:111]
ds_read_b128 v[188:191], v5 offset:49408
s_mul_i32 s31, s20, 2560
v_mfma_f32_16x16x32_bf16 v[112:115], a[60:63], v[160:163], v[112:115]
ds_read_b128 v[192:195], v5 offset:49664
s_add_u32 s26, s26, s31
v_mfma_f32_16x16x32_bf16 v[116:119], a[60:63], v[164:167], v[116:119]
ds_read_b128 v[196:199], v5 offset:49920
s_add_u32 s26, s26, s24
v_mfma_f32_16x16x32_bf16 v[120:123], a[64:67], v[152:155], v[120:123]
s_add_u32 s26, s26, 81920
v_mfma_f32_16x16x32_bf16 v[124:127], a[64:67], v[156:159], v[124:127]
buffer_load_dword v62, v30, s[16:19], s26 offen sc1
v_mfma_f32_16x16x32_bf16 v[128:131], a[64:67], v[160:163], v[128:131]
s_mul_i32 s3, s20, 18432
s_add_u32 m0, s3, 81920
s_nop 0
global_load_lds_dwordx4 v2, s[92:93] offset:2048
v_mfma_f32_16x16x32_bf16 v[132:135], a[64:67], v[164:167], v[132:135]
s_waitcnt lgkmcnt(4)
v_mfma_f32_16x16x32_bf16 v[104:107], a[68:71], v[168:171], v[104:107]
ds_read_b128 v[152:155], v6 offset:49152
global_load_dwordx4 a[112:115], v2, s[92:93] offset:3072
v_mfma_f32_16x16x32_bf16 v[108:111], a[68:71], v[172:175], v[108:111]
ds_read_b128 v[156:159], v6 offset:49408
v_mfma_f32_16x16x32_bf16 v[112:115], a[68:71], v[176:179], v[112:115]
ds_read_b128 v[160:163], v6 offset:49664
v_mfma_f32_16x16x32_bf16 v[116:119], a[68:71], v[180:183], v[116:119]
ds_read_b128 v[164:167], v6 offset:49920
s_waitcnt vmcnt(8)
s_barrier
s_waitcnt lgkmcnt(4)
v_mfma_f32_16x16x32_bf16 v[104:107], a[72:75], v[184:187], v[104:107]
ds_read_b128 v[168:171], v7 offset:0
s_add_u32 s92, s92, 4096
s_addc_u32 s93, s93, 0
s_mul_i32 s3, s20, 18432
s_add_u32 m0, s3, 84992
s_nop 0
global_load_lds_dwordx4 v2, s[92:93] offset:0
v_mfma_f32_16x16x32_bf16 v[108:111], a[72:75], v[188:191], v[108:111]
ds_read_b128 v[172:175], v7 offset:256
v_mfma_f32_16x16x32_bf16 v[112:115], a[72:75], v[192:195], v[112:115]
ds_read_b128 v[176:179], v7 offset:512
v_mfma_f32_16x16x32_bf16 v[116:119], a[72:75], v[196:199], v[116:119]
ds_read_b128 v[180:183], v7 offset:768
s_waitcnt lgkmcnt(4)
v_mfma_f32_16x16x32_bf16 v[104:107], a[76:79], v[152:155], v[104:107]
ds_read_b128 v[184:187], v8 offset:0
s_mul_i32 s3, s20, 18432
s_add_u32 m0, s3, 84992
s_nop 0
global_load_lds_dwordx4 v2, s[92:93] offset:1024
v_mfma_f32_16x16x32_bf16 v[108:111], a[76:79], v[156:159], v[108:111]
ds_read_b128 v[188:191], v8 offset:256
s_mul_i32 s3, s20, 18432
s_add_u32 m0, s3, 84992
s_nop 0
global_load_lds_dwordx4 v2, s[92:93] offset:2048
v_mfma_f32_16x16x32_bf16 v[112:115], a[76:79], v[160:163], v[112:115]
ds_read_b128 v[192:195], v8 offset:512
v_mfma_f32_16x16x32_bf16 v[116:119], a[76:79], v[164:167], v[116:119]
ds_read_b128 v[196:199], v8 offset:768
s_waitcnt lgkmcnt(4)
v_mfma_f32_16x16x32_bf16 v[104:107], a[80:83], v[168:171], v[104:107]
ds_read_b128 v[152:155], v9 offset:0
ds_read_b128 v[200:203], v22 offset:0
v_mfma_f32_16x16x32_bf16 v[108:111], a[80:83], v[172:175], v[108:111]
ds_read_b128 v[156:159], v9 offset:256
ds_read_b128 v[204:207], v22 offset:256
v_mfma_f32_16x16x32_bf16 v[112:115], a[80:83], v[176:179], v[112:115]
ds_read_b128 v[160:163], v9 offset:512
ds_read_b128 v[208:211], v22 offset:512
v_mfma_f32_16x16x32_bf16 v[116:119], a[80:83], v[180:183], v[116:119]
ds_read_b128 v[164:167], v9 offset:768
ds_read_b128 v[212:215], v22 offset:768
v_mfma_f32_16x16x32_bf16 v[120:123], a[84:87], v[168:171], v[120:123]
ds_read_b128 v[216:219], v21 offset:0
v_mfma_f32_16x16x32_bf16 v[124:127], a[84:87], v[172:175], v[124:127]
s_mul_i32 s3, s20, 18432
s_add_u32 m0, s3, 84992
s_nop 0
global_load_lds_dwordx4 v2, s[92:93] offset:3072
v_mfma_f32_16x16x32_bf16 v[128:131], a[84:87], v[176:179], v[128:131]
v_mfma_f32_16x16x32_bf16 v[132:135], a[84:87], v[180:183], v[132:135]
s_waitcnt lgkmcnt(9)
v_mfma_f32_16x16x32_bf16 v[104:107], a[88:91], v[184:187], v[104:107]
ds_read_b128 v[168:171], v10 offset:0
s_add_u32 s92, s92, 4096
s_addc_u32 s93, s93, 0
global_load_dwordx4 a[116:119], v2, s[92:93] offset:0
v_mfma_f32_16x16x32_bf16 v[108:111], a[88:91], v[188:191], v[108:111]
ds_read_b128 v[172:175], v10 offset:256
v_mfma_f32_16x16x32_bf16 v[112:115], a[88:91], v[192:195], v[112:115]
ds_read_b128 v[176:179], v10 offset:512
v_mfma_f32_16x16x32_bf16 v[116:119], a[88:91], v[196:199], v[116:119]
ds_read_b128 v[180:183], v10 offset:768
s_waitcnt lgkmcnt(6)
v_mfma_f32_16x16x32_bf16 v[104:107], a[92:95], v[152:155], v[104:107]
ds_write_b128 v23, v[120:123] offset:0
ds_write_b128 v23, v[124:127] offset:1024
v_mfma_f32_16x16x32_bf16 v[108:111], a[92:95], v[156:159], v[108:111]
ds_write_b128 v23, v[128:131] offset:2048
ds_write_b128 v23, v[132:135] offset:3072
v_mfma_f32_16x16x32_bf16 v[112:115], a[92:95], v[160:163], v[112:115]
s_mul_i32 s3, s20, 18432
s_add_u32 m0, s3, 88064
s_nop 0
global_load_lds_dwordx4 v2, s[92:93] offset:1024
v_mfma_f32_16x16x32_bf16 v[116:119], a[92:95], v[164:167], v[116:119]
s_waitcnt lgkmcnt(4)
v_mfma_f32_16x16x32_bf16 v[104:107], a[96:99], v[168:171], v[104:107]
s_mul_i32 s3, s20, 18432
s_add_u32 m0, s3, 88064
s_nop 0
global_load_lds_dwordx4 v2, s[92:93] offset:2048
v_mfma_f32_16x16x32_bf16 v[108:111], a[96:99], v[172:175], v[108:111]
s_mul_i32 s3, s20, 18432
s_add_u32 m0, s3, 88064
s_nop 0
global_load_lds_dwordx4 v2, s[92:93] offset:3072
v_mfma_f32_16x16x32_bf16 v[112:115], a[96:99], v[176:179], v[112:115]
v_mfma_f32_16x16x32_bf16 v[116:119], a[96:99], v[180:183], v[116:119]
s_waitcnt lgkmcnt(0)
s_barrier
ds_read_b128 v[152:155], v24 offset:0
ds_read_b128 v[156:159], v24 offset:4096
ds_read_b128 v[160:163], v24 offset:8192
ds_read_b128 v[164:167], v24 offset:12288
v_pk_add_f32 v[84:85], v[84:85], v[136:137]
v_pk_add_f32 v[86:87], v[86:87], v[138:139]
v_pk_add_f32 v[88:89], v[88:89], v[140:141]
v_pk_add_f32 v[90:91], v[90:91], v[142:143]
v_pk_add_f32 v[84:85], v[84:85], v[144:145]
v_pk_add_f32 v[86:87], v[86:87], v[146:147]
v_pk_add_f32 v[88:89], v[88:89], v[148:149]
v_pk_add_f32 v[90:91], v[90:91], v[150:151]
v_pk_add_f32 v[84:85], v[84:85], v[64:65]
v_pk_add_f32 v[86:87], v[86:87], v[66:67]
v_pk_add_f32 v[88:89], v[88:89], v[68:69]
v_pk_add_f32 v[90:91], v[90:91], v[70:71]
s_add_u32 s92, s92, 4096
s_addc_u32 s93, s93, 0
s_mul_i32 s3, s20, 18432
s_add_u32 m0, s3, 92160
s_nop 0
global_load_lds_dwordx4 v2, s[92:93] offset:0
global_load_dwordx4 a[120:123], v2, s[92:93] offset:1024
s_mul_i32 s3, s20, 18432
s_add_u32 m0, s3, 91136
s_nop 0
global_load_lds_dwordx4 v2, s[92:93] offset:2048
s_add_u32 s26, s24, s35
s_add_u32 s26, s26, 81920
s_add_u32 s31, s30, 0
s_add_u32 s65, s75, 24
v_pk_fma_f32 v[104:105], v[84:85], v[200:201], v[104:105] op_sel_hi:[1,0,1] neg_lo:[0,1,0] neg_hi:[0,1,0]
v_pk_fma_f32 v[106:107], v[86:87], v[200:201], v[106:107] op_sel_hi:[1,0,1] neg_lo:[0,1,0] neg_hi:[0,1,0]
v_pk_mul_f32 v[188:189], v[104:105], v[104:105]
v_pk_mul_f32 v[190:191], v[106:107], v[106:107]
v_pk_fma_f32 v[188:189], v[188:189], v[202:203], v[202:203] op_sel:[0,1,0] op_sel_hi:[1,1,0]
v_pk_fma_f32 v[190:191], v[190:191], v[202:203], v[202:203] op_sel:[0,1,0] op_sel_hi:[1,1,0]
v_pk_mul_f32 v[188:189], v[188:189], v[104:105]
v_pk_mul_f32 v[190:191], v[190:191], v[106:107]
v_exp_f32 v188, v188
v_exp_f32 v189, v189
v_exp_f32 v190, v190
v_exp_f32 v191, v191
v_pk_fma_f32 v[188:189], v[188:189], v[200:201], v[200:201] op_sel:[0,1,1] op_sel_hi:[1,1,1]
v_pk_fma_f32 v[190:191], v[190:191], v[200:201], v[200:201] op_sel:[0,1,1] op_sel_hi:[1,1,1]
v_rcp_f32 v188, v188
v_rcp_f32 v189, v189
v_rcp_f32 v190, v190
v_rcp_f32 v191, v191
v_pk_mul_f32 v[104:105], v[104:105], v[188:189]
v_pk_mul_f32 v[106:107], v[106:107], v[190:191]
v_cvt_pk_bf16_f32 v136, v104, v105
v_cvt_pk_bf16_f32 v137, v106, v107
s_mov_b64 exec, s[50:51]
s_cmp_lg_u32 s23, 0
s_cbranch_scc1 slow_44
global_store_dwordx2 v11, v[136:137], s[82:83] offset:0
back_45:
s_mov_b64 exec, -1
v_pk_fma_f32 v[116:117], v[84:85], v[212:213], v[116:117] op_sel_hi:[1,0,1] neg_lo:[0,1,0] neg_hi:[0,1,0]
v_pk_fma_f32 v[118:119], v[86:87], v[212:213], v[118:119] op_sel_hi:[1,0,1] neg_lo:[0,1,0] neg_hi:[0,1,0]
v_pk_mul_f32 v[188:189], v[116:117], v[116:117]
v_pk_mul_f32 v[190:191], v[118:119], v[118:119]
v_pk_fma_f32 v[188:189], v[188:189], v[214:215], v[214:215] op_sel:[0,1,0] op_sel_hi:[1,1,0]
v_pk_fma_f32 v[190:191], v[190:191], v[214:215], v[214:215] op_sel:[0,1,0] op_sel_hi:[1,1,0]
v_pk_mul_f32 v[188:189], v[188:189], v[116:117]
v_pk_mul_f32 v[190:191], v[190:191], v[118:119]
v_exp_f32 v188, v188
v_exp_f32 v189, v189
v_exp_f32 v190, v190
v_exp_f32 v191, v191
v_pk_fma_f32 v[188:189], v[188:189], v[212:213], v[212:213] op_sel:[0,1,1] op_sel_hi:[1,1,1]
v_pk_fma_f32 v[190:191], v[190:191], v[212:213], v[212:213] op_sel:[0,1,1] op_sel_hi:[1,1,1]
v_rcp_f32 v188, v188
v_rcp_f32 v189, v189
v_rcp_f32 v190, v190
v_rcp_f32 v191, v191
v_pk_mul_f32 v[116:117], v[116:117], v[188:189]
v_pk_mul_f32 v[118:119], v[118:119], v[190:191]
v_cvt_pk_bf16_f32 v142, v116, v117
v_cvt_pk_bf16_f32 v143, v118, v119
v_cndmask_b32 v192, v142, v136, s[66:67]
v_mov_b32 v193, s65
v_cndmask_b32 v194, v143, v137, s[66:67]
v_mov_b32 v195, s65
buffer_store_dwordx4 v[192:195], v27, s[16:19], s31 offen sc1
s_mov_b64 exec, s[52:53]
s_cbranch_scc1 slow_46
global_store_dwordx2 v11, v[142:143], s[82:83] offset:768
back_47:
s_mov_b64 exec, -1
s_waitcnt lgkmcnt(0)
v_pk_add_f32 v[152:153], v[152:153], v[156:157]
v_pk_add_f32 v[160:161], v[160:161], v[164:165]
v_pk_add_f32 v[154:155], v[154:155], v[158:159]
v_pk_add_f32 v[162:163], v[162:163], v[166:167]
v_pk_add_f32 v[120:121], v[152:153], v[160:161]
v_pk_add_f32 v[122:123], v[154:155], v[162:163]
v_pk_fma_f32 v[120:121], v[88:89], v[216:217], v[120:121] op_sel_hi:[1,0,1] neg_lo:[0,1,0] neg_hi:[0,1,0]
v_pk_fma_f32 v[122:123], v[90:91], v[216:217], v[122:123] op_sel_hi:[1,0,1] neg_lo:[0,1,0] neg_hi:[0,1,0]
v_pk_mul_f32 v[188:189], v[120:121], v[120:121]
v_pk_mul_f32 v[190:191], v[122:123], v[122:123]
v_pk_fma_f32 v[188:189], v[188:189], v[218:219], v[218:219] op_sel:[0,1,0] op_sel_hi:[1,1,0]
v_pk_fma_f32 v[190:191], v[190:191], v[218:219], v[218:219] op_sel:[0,1,0] op_sel_hi:[1,1,0]
v_pk_mul_f32 v[188:189], v[188:189], v[120:121]
v_pk_mul_f32 v[190:191], v[190:191], v[122:123]
v_exp_f32 v188, v188
v_exp_f32 v189, v189
v_exp_f32 v190, v190
v_exp_f32 v191, v191
v_pk_fma_f32 v[188:189], v[188:189], v[216:217], v[216:217] op_sel:[0,1,1] op_sel_hi:[1,1,1]
v_pk_fma_f32 v[190:191], v[190:191], v[216:217], v[216:217] op_sel:[0,1,1] op_sel_hi:[1,1,1]
v_rcp_f32 v188, v188
v_rcp_f32 v189, v189
v_rcp_f32 v190, v190
v_rcp_f32 v191, v191
v_pk_mul_f32 v[120:121], v[120:121], v[188:189]
v_pk_mul_f32 v[122:123], v[122:123], v[190:191]
v_cvt_pk_bf16_f32 v144, v120, v121
v_cvt_pk_bf16_f32 v145, v122, v123
v_mov_b32 v196, v144
v_mov_b32 v197, s65
v_mov_b32 v198, v145
v_mov_b32 v199, s65
buffer_store_dwordx4 v[196:199], v28, s[16:19], s31 offen sc1
s_mov_b64 exec, s[54:55]
s_cbranch_scc1 slow_48
global_store_dwordx2 v12, v[144:145], s[82:83] offset:0
back_49:
s_mov_b64 exec, -1
v_pk_fma_f32 v[108:109], v[84:85], v[204:205], v[108:109] op_sel_hi:[1,0,1] neg_lo:[0,1,0] neg_hi:[0,1,0]
v_pk_fma_f32 v[110:111], v[86:87], v[204:205], v[110:111] op_sel_hi:[1,0,1] neg_lo:[0,1,0] neg_hi:[0,1,0]
v_pk_mul_f32 v[188:189], v[108:109], v[108:109]
v_pk_mul_f32 v[190:191], v[110:111], v[110:111]
v_pk_fma_f32 v[188:189], v[188:189], v[206:207], v[206:207] op_sel:[0,1,0] op_sel_hi:[1,1,0]
v_pk_fma_f32 v[190:191], v[190:191], v[206:207], v[206:207] op_sel:[0,1,0] op_sel_hi:[1,1,0]
v_pk_mul_f32 v[188:189], v[188:189], v[108:109]
v_pk_mul_f32 v[190:191], v[190:191], v[110:111]
v_exp_f32 v188, v188
v_exp_f32 v189, v189
v_exp_f32 v190, v190
v_exp_f32 v191, v191
v_pk_fma_f32 v[188:189], v[188:189], v[204:205], v[204:205] op_sel:[0,1,1] op_sel_hi:[1,1,1]
v_pk_fma_f32 v[190:191], v[190:191], v[204:205], v[204:205] op_sel:[0,1,1] op_sel_hi:[1,1,1]
v_rcp_f32 v188, v188
v_rcp_f32 v189, v189
v_rcp_f32 v190, v190
v_rcp_f32 v191, v191
v_pk_mul_f32 v[108:109], v[108:109], v[188:189]
v_pk_mul_f32 v[110:111], v[110:111], v[190:191]
v_cvt_pk_bf16_f32 v138, v108, v109
v_cvt_pk_bf16_f32 v139, v110, v111
s_cbranch_scc1 slow_50
global_store_dwordx2 v11, v[138:139], s[82:83] offset:256
back_51:
v_pk_fma_f32 v[112:113], v[84:85], v[208:209], v[112:113] op_sel_hi:[1,0,1] neg_lo:[0,1,0] neg_hi:[0,1,0]
v_pk_fma_f32 v[114:115], v[86:87], v[208:209], v[114:115] op_sel_hi:[1,0,1] neg_lo:[0,1,0] neg_hi:[0,1,0]
v_pk_mul_f32 v[188:189], v[112:113], v[112:113]
v_pk_mul_f32 v[190:191], v[114:115], v[114:115]
v_pk_fma_f32 v[188:189], v[188:189], v[210:211], v[210:211] op_sel:[0,1,0] op_sel_hi:[1,1,0]
v_pk_fma_f32 v[190:191], v[190:191], v[210:211], v[210:211] op_sel:[0,1,0] op_sel_hi:[1,1,0]
v_pk_mul_f32 v[188:189], v[188:189], v[112:113]
v_pk_mul_f32 v[190:191], v[190:191], v[114:115]
v_exp_f32 v188, v188
v_exp_f32 v189, v189
v_exp_f32 v190, v190
v_exp_f32 v191, v191
v_pk_fma_f32 v[188:189], v[188:189], v[208:209], v[208:209] op_sel:[0,1,1] op_sel_hi:[1,1,1]
v_pk_fma_f32 v[190:191], v[190:191], v[208:209], v[208:209] op_sel:[0,1,1] op_sel_hi:[1,1,1]
v_rcp_f32 v188, v188
v_rcp_f32 v189, v189
v_rcp_f32 v190, v190
v_rcp_f32 v191, v191
v_pk_mul_f32 v[112:113], v[112:113], v[188:189]
v_pk_mul_f32 v[114:115], v[114:115], v[190:191]
v_cvt_pk_bf16_f32 v140, v112, v113
v_cvt_pk_bf16_f32 v141, v114, v115
s_cbranch_scc1 slow_52
global_store_dwordx2 v11, v[140:141], s[82:83] offset:512
back_53:
s_mov_b32 s95, 11993088
s_add_u32 s94, s75, 32
buffer_load_dword v60, v31, s[16:19], s95 offen sc1
buffer_load_dword v61, v234, s[16:19], s95 offen sc1
ds_read_b32 v201, v22 offset:1024
ds_read_b32 v205, v22 offset:1280
ds_read_b32 v209, v22 offset:1536
ds_read_b32 v213, v22 offset:1792
ds_read_b32 v217, v21 offset:1024
v_lshlrev_b32 v64, 16, v42
v_and_b32 v65, s64, v42
v_lshlrev_b32 v66, 16, v43
v_and_b32 v67, s64, v43
v_lshlrev_b32 v68, 16, v44
v_and_b32 v69, s64, v44
v_lshlrev_b32 v70, 16, v45
v_and_b32 v71, s64, v45
v_lshlrev_b32 v72, 16, v46
v_and_b32 v73, s64, v46
v_lshlrev_b32 v74, 16, v47
v_and_b32 v75, s64, v47
v_lshlrev_b32 v76, 16, v48
v_and_b32 v77, s64, v48
v_lshlrev_b32 v78, 16, v49
v_and_b32 v79, s64, v49
v_lshlrev_b32 v80, 16, v50
v_and_b32 v81, s64, v50
v_lshlrev_b32 v82, 16, v51
v_and_b32 v83, s64, v51
s_waitcnt lgkmcnt(4)
v_pk_add_f32 v[64:65], v[64:65], v[200:201] op_sel_hi:[1,0] neg_lo:[0,1] neg_hi:[0,1]
v_pk_add_f32 v[66:67], v[66:67], v[200:201] op_sel_hi:[1,0] neg_lo:[0,1] neg_hi:[0,1]
v_pk_mul_f32 v[64:65], v[64:65], v[200:201] op_sel:[0,1] op_sel_hi:[1,1]
v_pk_mul_f32 v[66:67], v[66:67], v[200:201] op_sel:[0,1] op_sel_hi:[1,1]
s_waitcnt lgkmcnt(3)
v_pk_add_f32 v[68:69], v[68:69], v[204:205] op_sel_hi:[1,0] neg_lo:[0,1] neg_hi:[0,1]
v_pk_add_f32 v[70:71], v[70:71], v[204:205] op_sel_hi:[1,0] neg_lo:[0,1] neg_hi:[0,1]
v_pk_mul_f32 v[68:69], v[68:69], v[204:205] op_sel:[0,1] op_sel_hi:[1,1]
v_pk_mul_f32 v[70:71], v[70:71], v[204:205] op_sel:[0,1] op_sel_hi:[1,1]
s_waitcnt lgkmcnt(2)
v_pk_add_f32 v[72:73], v[72:73], v[208:209] op_sel_hi:[1,0] neg_lo:[0,1] neg_hi:[0,1]
v_pk_add_f32 v[74:75], v[74:75], v[208:209] op_sel_hi:[1,0] neg_lo:[0,1] neg_hi:[0,1]
v_pk_mul_f32 v[72:73], v[72:73], v[208:209] op_sel:[0,1] op_sel_hi:[1,1]
v_pk_mul_f32 v[74:75], v[74:75], v[208:209] op_sel:[0,1] op_sel_hi:[1,1]
s_waitcnt lgkmcnt(1)
v_pk_add_f32 v[76:77], v[76:77], v[212:213] op_sel_hi:[1,0] neg_lo:[0,1] neg_hi:[0,1]
v_pk_add_f32 v[78:79], v[78:79], v[212:213] op_sel_hi:[1,0] neg_lo:[0,1] neg_hi:[0,1]
v_pk_mul_f32 v[76:77], v[76:77], v[212:213] op_sel:[0,1] op_sel_hi:[1,1]
v_pk_mul_f32 v[78:79], v[78:79], v[212:213] op_sel:[0,1] op_sel_hi:[1,1]
s_waitcnt lgkmcnt(0)
v_pk_add_f32 v[80:81], v[80:81], v[216:217] op_sel_hi:[1,0] neg_lo:[0,1] neg_hi:[0,1]
v_pk_add_f32 v[82:83], v[82:83], v[216:217] op_sel_hi:[1,0] neg_lo:[0,1] neg_hi:[0,1]
v_pk_mul_f32 v[80:81], v[80:81], v[216:217] op_sel:[0,1] op_sel_hi:[1,1]
v_pk_mul_f32 v[82:83], v[82:83], v[216:217] op_sel:[0,1] op_sel_hi:[1,1]
s_add_u32 s26, s75, 2
v_mov_b32 v63, s26
s_waitcnt vmcnt(2) lgkmcnt(0)
s_barrier
s_cmp_lg_u32 s23, 0
s_cbranch_scc1 slow_54
buffer_store_dword v63, v17, s[16:19], s27 offen
back_55:
s_add_u32 s72, s29, 0
s_add_u32 s73, s38, 81920
s_add_u32 s73, s73, s24
s_add_u32 s90, s16, s73
s_addc_u32 s91, s17, 0
s_mov_b32 m0, s38
s_mov_b32 s36, 0
s_add_u32 s26, s75, 2
poll_56:
global_load_dword v63, v16, s[16:17] sc1
buffer_load_dwordx4 v[184:187], v25, s[16:19], s72 offen sc1
buffer_load_dwordx4 v[188:191], v221, s[16:19], s72 offen sc1
s_add_u32 s36, s36, 1
s_cmp_gt_u32 s36, 0x200000
s_cbranch_scc1 k2_bail
s_waitcnt vmcnt(2)
v_subrev_u32 v63, s26, v63
v_cmp_lt_u32 vcc, 15, v63
s_cbranch_vccnz poll_56
s_mov_b64 exec, s[40:41]
global_load_lds_dwordx4 v2, s[90:91] offset:0 sc1
global_load_lds_dwordx4 v2, s[90:91] offset:1024 sc1
global_load_lds_dwordx4 v2, s[90:91] offset:2048 sc1
global_load_lds_dwordx4 v2, s[90:91] offset:3072 sc1
s_mov_b64 exec, -1
s_waitcnt vmcnt(4)
v_xor_b32 v192, v185, v187
v_xor_b32 v193, s65, v185
v_or_b32 v192, v192, v193
s_add_u32 s90, s90, 16384
s_addc_u32 s91, s91, 0
s_add_u32 m0, m0, 16384
s_mov_b64 exec, s[42:43]
global_load_lds_dwordx4 v2, s[90:91] offset:0 sc1
s_mov_b64 exec, -1
v_xor_b32 v193, v189, v191
v_xor_b32 v194, s65, v189
v_or_b32 v193, v193, v194
v_cmp_ne_u32 vcc, 0, v192
s_mov_b64 exec, s[42:43]
global_load_lds_dwordx4 v2, s[90:91] offset:1024 sc1
s_mov_b64 exec, -1
v_cmp_ne_u32 s[98:99], 0, v193
s_and_b64 vcc, vcc, s[56:57]
s_and_b64 s[98:99], s[98:99], s[58:59]
s_or_b64 vcc, vcc, s[98:99]
s_mov_b64 exec, s[42:43]
global_load_lds_dwordx4 v2, s[90:91] offset:2048 sc1
s_mov_b64 exec, -1
s_cbranch_vccnz hretry_57
hgot_58:
v_mov_b32 v185, v186
v_mov_b32 v189, v190
ds_write_b64 v26, v[184:185]
s_mov_b64 exec, s[42:43]
global_load_lds_dwordx4 v2, s[90:91] offset:3072 sc1
s_mov_b64 exec, -1
ds_write_b64 v222, v[188:189]
v_subrev_u32 v60, s94, v60
v_subrev_u32 v61, s94, v61
v_or_b32 v60, v60, v61
v_cmp_lt_u32 vcc, 15, v60
s_cbranch_vccnz wlate_59
wok_60:
s_waitcnt vmcnt(4) lgkmcnt(0)
s_barrier
ds_read_b128 v[152:155], v3 offset:0
ds_read_b128 v[156:159], v3 offset:256
ds_read_b128 v[160:163], v3 offset:512
ds_read_b128 v[164:167], v3 offset:768
ds_read_b128 v[168:171], v4 offset:0
ds_read_b128 v[172:175], v4 offset:256
ds_read_b128 v[176:179], v4 offset:512
ds_read_b128 v[180:183], v4 offset:768
s_waitcnt lgkmcnt(4)
v_mfma_f32_16x16x32_bf16 v[104:107], a[100:103], v[152:155], v[64:67]
ds_read_b128 v[144:147], v0 offset:0
v_mfma_f32_16x16x32_bf16 v[108:111], a[100:103], v[156:159], v[68:71]
ds_read_b128 v[184:187], v5 offset:0
s_add_u32 s90, s90, 16384
s_addc_u32 s91, s91, 0
s_add_u32 m0, m0, 16384
s_mov_b64 exec, s[44:45]
global_load_lds_dwordx4 v2, s[90:91] offset:0 sc1
s_mov_b64 exec, -1
v_mfma_f32_16x16x32_bf16 v[112:115], a[100:103], v[160:163], v[72:75]
ds_read_b128 v[188:191], v5 offset:256
v_mfma_f32_16x16x32_bf16 v[116:119], a[100:103], v[164:167], v[76:79]
ds_read_b128 v[192:195], v5 offset:512
s_mov_b64 exec, s[44:45]
global_load_lds_dwordx4 v2, s[90:91] offset:1024 sc1
s_mov_b64 exec, -1
v_mfma_f32_16x16x32_bf16 v[120:123], a[104:107], v[152:155], 0
ds_read_b128 v[196:199], v5 offset:768
v_mfma_f32_16x16x32_bf16 v[124:127], a[104:107], v[156:159], 0
v_mfma_f32_16x16x32_bf16 v[128:131], a[104:107], v[160:163], 0
v_mfma_f32_16x16x32_bf16 v[132:135], a[104:107], v[164:167], 0
s_waitcnt lgkmcnt(5)
v_mfma_f32_16x16x32_bf16 v[104:107], a[108:111], v[168:171], v[104:107]
ds_read_b128 v[136:139], v0 offset:1024
ds_read_b128 v[152:155], v6 offset:0
v_mfma_f32_16x16x32_bf16 v[108:111], a[108:111], v[172:175], v[108:111]
ds_read_b128 v[156:159], v6 offset:256
s_mov_b64 exec, s[44:45]
global_load_lds_dwordx4 v2, s[90:91] offset:2048 sc1
s_mov_b64 exec, -1
v_mfma_f32_16x16x32_bf16 v[112:115], a[108:111], v[176:179], v[112:115]
ds_read_b128 v[160:163], v6 offset:512
v_mfma_f32_16x16x32_bf16 v[116:119], a[108:111], v[180:183], v[116:119]
ds_read_b128 v[164:167], v6 offset:768
s_mov_b64 exec, s[44:45]
global_load_lds_dwordx4 v2, s[90:91] offset:3072 sc1
s_mov_b64 exec, -1
s_waitcnt vmcnt(4)
s_barrier
s_waitcnt lgkmcnt(5)
v_mfma_f32_16x16x32_bf16 v[104:107], v[144:147], v[184:187], v[104:107]
ds_read_b128 v[140:143], v0 offset:2048
ds_read_b128 v[168:171], v3 offset:16384
v_mfma_f32_16x16x32_bf16 v[108:111], v[144:147], v[188:191], v[108:111]
ds_read_b128 v[172:175], v3 offset:16640
s_add_u32 s90, s90, 16384
s_addc_u32 s91, s91, 0
s_add_u32 m0, m0, 16384
s_mov_b64 exec, s[46:47]
global_load_lds_dwordx4 v2, s[90:91] offset:0 sc1
s_mov_b64 exec, -1
v_mfma_f32_16x16x32_bf16 v[112:115], v[144:147], v[192:195], v[112:115]
ds_read_b128 v[176:179], v3 offset:16896
v_mfma_f32_16x16x32_bf16 v[116:119], v[144:147], v[196:199], v[116:119]
ds_read_b128 v[180:183], v3 offset:17152
s_mov_b64 exec, s[46:47]
global_load_lds_dwordx4 v2, s[90:91] offset:1024 sc1
s_mov_b64 exec, -1
s_waitcnt lgkmcnt(5)
v_mfma_f32_16x16x32_bf16 v[104:107], v[136:139], v[152:155], v[104:107]
ds_read_b128 v[144:147], v0 offset:3072
ds_read_b128 v[184:187], v4 offset:16384
v_mfma_f32_16x16x32_bf16 v[108:111], v[136:139], v[156:159], v[108:111]
ds_read_b128 v[188:191], v4 offset:16640
s_mov_b64 exec, s[46:47]
global_load_lds_dwordx4 v2, s[90:91] offset:2048 sc1
s_mov_b64 exec, -1
v_mfma_f32_16x16x32_bf16 v[112:115], v[136:139], v[160:163], v[112:115]
ds_read_b128 v[192:195], v4 offset:16896
v_mfma_f32_16x16x32_bf16 v[116:119], v[136:139], v[164:167], v[116:119]
ds_read_b128 v[196:199], v4 offset:17152
s_mov_b64 exec, s[46:47]
global_load_lds_dwordx4 v2, s[90:91] offset:3072 sc1
s_mov_b64 exec, -1
s_waitcnt lgkmcnt(5)
v_mfma_f32_16x16x32_bf16 v[104:107], v[140:143], v[168:171], v[104:107]
ds_read_b128 v[136:139], v0 offset:4096
v_mfma_f32_16x16x32_bf16 v[108:111], v[140:143], v[172:175], v[108:111]
ds_read_b128 v[152:155], v5 offset:16384
s_add_u32 s90, s90, 16384
s_addc_u32 s91, s91, 0
s_add_u32 m0, m0, 16384
s_mov_b64 exec, s[48:49]
global_load_lds_dwordx4 v2, s[90:91] offset:0 sc1
s_mov_b64 exec, -1
v_mfma_f32_16x16x32_bf16 v[112:115], v[140:143], v[176:179], v[112:115]
ds_read_b128 v[156:159], v5 offset:16640
v_mfma_f32_16x16x32_bf16 v[116:119], v[140:143], v[180:183], v[116:119]
ds_read_b128 v[160:163], v5 offset:16896
s_mov_b64 exec, s[48:49]
global_load_lds_dwordx4 v2, s[90:91] offset:1024 sc1
s_mov_b64 exec, -1
v_mfma_f32_16x16x32_bf16 v[120:123], a[112:115], v[168:171], v[120:123]
ds_read_b128 v[164:167], v5 offset:17152
v_mfma_f32_16x16x32_bf16 v[124:127], a[112:115], v[172:175], v[124:127]
v_mfma_f32_16x16x32_bf16 v[128:131], a[112:115], v[176:179], v[128:131]
v_mfma_f32_16x16x32_bf16 v[132:135], a[112:115], v[180:183], v[132:135]
s_waitcnt lgkmcnt(5)
v_mfma_f32_16x16x32_bf16 v[104:107], v[144:147], v[184:187], v[104:107]
ds_read_b128 v[140:143], v0 offset:5120
ds_read_b128 v[168:171], v6 offset:16384
v_mfma_f32_16x16x32_bf16 v[108:111], v[144:147], v[188:191], v[108:111]
ds_read_b128 v[172:175], v6 offset:16640
s_mov_b64 exec, s[48:49]
global_load_lds_dwordx4 v2, s[90:91] offset:2048 sc1
s_mov_b64 exec, -1
v_mfma_f32_16x16x32_bf16 v[112:115], v[144:147], v[192:195], v[112:115]
ds_read_b128 v[176:179], v6 offset:16896
v_mfma_f32_16x16x32_bf16 v[116:119], v[144:147], v[196:199], v[116:119]
ds_read_b128 v[180:183], v6 offset:17152
s_mov_b64 exec, s[48:49]
global_load_lds_dwordx4 v2, s[90:91] offset:3072 sc1
s_mov_b64 exec, -1
s_waitcnt vmcnt(8)
s_barrier
s_waitcnt lgkmcnt(5)
v_mfma_f32_16x16x32_bf16 v[104:107], v[136:139], v[152:155], v[104:107]
ds_read_b128 v[144:147], v0 offset:6144
ds_read_b128 v[184:187], v3 offset:32768
s_mul_i32 s3, s20, 18432
s_add_u32 m0, s3, 91136
s_nop 0
global_load_lds_dwordx4 v2, s[92:93] offset:3072
v_mfma_f32_16x16x32_bf16 v[108:111], v[136:139], v[156:159], v[108:111]
ds_read_b128 v[188:191], v3 offset:33024
s_add_u32 s92, s92, 4096
s_addc_u32 s93, s93, 0
s_mul_i32 s3, s20, 18432
s_add_u32 m0, s3, 95232
s_nop 0
global_load_lds_dwordx4 v2, s[92:93] offset:0
v_mfma_f32_16x16x32_bf16 v[112:115], v[136:139], v[160:163], v[112:115]
ds_read_b128 v[192:195], v3 offset:33280
v_mfma_f32_16x16x32_bf16 v[116:119], v[136:139], v[164:167], v[116:119]
ds_read_b128 v[196:199], v3 offset:33536
s_waitcnt lgkmcnt(5)
v_mfma_f32_16x16x32_bf16 v[104:107], v[140:143], v[168:171], v[104:107]
ds_read_b128 v[136:139], v0 offset:7168
ds_read_b128 v[152:155], v4 offset:32768
s_mul_i32 s3, s20, 18432
s_add_u32 m0, s3, 95232
s_nop 0
global_load_lds_dwordx4 v2, s[92:93] offset:1024
v_mfma_f32_16x16x32_bf16 v[108:111], v[140:143], v[172:175], v[108:111]
ds_read_b128 v[156:159], v4 offset:33024
v_mfma_f32_16x16x32_bf16 v[112:115], v[140:143], v[176:179], v[112:115]
ds_read_b128 v[160:163], v4 offset:33280
v_mfma_f32_16x16x32_bf16 v[116:119], v[140:143], v[180:183], v[116:119]
ds_read_b128 v[164:167], v4 offset:33536
s_waitcnt lgkmcnt(5)
v_mfma_f32_16x16x32_bf16 v[104:107], v[144:147], v[184:187], v[104:107]
ds_read_b128 v[140:143], v0 offset:8192
global_load_dwordx4 a[124:127], v2, s[92:93] offset:2048
v_mfma_f32_16x16x32_bf16 v[108:111], v[144:147], v[188:191], v[108:111]
ds_read_b128 v[168:171], v5 offset:32768
s_mul_i32 s3, s20, 18432
s_add_u32 m0, s3, 94208
s_nop 0
global_load_lds_dwordx4 v2, s[92:93] offset:3072
v_mfma_f32_16x16x32_bf16 v[112:115], v[144:147], v[192:195], v[112:115]
ds_read_b128 v[172:175], v5 offset:33024
v_mfma_f32_16x16x32_bf16 v[116:119], v[144:147], v[196:199], v[116:119]
ds_read_b128 v[176:179], v5 offset:33280
v_mfma_f32_16x16x32_bf16 v[120:123], a[116:119], v[184:187], v[120:123]
ds_read_b128 v[180:183], v5 offset:33536
v_mfma_f32_16x16x32_bf16 v[124:127], a[116:119], v[188:191], v[124:127]
v_mfma_f32_16x16x32_bf16 v[128:131], a[116:119], v[192:195], v[128:131]
v_mfma_f32_16x16x32_bf16 v[132:135], a[116:119], v[196:199], v[132:135]
s_waitcnt lgkmcnt(5)
v_mfma_f32_16x16x32_bf16 v[104:107], v[136:139], v[152:155], v[104:107]
ds_read_b128 v[144:147], v0 offset:9216
ds_read_b128 v[184:187], v6 offset:32768
s_add_u32 s92, s92, 4096
s_addc_u32 s93, s93, 0
s_mul_i32 s3, s20, 18432
s_add_u32 m0, s3, 98304
s_nop 0
global_load_lds_dwordx4 v2, s[92:93] offset:0
v_mfma_f32_16x16x32_bf16 v[108:111], v[136:139], v[156:159], v[108:111]
ds_read_b128 v[188:191], v6 offset:33024
s_mul_i32 s3, s20, 18432
s_add_u32 m0, s3, 98304
s_nop 0
global_load_lds_dwordx4 v2, s[92:93] offset:1024
v_mfma_f32_16x16x32_bf16 v[112:115], v[136:139], v[160:163], v[112:115]
ds_read_b128 v[192:195], v6 offset:33280
v_mfma_f32_16x16x32_bf16 v[116:119], v[136:139], v[164:167], v[116:119]
ds_read_b128 v[196:199], v6 offset:33536
s_waitcnt vmcnt(11)
s_barrier
s_waitcnt lgkmcnt(5)
v_mfma_f32_16x16x32_bf16 v[104:107], v[140:143], v[168:171], v[104:107]
ds_read_b128 v[136:139], v0 offset:10240
ds_read_b128 v[152:155], v3 offset:49152
global_load_dwordx4 a[128:131], v2, s[92:93] offset:2048
v_mfma_f32_16x16x32_bf16 v[108:111], v[140:143], v[172:175], v[108:111]
ds_read_b128 v[156:159], v3 offset:49408
v_mfma_f32_16x16x32_bf16 v[112:115], v[140:143], v[176:179], v[112:115]
ds_read_b128 v[160:163], v3 offset:49664
v_mfma_f32_16x16x32_bf16 v[116:119], v[140:143], v[180:183], v[116:119]
ds_read_b128 v[164:167], v3 offset:49920
s_waitcnt lgkmcnt(5)
v_mfma_f32_16x16x32_bf16 v[104:107], v[144:147], v[184:187], v[104:107]
ds_read_b128 v[140:143], v0 offset:11264
ds_read_b128 v[168:171], v4 offset:49152
global_load_dwordx4 a[132:135], v2, s[92:93] offset:3072
v_mfma_f32_16x16x32_bf16 v[108:111], v[144:147], v[188:191], v[108:111]
ds_read_b128 v[172:175], v4 offset:49408
s_add_u32 s92, s92, 4096
s_addc_u32 s93, s93, 0
global_load_dwordx4 a[136:139], v2, s[92:93] offset:0
v_mfma_f32_16x16x32_bf16 v[112:115], v[144:147], v[192:195], v[112:115]
ds_read_b128 v[176:179], v4 offset:49664
v_mfma_f32_16x16x32_bf16 v[116:119], v[144:147], v[196:199], v[116:119]
ds_read_b128 v[180:183], v4 offset:49920
s_waitcnt vmcnt(9) lgkmcnt(5)
v_mfma_f32_16x16x32_bf16 v[104:107], v[136:139], v[152:155], v[104:107]
ds_read_b128 v[144:147], v0 offset:12288
global_load_dwordx4 a[140:143], v2, s[92:93] offset:1024
v_mfma_f32_16x16x32_bf16 v[108:111], v[136:139], v[156:159], v[108:111]
ds_read_b128 v[184:187], v5 offset:49152
v_mfma_f32_16x16x32_bf16 v[112:115], v[136:139], v[160:163], v[112:115]
ds_read_b128 v[188:191], v5 offset:49408
v_mfma_f32_16x16x32_bf16 v[116:119], v[136:139], v[164:167], v[116:119]
ds_read_b128 v[192:195], v5 offset:49664
v_mfma_f32_16x16x32_bf16 v[120:123], a[120:123], v[152:155], v[120:123]
ds_read_b128 v[196:199], v5 offset:49920
v_mfma_f32_16x16x32_bf16 v[124:127], a[120:123], v[156:159], v[124:127]
v_mfma_f32_16x16x32_bf16 v[128:131], a[120:123], v[160:163], v[128:131]
v_mfma_f32_16x16x32_bf16 v[132:135], a[120:123], v[164:167], v[132:135]
s_waitcnt vmcnt(9) lgkmcnt(5)
v_mfma_f32_16x16x32_bf16 v[104:107], v[140:143], v[168:171], v[104:107]
ds_read_b128 v[136:139], v0 offset:13312
ds_read_b128 v[152:155], v6 offset:49152
global_load_dwordx4 a[144:147], v2, s[92:93] offset:2048
v_mfma_f32_16x16x32_bf16 v[108:111], v[140:143], v[172:175], v[108:111]
ds_read_b128 v[156:159], v6 offset:49408
v_mfma_f32_16x16x32_bf16 v[112:115], v[140:143], v[176:179], v[112:115]
ds_read_b128 v[160:163], v6 offset:49664
v_mfma_f32_16x16x32_bf16 v[116:119], v[140:143], v[180:183], v[116:119]
ds_read_b128 v[164:167], v6 offset:49920
s_barrier
s_waitcnt vmcnt(9) lgkmcnt(5)
v_mfma_f32_16x16x32_bf16 v[104:107], v[144:147], v[184:187], v[104:107]
ds_read_b128 v[140:143], v0 offset:14336
ds_read_b128 v[168:171], v7 offset:0
global_load_dwordx4 a[148:151], v2, s[92:93] offset:3072
v_mfma_f32_16x16x32_bf16 v[108:111], v[144:147], v[188:191], v[108:111]
ds_read_b128 v[172:175], v7 offset:256
v_mfma_f32_16x16x32_bf16 v[112:115], v[144:147], v[192:195], v[112:115]
ds_read_b128 v[176:179], v7 offset:512
v_mfma_f32_16x16x32_bf16 v[116:119], v[144:147], v[196:199], v[116:119]
ds_read_b128 v[180:183], v7 offset:768
s_waitcnt vmcnt(8) lgkmcnt(5)
v_mfma_f32_16x16x32_bf16 v[104:107], v[136:139], v[152:155], v[104:107]
ds_read_b128 v[144:147], v0 offset:15360
ds_read_b128 v[184:187], v8 offset:0
s_add_u32 s92, s92, 4096
s_addc_u32 s93, s93, 0
global_load_dwordx4 a[152:155], v2, s[92:93] offset:0
v_mfma_f32_16x16x32_bf16 v[108:111], v[136:139], v[156:159], v[108:111]
ds_read_b128 v[188:191], v8 offset:256
global_load_dwordx4 a[156:159], v2, s[92:93] offset:1024
v_mfma_f32_16x16x32_bf16 v[112:115], v[136:139], v[160:163], v[112:115]
ds_read_b128 v[192:195], v8 offset:512
v_mfma_f32_16x16x32_bf16 v[116:119], v[136:139], v[164:167], v[116:119]
ds_read_b128 v[196:199], v8 offset:768
s_waitcnt vmcnt(9) lgkmcnt(5)
v_mfma_f32_16x16x32_bf16 v[104:107], v[140:143], v[168:171], v[104:107]
ds_read_b128 v[136:139], v0 offset:16384
global_load_dwordx4 a[160:163], v2, s[92:93] offset:2048
v_mfma_f32_16x16x32_bf16 v[108:111], v[140:143], v[172:175], v[108:111]
ds_read_b128 v[152:155], v9 offset:0
v_mfma_f32_16x16x32_bf16 v[112:115], v[140:143], v[176:179], v[112:115]
ds_read_b128 v[156:159], v9 offset:256
v_mfma_f32_16x16x32_bf16 v[116:119], v[140:143], v[180:183], v[116:119]
ds_read_b128 v[160:163], v9 offset:512
v_mfma_f32_16x16x32_bf16 v[120:123], a[124:127], v[168:171], v[120:123]
ds_read_b128 v[164:167], v9 offset:768
v_mfma_f32_16x16x32_bf16 v[124:127], a[124:127], v[172:175], v[124:127]
v_mfma_f32_16x16x32_bf16 v[128:131], a[124:127], v[176:179], v[128:131]
v_mfma_f32_16x16x32_bf16 v[132:135], a[124:127], v[180:183], v[132:135]
s_waitcnt vmcnt(9) lgkmcnt(5)
v_mfma_f32_16x16x32_bf16 v[104:107], v[144:147], v[184:187], v[104:107]
ds_read_b128 v[140:143], v0 offset:17408
ds_read_b128 v[168:171], v10 offset:0
global_load_dwordx4 a[164:167], v2, s[92:93] offset:3072
v_mfma_f32_16x16x32_bf16 v[108:111], v[144:147], v[188:191], v[108:111]
ds_read_b128 v[172:175], v10 offset:256
v_mfma_f32_16x16x32_bf16 v[112:115], v[144:147], v[192:195], v[112:115]
ds_read_b128 v[176:179], v10 offset:512
v_mfma_f32_16x16x32_bf16 v[116:119], v[144:147], v[196:199], v[116:119]
ds_read_b128 v[180:183], v10 offset:768
s_waitcnt lgkmcnt(5)
v_mfma_f32_16x16x32_bf16 v[104:107], v[136:139], v[152:155], v[104:107]
ds_write_b128 v23, v[120:123] offset:0
ds_write_b128 v23, v[124:127] offset:1024
v_mfma_f32_16x16x32_bf16 v[108:111], v[136:139], v[156:159], v[108:111]
ds_write_b128 v23, v[128:131] offset:2048
ds_write_b128 v23, v[132:135] offset:3072
v_mfma_f32_16x16x32_bf16 v[112:115], v[136:139], v[160:163], v[112:115]
s_add_u32 s92, s92, 4096
s_addc_u32 s93, s93, 0
global_load_dwordx4 a[168:171], v2, s[92:93] offset:0
v_mfma_f32_16x16x32_bf16 v[116:119], v[136:139], v[164:167], v[116:119]
s_waitcnt lgkmcnt(4)
v_mfma_f32_16x16x32_bf16 v[104:107], v[140:143], v[168:171], v[104:107]
global_load_dwordx4 a[172:175], v2, s[92:93] offset:1024
v_mfma_f32_16x16x32_bf16 v[108:111], v[140:143], v[172:175], v[108:111]
global_load_dwordx4 a[176:179], v2, s[92:93] offset:2048
v_mfma_f32_16x16x32_bf16 v[112:115], v[140:143], v[176:179], v[112:115]
v_mfma_f32_16x16x32_bf16 v[116:119], v[140:143], v[180:183], v[116:119]
s_waitcnt lgkmcnt(0)
s_barrier
ds_read_b128 v[152:155], v24 offset:0
ds_read_b128 v[156:159], v24 offset:4096
ds_read_b128 v[160:163], v24 offset:8192
ds_read_b128 v[164:167], v24 offset:12288
global_load_dwordx4 a[180:183], v2, s[92:93] offset:3072
s_add_u32 s92, s92, 4096
s_addc_u32 s93, s93, 0
global_load_dwordx4 a[184:187], v2, s[92:93] offset:0
v_cvt_pk_bf16_f32 v52, v104, v105
v_cvt_pk_bf16_f32 v53, v106, v107
s_cmp_lg_u32 s23, 0
s_cbranch_scc1 slow_61
global_store_dwordx2 v11, v[52:53], s[16:17] offset:0
back_62:
v_cvt_pk_bf16_f32 v54, v108, v109
v_cvt_pk_bf16_f32 v55, v110, v111
s_cbranch_scc1 slow_63
global_store_dwordx2 v11, v[54:55], s[16:17] offset:256
back_64:
v_cvt_pk_bf16_f32 v56, v112, v113
v_cvt_pk_bf16_f32 v57, v114, v115
s_cbranch_scc1 slow_65
global_store_dwordx2 v11, v[56:57], s[16:17] offset:512
back_66:
v_cvt_pk_bf16_f32 v58, v116, v117
v_cvt_pk_bf16_f32 v59, v118, v119
s_cbranch_scc1 slow_67
global_store_dwordx2 v11, v[58:59], s[16:17] offset:768
back_68:
s_waitcnt lgkmcnt(0)
v_pk_add_f32 v[152:153], v[152:153], v[156:157]
v_pk_add_f32 v[160:161], v[160:161], v[164:165]
v_pk_add_f32 v[154:155], v[154:155], v[158:159]
v_pk_add_f32 v[162:163], v[162:163], v[166:167]
v_pk_add_f32 v[152:153], v[152:153], v[80:81]
v_pk_add_f32 v[154:155], v[154:155], v[82:83]
v_pk_add_f32 v[120:121], v[152:153], v[160:161]
v_pk_add_f32 v[122:123], v[154:155], v[162:163]
v_cvt_pk_bf16_f32 v60, v120, v121
v_cvt_pk_bf16_f32 v61, v122, v123
s_cbranch_scc1 slow_69
global_store_dwordx2 v12, v[60:61], s[16:17] offset:0
back_70:
v_pk_add_f32 v[152:153], v[104:105], v[106:107]
v_pk_mul_f32 v[154:155], v[104:105], v[104:105]
v_pk_add_f32 v[156:157], v[108:109], v[110:111]
v_pk_mul_f32 v[158:159], v[108:109], v[108:109]
v_pk_add_f32 v[160:161], v[112:113], v[114:115]
v_pk_mul_f32 v[162:163], v[112:113], v[112:113]
v_pk_add_f32 v[164:165], v[116:117], v[118:119]
v_pk_mul_f32 v[166:167], v[116:117], v[116:117]
v_pk_add_f32 v[168:169], v[120:121], v[122:123]
v_pk_mul_f32 v[170:171], v[120:121], v[120:121]
v_pk_fma_f32 v[154:155], v[106:107], v[106:107], v[154:155]
v_add_f32 v152, v152, v153
v_pk_fma_f32 v[158:159], v[110:111], v[110:111], v[158:159]
v_add_f32 v156, v156, v157
v_pk_fma_f32 v[162:163], v[114:115], v[114:115], v[162:163]
v_add_f32 v160, v160, v161
v_pk_fma_f32 v[166:167], v[118:119], v[118:119], v[166:167]
v_add_f32 v164, v164, v165
v_pk_fma_f32 v[170:171], v[122:123], v[122:123], v[170:171]
v_add_f32 v168, v168, v169
v_add_f32 v153, v154, v155
v_add_f32 v157, v158, v159
v_add_f32 v161, v162, v163
v_add_f32 v165, v166, v167
v_add_f32 v169, v170, v171
v_fmac_f32 v152, s60, v168
v_fmac_f32 v153, s60, v169
v_fmac_f32 v156, s61, v168
v_fmac_f32 v157, s61, v169
v_fmac_f32 v160, s62, v168
v_fmac_f32 v161, s62, v169
v_fmac_f32 v164, s63, v168
v_fmac_f32 v165, s63, v169
v_permlane32_swap_b32 v152, v160
v_permlane32_swap_b32 v156, v164
v_permlane32_swap_b32 v153, v161
v_permlane32_swap_b32 v157, v165
v_pk_add_f32 v[152:153], v[152:153], v[160:161]
v_pk_add_f32 v[156:157], v[156:157], v[164:165]
s_nop 1
v_permlane16_swap_b32 v152, v156
v_permlane16_swap_b32 v153, v157
v_pk_add_f32 v[152:153], v[152:153], v[156:157]
ds_write_b64 v20, v[152:153]
s_waitcnt lgkmcnt(0)
s_barrier
ds_read_b64 v[184:185], v19 offset:0
ds_read_b64 v[186:187], v19 offset:512
ds_read_b64 v[188:189], v19 offset:1024
ds_read_b64 v[190:191], v19 offset:1536
s_add_u32 s74, s28, 0
s_add_u32 s65, s75, 18
v_mov_b32 v193, s65
v_mov_b32 v195, s65
s_waitcnt lgkmcnt(0)
v_pk_add_f32 v[184:185], v[184:185], v[186:187]
v_pk_add_f32 v[188:189], v[188:189], v[190:191]
v_add_f32 v192, v184, v188
v_add_f32 v194, v185, v189
s_cmp_lg_u32 s23, 0
s_cbranch_scc1 slow_71
buffer_store_dwordx4 v[192:195], v220, s[16:19], s74 offen
back_72:
global_load_dwordx4 a[188:191], v2, s[92:93] offset:1024
global_load_dwordx4 a[192:195], v2, s[92:93] offset:2048
global_load_dwordx4 a[196:199], v2, s[92:93] offset:3072
s_add_u32 s92, s92, 4096
s_addc_u32 s93, s93, 0
global_load_dwordx4 a[200:203], v2, s[92:93] offset:0
s_add_u32 s26, s75, 3
v_mov_b32 v63, s26
s_waitcnt vmcnt(5) lgkmcnt(0)
s_barrier
s_cmp_lg_u32 s23, 0
s_cbranch_scc1 slow_73
buffer_store_dword v63, v17, s[16:19], s27 offen
back_74:
s_add_u32 s73, s38, 0
s_add_u32 s73, s73, s24
s_add_u32 s90, s16, s73
s_addc_u32 s91, s17, 0
s_mov_b32 m0, s38
s_mov_b32 s36, 0
s_add_u32 s26, s75, 3
poll_75:
global_load_dword v63, v16, s[16:17] sc1
global_load_dwordx4 v[184:187], v18, s[16:17] offset:0 sc1
global_load_dwordx4 v[188:191], v18, s[16:17] offset:1024 sc1
s_add_u32 s36, s36, 1
s_cmp_gt_u32 s36, 0x200000
s_cbranch_scc1 k2_bail
s_waitcnt vmcnt(2)
v_subrev_u32 v63, s26, v63
v_cmp_lt_u32 vcc, 15, v63
s_cbranch_vccnz poll_75
global_load_lds_dwordx4 v2, s[90:91] offset:0 sc1
global_load_lds_dwordx4 v2, s[90:91] offset:1024 sc1
global_load_lds_dwordx4 v2, s[90:91] offset:2048 sc1
global_load_lds_dwordx4 v2, s[90:91] offset:3072 sc1
s_waitcnt vmcnt(4)
v_xor_b32 v192, v185, v187
v_xor_b32 v193, v189, v191
v_xor_b32 v194, s65, v185
v_xor_b32 v195, s65, v189
v_or3_b32 v192, v192, v193, v194
s_add_u32 s90, s90, 16384
s_addc_u32 s91, s91, 0
s_add_u32 m0, m0, 16384
s_nop 0
global_load_lds_dwordx4 v2, s[90:91] offset:0 sc1
v_or_b32 v192, v192, v195
v_cmp_ne_u32 vcc, 0, v192
s_cbranch_vccnz retry_76
got_77:
v_add_f32 v184, v184, v188
v_add_f32 v185, v186, v190
v_mov_b32 v186, v184
global_load_lds_dwordx4 v2, s[90:91] offset:1024 sc1
v_mov_b32 v187, v185
v_permlane32_swap_b32 v184, v186
s_nop 0
v_permlane32_swap_b32 v185, v187
v_pk_add_f32 v[184:185], v[184:185], v[186:187]
v_mov_b32 v186, v184
v_mov_b32 v187, v185
global_load_lds_dwordx4 v2, s[90:91] offset:2048 sc1
v_permlane16_swap_b32 v184, v186
v_permlane16_swap_b32 v185, v187
v_pk_add_f32 v[184:185], v[184:185], v[186:187]
v_mul_f32 v184, 0x3acccccd, v184
v_mul_f32 v185, 0x3acccccd, v185
v_fma_f32 v188, -v184, v184, v185
global_load_lds_dwordx4 v2, s[90:91] offset:3072 sc1
v_max_f32 v188, 0, v188
v_add_f32 v189, 0x3727c5ac, v188
v_rsq_f32 v188, v189
s_nop 0
v_mul_f32 v185, v189, v188
v_mul_f32 v186, 0xc0135761, v188
v_mul_f32 v187, 0xbdd2d3e8, v188
v_mul_f32 v188, v188, v188
v_mul_f32 v187, v187, v188
ds_write_b128 v21, v[184:187]
s_waitcnt vmcnt(4) lgkmcnt(0)
s_barrier
ds_read_b128 v[152:155], v3 offset:0
ds_read_b128 v[156:159], v3 offset:256
ds_read_b128 v[160:163], v3 offset:512
ds_read_b128 v[164:167], v3 offset:768
ds_read_b128 v[168:171], v4 offset:0
ds_read_b128 v[172:175], v4 offset:256
ds_read_b128 v[176:179], v4 offset:512
ds_read_b128 v[180:183], v4 offset:768
s_waitcnt lgkmcnt(4)
v_mfma_f32_16x16x32_bf16 v[104:107], a[128:131], v[152:155], 0
ds_read_b128 v[184:187], v5 offset:0
v_mfma_f32_16x16x32_bf16 v[108:111], a[128:131], v[156:159], 0
ds_read_b128 v[188:191], v5 offset:256
s_add_u32 s90, s90, 16384
s_addc_u32 s91, s91, 0
s_add_u32 m0, m0, 16384
s_nop 0
global_load_lds_dwordx4 v2, s[90:91] offset:0 sc1
v_mfma_f32_16x16x32_bf16 v[112:115], a[128:131], v[160:163], 0
ds_read_b128 v[192:195], v5 offset:512
v_mfma_f32_16x16x32_bf16 v[116:119], a[128:131], v[164:167], 0
ds_read_b128 v[196:199], v5 offset:768
global_load_lds_dwordx4 v2, s[90:91] offset:1024 sc1
v_mfma_f32_16x16x32_bf16 v[120:123], a[132:135], v[152:155], 0
v_mfma_f32_16x16x32_bf16 v[124:127], a[132:135], v[156:159], 0
v_mfma_f32_16x16x32_bf16 v[128:131], a[132:135], v[160:163], 0
v_mfma_f32_16x16x32_bf16 v[132:135], a[132:135], v[164:167], 0
v_mfma_f32_16x16x32_bf16 v[136:139], a[136:139], v[152:155], 0
v_mfma_f32_16x16x32_bf16 v[140:143], a[136:139], v[156:159], 0
v_mfma_f32_16x16x32_bf16 v[144:147], a[136:139], v[160:163], 0
v_mfma_f32_16x16x32_bf16 v[148:151], a[136:139], v[164:167], 0
s_waitcnt lgkmcnt(4)
v_mfma_f32_16x16x32_bf16 v[104:107], a[140:143], v[168:171], v[104:107]
ds_read_b128 v[152:155], v6 offset:0
global_load_dwordx4 a[204:207], v2, s[92:93] offset:1024
v_mfma_f32_16x16x32_bf16 v[108:111], a[140:143], v[172:175], v[108:111]
ds_read_b128 v[156:159], v6 offset:256
global_load_lds_dwordx4 v2, s[90:91] offset:2048 sc1
v_mfma_f32_16x16x32_bf16 v[112:115], a[140:143], v[176:179], v[112:115]
ds_read_b128 v[160:163], v6 offset:512
global_load_dwordx4 a[208:211], v2, s[92:93] offset:2048
v_mfma_f32_16x16x32_bf16 v[116:119], a[140:143], v[180:183], v[116:119]
ds_read_b128 v[164:167], v6 offset:768
global_load_lds_dwordx4 v2, s[90:91] offset:3072 sc1
v_mfma_f32_16x16x32_bf16 v[120:123], a[144:147], v[168:171], v[120:123]
v_mfma_f32_16x16x32_bf16 v[124:127], a[144:147], v[172:175], v[124:127]
v_mfma_f32_16x16x32_bf16 v[128:131], a[144:147], v[176:179], v[128:131]
v_mfma_f32_16x16x32_bf16 v[132:135], a[144:147], v[180:183], v[132:135]
v_mfma_f32_16x16x32_bf16 v[136:139], a[148:151], v[168:171], v[136:139]
v_mfma_f32_16x16x32_bf16 v[140:143], a[148:151], v[172:175], v[140:143]
v_mfma_f32_16x16x32_bf16 v[144:147], a[148:151], v[176:179], v[144:147]
v_mfma_f32_16x16x32_bf16 v[148:151], a[148:151], v[180:183], v[148:151]
s_waitcnt vmcnt(6)
s_barrier
s_waitcnt lgkmcnt(4)
v_mfma_f32_16x16x32_bf16 v[104:107], a[152:155], v[184:187], v[104:107]
ds_read_b128 v[168:171], v3 offset:16384
global_load_dwordx4 a[212:215], v2, s[92:93] offset:3072
v_mfma_f32_16x16x32_bf16 v[108:111], a[152:155], v[188:191], v[108:111]
ds_read_b128 v[172:175], v3 offset:16640
s_add_u32 s90, s90, 16384
s_addc_u32 s91, s91, 0
s_add_u32 m0, m0, 16384
s_nop 0
global_load_lds_dwordx4 v2, s[90:91] offset:0 sc1
v_mfma_f32_16x16x32_bf16 v[112:115], a[152:155], v[192:195], v[112:115]
ds_read_b128 v[176:179], v3 offset:16896
s_add_u32 s92, s92, 4096
s_addc_u32 s93, s93, 0
global_load_dwordx4 a[216:219], v2, s[92:93] offset:0
v_mfma_f32_16x16x32_bf16 v[116:119], a[152:155], v[196:199], v[116:119]
ds_read_b128 v[180:183], v3 offset:17152
global_load_lds_dwordx4 v2, s[90:91] offset:1024 sc1
v_mfma_f32_16x16x32_bf16 v[120:123], a[156:159], v[184:187], v[120:123]
global_load_dwordx4 a[220:223], v2, s[92:93] offset:1024
v_mfma_f32_16x16x32_bf16 v[124:127], a[156:159], v[188:191], v[124:127]
v_mfma_f32_16x16x32_bf16 v[128:131], a[156:159], v[192:195], v[128:131]
v_mfma_f32_16x16x32_bf16 v[132:135], a[156:159], v[196:199], v[132:135]
v_mfma_f32_16x16x32_bf16 v[136:139], a[160:163], v[184:187], v[136:139]
v_mfma_f32_16x16x32_bf16 v[140:143], a[160:163], v[188:191], v[140:143]
v_mfma_f32_16x16x32_bf16 v[144:147], a[160:163], v[192:195], v[144:147]
v_mfma_f32_16x16x32_bf16 v[148:151], a[160:163], v[196:199], v[148:151]
s_waitcnt lgkmcnt(4)
v_mfma_f32_16x16x32_bf16 v[104:107], a[164:167], v[152:155], v[104:107]
ds_read_b128 v[184:187], v4 offset:16384
global_load_dwordx4 a[224:227], v2, s[92:93] offset:2048
v_mfma_f32_16x16x32_bf16 v[108:111], a[164:167], v[156:159], v[108:111]
ds_read_b128 v[188:191], v4 offset:16640
global_load_lds_dwordx4 v2, s[90:91] offset:2048 sc1
v_mfma_f32_16x16x32_bf16 v[112:115], a[164:167], v[160:163], v[112:115]
ds_read_b128 v[192:195], v4 offset:16896
global_load_dwordx4 a[228:231], v2, s[92:93] offset:3072
v_mfma_f32_16x16x32_bf16 v[116:119], a[164:167], v[164:167], v[116:119]
ds_read_b128 v[196:199], v4 offset:17152
global_load_lds_dwordx4 v2, s[90:91] offset:3072 sc1
v_mfma_f32_16x16x32_bf16 v[120:123], a[168:171], v[152:155], v[120:123]
s_add_u32 s92, s92, 4096
s_addc_u32 s93, s93, 0
global_load_dwordx4 a[232:235], v2, s[92:93] offset:0
v_mfma_f32_16x16x32_bf16 v[124:127], a[168:171], v[156:159], v[124:127]
v_mfma_f32_16x16x32_bf16 v[128:131], a[168:171], v[160:163], v[128:131]
v_mfma_f32_16x16x32_bf16 v[132:135], a[168:171], v[164:167], v[132:135]
v_mfma_f32_16x16x32_bf16 v[136:139], a[172:175], v[152:155], v[136:139]
v_mfma_f32_16x16x32_bf16 v[140:143], a[172:175], v[156:159], v[140:143]
v_mfma_f32_16x16x32_bf16 v[144:147], a[172:175], v[160:163], v[144:147]
v_mfma_f32_16x16x32_bf16 v[148:151], a[172:175], v[164:167], v[148:151]
s_waitcnt lgkmcnt(4)
v_mfma_f32_16x16x32_bf16 v[104:107], a[176:179], v[168:171], v[104:107]
ds_read_b128 v[152:155], v5 offset:16384
global_load_dwordx4 a[236:239], v2, s[92:93] offset:1024
v_mfma_f32_16x16x32_bf16 v[108:111], a[176:179], v[172:175], v[108:111]
ds_read_b128 v[156:159], v5 offset:16640
s_add_u32 s90, s90, 16384
s_addc_u32 s91, s91, 0
s_add_u32 m0, m0, 16384
s_nop 0
global_load_lds_dwordx4 v2, s[90:91] offset:0 sc1
v_mfma_f32_16x16x32_bf16 v[112:115], a[176:179], v[176:179], v[112:115]
ds_read_b128 v[160:163], v5 offset:16896
global_load_dwordx4 a[240:243], v2, s[92:93] offset:2048
v_mfma_f32_16x16x32_bf16 v[116:119], a[176:179], v[180:183], v[116:119]
ds_read_b128 v[164:167], v5 offset:17152
global_load_lds_dwordx4 v2, s[90:91] offset:1024 sc1
v_mfma_f32_16x16x32_bf16 v[120:123], a[180:183], v[168:171], v[120:123]
global_load_dwordx4 a[244:247], v2, s[92:93] offset:3072
v_mfma_f32_16x16x32_bf16 v[124:127], a[180:183], v[172:175], v[124:127]
v_mfma_f32_16x16x32_bf16 v[128:131], a[180:183], v[176:179], v[128:131]
v_mfma_f32_16x16x32_bf16 v[132:135], a[180:183], v[180:183], v[132:135]
v_mfma_f32_16x16x32_bf16 v[136:139], a[184:187], v[168:171], v[136:139]
v_mfma_f32_16x16x32_bf16 v[140:143], a[184:187], v[172:175], v[140:143]
v_mfma_f32_16x16x32_bf16 v[144:147], a[184:187], v[176:179], v[144:147]
v_mfma_f32_16x16x32_bf16 v[148:151], a[184:187], v[180:183], v[148:151]
s_waitcnt lgkmcnt(4)
v_mfma_f32_16x16x32_bf16 v[104:107], a[188:191], v[184:187], v[104:107]
ds_read_b128 v[168:171], v6 offset:16384
s_add_u32 s92, s92, 4096
s_addc_u32 s93, s93, 0
global_load_dwordx4 a[248:251], v2, s[92:93] offset:0
v_mfma_f32_16x16x32_bf16 v[108:111], a[188:191], v[188:191], v[108:111]
ds_read_b128 v[172:175], v6 offset:16640
global_load_lds_dwordx4 v2, s[90:91] offset:2048 sc1
v_mfma_f32_16x16x32_bf16 v[112:115], a[188:191], v[192:195], v[112:115]
ds_read_b128 v[176:179], v6 offset:16896
global_load_dwordx4 a[252:255], v2, s[92:93] offset:1024
v_mfma_f32_16x16x32_bf16 v[116:119], a[188:191], v[196:199], v[116:119]
ds_read_b128 v[180:183], v6 offset:17152
global_load_lds_dwordx4 v2, s[90:91] offset:3072 sc1
v_mfma_f32_16x16x32_bf16 v[120:123], a[192:195], v[184:187], v[120:123]
global_load_dwordx4 v[224:227], v2, s[92:93] offset:2048
v_mfma_f32_16x16x32_bf16 v[124:127], a[192:195], v[188:191], v[124:127]
global_load_dwordx4 v[228:231], v2, s[92:93] offset:3072
v_mfma_f32_16x16x32_bf16 v[128:131], a[192:195], v[192:195], v[128:131]
s_add_u32 s92, s92, 4096
s_addc_u32 s93, s93, 0
global_load_dwordx4 v[232:235], v2, s[92:93] offset:0
v_mfma_f32_16x16x32_bf16 v[132:135], a[192:195], v[196:199], v[132:135]
v_mfma_f32_16x16x32_bf16 v[136:139], a[196:199], v[184:187], v[136:139]
v_mfma_f32_16x16x32_bf16 v[140:143], a[196:199], v[188:191], v[140:143]
v_mfma_f32_16x16x32_bf16 v[144:147], a[196:199], v[192:195], v[144:147]
v_mfma_f32_16x16x32_bf16 v[148:151], a[196:199], v[196:199], v[148:151]
s_waitcnt vmcnt(22)
s_barrier
s_waitcnt lgkmcnt(4)
v_mfma_f32_16x16x32_bf16 v[104:107], a[200:203], v[152:155], v[104:107]
ds_read_b128 v[184:187], v3 offset:32768
global_load_dwordx4 v[236:239], v2, s[92:93] offset:1024
v_mfma_f32_16x16x32_bf16 v[108:111], a[200:203], v[156:159], v[108:111]
ds_read_b128 v[188:191], v3 offset:33024
global_load_dwordx4 v[240:243], v2, s[92:93] offset:2048
v_mfma_f32_16x16x32_bf16 v[112:115], a[200:203], v[160:163], v[112:115]
ds_read_b128 v[192:195], v3 offset:33280
global_load_dwordx4 v[244:247], v2, s[92:93] offset:3072
v_mfma_f32_16x16x32_bf16 v[116:119], a[200:203], v[164:167], v[116:119]
ds_read_b128 v[196:199], v3 offset:33536
v_mfma_f32_16x16x32_bf16 v[120:123], a[204:207], v[152:155], v[120:123]
v_mfma_f32_16x16x32_bf16 v[124:127], a[204:207], v[156:159], v[124:127]
v_mfma_f32_16x16x32_bf16 v[128:131], a[204:207], v[160:163], v[128:131]
v_mfma_f32_16x16x32_bf16 v[132:135], a[204:207], v[164:167], v[132:135]
v_mfma_f32_16x16x32_bf16 v[136:139], a[208:211], v[152:155], v[136:139]
v_mfma_f32_16x16x32_bf16 v[140:143], a[208:211], v[156:159], v[140:143]
v_mfma_f32_16x16x32_bf16 v[144:147], a[208:211], v[160:163], v[144:147]
v_mfma_f32_16x16x32_bf16 v[148:151], a[208:211], v[164:167], v[148:151]
s_waitcnt vmcnt(24) lgkmcnt(4)
v_mfma_f32_16x16x32_bf16 v[104:107], a[212:215], v[168:171], v[104:107]
ds_read_b128 v[152:155], v4 offset:32768
s_add_u32 s92, s92, 4096
s_addc_u32 s93, s93, 0
global_load_dwordx4 v[248:251], v2, s[92:93] offset:0
v_mfma_f32_16x16x32_bf16 v[108:111], a[212:215], v[172:175], v[108:111]
ds_read_b128 v[156:159], v4 offset:33024
v_lshrrev_b32 v62, 4, v1
v_mfma_f32_16x16x32_bf16 v[112:115], a[212:215], v[176:179], v[112:115]
ds_read_b128 v[160:163], v4 offset:33280
v_lshlrev_b32 v80, 4, v62
v_mfma_f32_16x16x32_bf16 v[116:119], a[212:215], v[180:183], v[116:119]
ds_read_b128 v[164:167], v4 offset:33536
s_mul_i32 s94, s22, 768
s_waitcnt vmcnt(23)
v_mfma_f32_16x16x32_bf16 v[120:123], a[216:219], v[168:171], v[120:123]
s_lshl_b32 s95, s20, 6
s_add_u32 s96, s94, s95
v_mfma_f32_16x16x32_bf16 v[124:127], a[216:219], v[172:175], v[124:127]
s_add_u32 s96, s96, 10829824
v_mfma_f32_16x16x32_bf16 v[128:131], a[216:219], v[176:179], v[128:131]
buffer_load_dwordx4 v[92:95], v80, s[16:19], s96 offen offset:0 sc1
v_mfma_f32_16x16x32_bf16 v[132:135], a[216:219], v[180:183], v[132:135]
buffer_load_dwordx4 v[96:99], v80, s[16:19], s96 offen offset:256 sc1
s_waitcnt vmcnt(23)
v_mfma_f32_16x16x32_bf16 v[136:139], a[220:223], v[168:171], v[136:139]
buffer_load_dwordx4 v[100:103], v80, s[16:19], s96 offen offset:512 sc1
v_mfma_f32_16x16x32_bf16 v[140:143], a[220:223], v[172:175], v[140:143]
s_add_u32 s96, s96, 6144
v_mfma_f32_16x16x32_bf16 v[144:147], a[220:223], v[176:179], v[144:147]
buffer_load_dwordx4 v[64:67], v80, s[16:19], s96 offen offset:0 sc1
v_mfma_f32_16x16x32_bf16 v[148:151], a[220:223], v[180:183], v[148:151]
buffer_load_dwordx4 v[68:71], v80, s[16:19], s96 offen offset:256 sc1
s_waitcnt vmcnt(25) lgkmcnt(4)
v_mfma_f32_16x16x32_bf16 v[104:107], a[224:227], v[184:187], v[104:107]
ds_read_b128 v[168:171], v5 offset:32768
global_load_dwordx4 v[252:255], v2, s[92:93] offset:1024
v_mfma_f32_16x16x32_bf16 v[108:111], a[224:227], v[188:191], v[108:111]
ds_read_b128 v[172:175], v5 offset:33024
buffer_load_dwordx4 v[72:75], v80, s[16:19], s96 offen offset:512 sc1
v_mfma_f32_16x16x32_bf16 v[112:115], a[224:227], v[192:195], v[112:115]
ds_read_b128 v[176:179], v5 offset:33280
global_load_dwordx4 a[128:131], v2, s[92:93] offset:2048
v_mfma_f32_16x16x32_bf16 v[116:119], a[224:227], v[196:199], v[116:119]
ds_read_b128 v[180:183], v5 offset:33536
global_load_dwordx4 a[132:135], v2, s[92:93] offset:3072
s_waitcnt vmcnt(27)
v_mfma_f32_16x16x32_bf16 v[120:123], a[228:231], v[184:187], v[120:123]
s_add_u32 s92, s92, 4096
s_addc_u32 s93, s93, 0
global_load_dwordx4 a[136:139], v2, s[92:93] offset:0
v_mfma_f32_16x16x32_bf16 v[124:127], a[228:231], v[188:191], v[124:127]
global_load_dwordx4 a[140:143], v2, s[92:93] offset:1024
v_mfma_f32_16x16x32_bf16 v[128:131], a[228:231], v[192:195], v[128:131]
v_mfma_f32_16x16x32_bf16 v[132:135], a[228:231], v[196:199], v[132:135]
s_waitcnt vmcnt(27)
v_mfma_f32_16x16x32_bf16 v[136:139], a[232:235], v[184:187], v[136:139]
v_mfma_f32_16x16x32_bf16 v[140:143], a[232:235], v[188:191], v[140:143]
v_mfma_f32_16x16x32_bf16 v[144:147], a[232:235], v[192:195], v[144:147]
v_mfma_f32_16x16x32_bf16 v[148:151], a[232:235], v[196:199], v[148:151]
s_waitcnt vmcnt(26) lgkmcnt(4)
v_mfma_f32_16x16x32_bf16 v[104:107], a[236:239], v[152:155], v[104:107]
ds_read_b128 v[184:187], v6 offset:32768
global_load_dwordx4 a[144:147], v2, s[92:93] offset:2048
v_mfma_f32_16x16x32_bf16 v[108:111], a[236:239], v[156:159], v[108:111]
ds_read_b128 v[188:191], v6 offset:33024
global_load_dwordx4 a[148:151], v2, s[92:93] offset:3072
v_mfma_f32_16x16x32_bf16 v[112:115], a[236:239], v[160:163], v[112:115]
ds_read_b128 v[192:195], v6 offset:33280
s_add_u32 s92, s92, 4096
s_addc_u32 s93, s93, 0
global_load_dwordx4 a[152:155], v2, s[92:93] offset:0
v_mfma_f32_16x16x32_bf16 v[116:119], a[236:239], v[164:167], v[116:119]
ds_read_b128 v[196:199], v6 offset:33536
s_waitcnt vmcnt(27)
v_mfma_f32_16x16x32_bf16 v[120:123], a[240:243], v[152:155], v[120:123]
v_mfma_f32_16x16x32_bf16 v[124:127], a[240:243], v[156:159], v[124:127]
v_mfma_f32_16x16x32_bf16 v[128:131], a[240:243], v[160:163], v[128:131]
v_mfma_f32_16x16x32_bf16 v[132:135], a[240:243], v[164:167], v[132:135]
s_waitcnt vmcnt(25)
v_mfma_f32_16x16x32_bf16 v[136:139], a[244:247], v[152:155], v[136:139]
v_mfma_f32_16x16x32_bf16 v[140:143], a[244:247], v[156:159], v[140:143]
v_mfma_f32_16x16x32_bf16 v[144:147], a[244:247], v[160:163], v[144:147]
v_mfma_f32_16x16x32_bf16 v[148:151], a[244:247], v[164:167], v[148:151]
s_barrier
s_waitcnt vmcnt(24) lgkmcnt(4)
v_mfma_f32_16x16x32_bf16 v[104:107], a[248:251], v[168:171], v[104:107]
ds_read_b128 v[152:155], v3 offset:49152
global_load_dwordx4 a[156:159], v2, s[92:93] offset:1024
v_mfma_f32_16x16x32_bf16 v[108:111], a[248:251], v[172:175], v[108:111]
ds_read_b128 v[156:159], v3 offset:49408
global_load_dwordx4 a[160:163], v2, s[92:93] offset:2048
v_mfma_f32_16x16x32_bf16 v[112:115], a[248:251], v[176:179], v[112:115]
ds_read_b128 v[160:163], v3 offset:49664
global_load_dwordx4 a[164:167], v2, s[92:93] offset:3072
v_mfma_f32_16x16x32_bf16 v[116:119], a[248:251], v[180:183], v[116:119]
ds_read_b128 v[164:167], v3 offset:49920
s_waitcnt vmcnt(25)
v_mfma_f32_16x16x32_bf16 v[120:123], a[252:255], v[168:171], v[120:123]
v_mfma_f32_16x16x32_bf16 v[124:127], a[252:255], v[172:175], v[124:127]
v_mfma_f32_16x16x32_bf16 v[128:131], a[252:255], v[176:179], v[128:131]
v_mfma_f32_16x16x32_bf16 v[132:135], a[252:255], v[180:183], v[132:135]
s_waitcnt vmcnt(23)
v_mfma_f32_16x16x32_bf16 v[136:139], v[224:227], v[168:171], v[136:139]
v_mfma_f32_16x16x32_bf16 v[140:143], v[224:227], v[172:175], v[140:143]
v_mfma_f32_16x16x32_bf16 v[144:147], v[224:227], v[176:179], v[144:147]
v_mfma_f32_16x16x32_bf16 v[148:151], v[224:227], v[180:183], v[148:151]
s_waitcnt vmcnt(22) lgkmcnt(4)
v_mfma_f32_16x16x32_bf16 v[104:107], v[228:231], v[184:187], v[104:107]
ds_read_b128 v[168:171], v4 offset:49152
s_add_u32 s92, s92, 4096
s_addc_u32 s93, s93, 0
global_load_dwordx4 a[168:171], v2, s[92:93] offset:0
v_mfma_f32_16x16x32_bf16 v[108:111], v[228:231], v[188:191], v[108:111]
ds_read_b128 v[172:175], v4 offset:49408
s_waitcnt vmcnt(11)
v_mfma_f32_16x16x32_bf16 v[112:115], v[228:231], v[192:195], v[112:115]
ds_read_b128 v[176:179], v4 offset:49664
v_add_f32 v92, v92, v64
v_mfma_f32_16x16x32_bf16 v[116:119], v[228:231], v[196:199], v[116:119]
ds_read_b128 v[180:183], v4 offset:49920
v_add_f32 v93, v93, v65
v_mfma_f32_16x16x32_bf16 v[120:123], v[232:235], v[184:187], v[120:123]
v_add_f32 v94, v94, v66
v_add_f32 v95, v95, v67
v_mfma_f32_16x16x32_bf16 v[124:127], v[232:235], v[188:191], v[124:127]
v_add_f32 v96, v96, v68
v_add_f32 v97, v97, v69
v_mfma_f32_16x16x32_bf16 v[128:131], v[232:235], v[192:195], v[128:131]
v_add_f32 v98, v98, v70
v_add_f32 v99, v99, v71
v_mfma_f32_16x16x32_bf16 v[132:135], v[232:235], v[196:199], v[132:135]
v_add_f32 v100, v100, v72
v_add_f32 v101, v101, v73
v_mfma_f32_16x16x32_bf16 v[136:139], v[236:239], v[184:187], v[136:139]
v_add_f32 v102, v102, v74
v_add_f32 v103, v103, v75
v_mfma_f32_16x16x32_bf16 v[140:143], v[236:239], v[188:191], v[140:143]
s_add_u32 s96, s96, 6144
v_mfma_f32_16x16x32_bf16 v[144:147], v[236:239], v[192:195], v[144:147]
buffer_load_dwordx4 v[64:67], v80, s[16:19], s96 offen offset:0 sc1
v_mfma_f32_16x16x32_bf16 v[148:151], v[236:239], v[196:199], v[148:151]
buffer_load_dwordx4 v[68:71], v80, s[16:19], s96 offen offset:256 sc1
s_waitcnt lgkmcnt(4)
v_mfma_f32_16x16x32_bf16 v[104:107], v[240:243], v[152:155], v[104:107]
ds_read_b128 v[184:187], v5 offset:49152
global_load_dwordx4 a[172:175], v2, s[92:93] offset:1024
v_mfma_f32_16x16x32_bf16 v[108:111], v[240:243], v[156:159], v[108:111]
ds_read_b128 v[188:191], v5 offset:49408
buffer_load_dwordx4 v[72:75], v80, s[16:19], s96 offen offset:512 sc1
v_mfma_f32_16x16x32_bf16 v[112:115], v[240:243], v[160:163], v[112:115]
ds_read_b128 v[192:195], v5 offset:49664
global_load_dwordx4 a[176:179], v2, s[92:93] offset:2048
v_mfma_f32_16x16x32_bf16 v[116:119], v[240:243], v[164:167], v[116:119]
ds_read_b128 v[196:199], v5 offset:49920
global_load_dwordx4 a[180:183], v2, s[92:93] offset:3072
v_mfma_f32_16x16x32_bf16 v[120:123], v[244:247], v[152:155], v[120:123]
s_lshl_b32 s26, s22, 13
s_lshl_b32 s31, s20, 11
v_mfma_f32_16x16x32_bf16 v[124:127], v[244:247], v[156:159], v[124:127]
s_add_u32 s26, s26, s31
s_add_u32 s26, s26, s24
v_mfma_f32_16x16x32_bf16 v[128:131], v[244:247], v[160:163], v[128:131]
s_add_u32 s26, s26, 81920
v_mfma_f32_16x16x32_bf16 v[132:135], v[244:247], v[164:167], v[132:135]
buffer_load_dword v62, v29, s[16:19], s26 offen sc1
v_mfma_f32_16x16x32_bf16 v[136:139], v[248:251], v[152:155], v[136:139]
s_add_u32 s92, s92, 4096
s_addc_u32 s93, s93, 0
global_load_dwordx4 a[184:187], v2, s[92:93] offset:0
v_mfma_f32_16x16x32_bf16 v[140:143], v[248:251], v[156:159], v[140:143]
global_load_dwordx4 a[188:191], v2, s[92:93] offset:1024
v_mfma_f32_16x16x32_bf16 v[144:147], v[248:251], v[160:163], v[144:147]
v_mfma_f32_16x16x32_bf16 v[148:151], v[248:251], v[164:167], v[148:151]
s_waitcnt lgkmcnt(4)
v_mfma_f32_16x16x32_bf16 v[104:107], v[252:255], v[168:171], v[104:107]
ds_read_b128 v[152:155], v6 offset:49152
global_load_dwordx4 a[192:195], v2, s[92:93] offset:2048
v_mfma_f32_16x16x32_bf16 v[108:111], v[252:255], v[172:175], v[108:111]
ds_read_b128 v[156:159], v6 offset:49408
global_load_dwordx4 a[196:199], v2, s[92:93] offset:3072
v_mfma_f32_16x16x32_bf16 v[112:115], v[252:255], v[176:179], v[112:115]
ds_read_b128 v[160:163], v6 offset:49664
s_add_u32 s92, s92, 4096
s_addc_u32 s93, s93, 0
global_load_dwordx4 a[200:203], v2, s[92:93] offset:0
v_mfma_f32_16x16x32_bf16 v[116:119], v[252:255], v[180:183], v[116:119]
ds_read_b128 v[164:167], v6 offset:49920
s_waitcnt vmcnt(22)
v_mfma_f32_16x16x32_bf16 v[120:123], a[128:131], v[168:171], v[120:123]
v_mfma_f32_16x16x32_bf16 v[124:127], a[128:131], v[172:175], v[124:127]
v_mfma_f32_16x16x32_bf16 v[128:131], a[128:131], v[176:179], v[128:131]
v_mfma_f32_16x16x32_bf16 v[132:135], a[128:131], v[180:183], v[132:135]
s_waitcnt vmcnt(21)
v_mfma_f32_16x16x32_bf16 v[136:139], a[132:135], v[168:171], v[136:139]
v_mfma_f32_16x16x32_bf16 v[140:143], a[132:135], v[172:175], v[140:143]
v_mfma_f32_16x16x32_bf16 v[144:147], a[132:135], v[176:179], v[144:147]
v_mfma_f32_16x16x32_bf16 v[148:151], a[132:135], v[180:183], v[148:151]
s_barrier
s_waitcnt vmcnt(20) lgkmcnt(4)
v_mfma_f32_16x16x32_bf16 v[104:107], a[136:139], v[184:187], v[104:107]
ds_read_b128 v[168:171], v7 offset:0
global_load_dwordx4 a[204:207], v2, s[92:93] offset:1024
v_mfma_f32_16x16x32_bf16 v[108:111], a[136:139], v[188:191], v[108:111]
ds_read_b128 v[172:175], v7 offset:256
global_load_dwordx4 a[208:211], v2, s[92:93] offset:2048
v_mfma_f32_16x16x32_bf16 v[112:115], a[136:139], v[192:195], v[112:115]
ds_read_b128 v[176:179], v7 offset:512
global_load_dwordx4 a[212:215], v2, s[92:93] offset:3072
v_mfma_f32_16x16x32_bf16 v[116:119], a[136:139], v[196:199], v[116:119]
ds_read_b128 v[180:183], v7 offset:768
s_waitcnt vmcnt(22)
v_mfma_f32_16x16x32_bf16 v[120:123], a[140:143], v[184:187], v[120:123]
v_mfma_f32_16x16x32_bf16 v[124:127], a[140:143], v[188:191], v[124:127]
v_mfma_f32_16x16x32_bf16 v[128:131], a[140:143], v[192:195], v[128:131]
v_mfma_f32_16x16x32_bf16 v[132:135], a[140:143], v[196:199], v[132:135]
s_waitcnt vmcnt(21)
v_mfma_f32_16x16x32_bf16 v[136:139], a[144:147], v[184:187], v[136:139]
v_mfma_f32_16x16x32_bf16 v[140:143], a[144:147], v[188:191], v[140:143]
v_mfma_f32_16x16x32_bf16 v[144:147], a[144:147], v[192:195], v[144:147]
v_mfma_f32_16x16x32_bf16 v[148:151], a[144:147], v[196:199], v[148:151]
s_waitcnt vmcnt(20) lgkmcnt(4)
v_mfma_f32_16x16x32_bf16 v[104:107], a[148:151], v[152:155], v[104:107]
ds_read_b128 v[184:187], v8 offset:0
s_add_u32 s92, s92, 4096
s_addc_u32 s93, s93, 0
global_load_dwordx4 a[216:219], v2, s[92:93] offset:0
v_mfma_f32_16x16x32_bf16 v[108:111], a[148:151], v[156:159], v[108:111]
ds_read_b128 v[188:191], v8 offset:256
s_waitcnt vmcnt(12)
v_mfma_f32_16x16x32_bf16 v[112:115], a[148:151], v[160:163], v[112:115]
ds_read_b128 v[192:195], v8 offset:512
v_add_f32 v92, v92, v64
v_mfma_f32_16x16x32_bf16 v[116:119], a[148:151], v[164:167], v[116:119]
ds_read_b128 v[196:199], v8 offset:768
v_add_f32 v93, v93, v65
v_mfma_f32_16x16x32_bf16 v[120:123], a[152:155], v[152:155], v[120:123]
v_add_f32 v94, v94, v66
v_add_f32 v95, v95, v67
v_mfma_f32_16x16x32_bf16 v[124:127], a[152:155], v[156:159], v[124:127]
v_add_f32 v96, v96, v68
v_add_f32 v97, v97, v69
v_mfma_f32_16x16x32_bf16 v[128:131], a[152:155], v[160:163], v[128:131]
v_add_f32 v98, v98, v70
v_add_f32 v99, v99, v71
v_mfma_f32_16x16x32_bf16 v[132:135], a[152:155], v[164:167], v[132:135]
v_add_f32 v100, v100, v72
v_add_f32 v101, v101, v73
v_mfma_f32_16x16x32_bf16 v[136:139], a[156:159], v[152:155], v[136:139]
v_add_f32 v102, v102, v74
v_add_f32 v103, v103, v75
v_mfma_f32_16x16x32_bf16 v[140:143], a[156:159], v[156:159], v[140:143]
s_add_u32 s96, s96, 6144
v_mfma_f32_16x16x32_bf16 v[144:147], a[156:159], v[160:163], v[144:147]
buffer_load_dwordx4 v[64:67], v80, s[16:19], s96 offen offset:0 sc1
v_mfma_f32_16x16x32_bf16 v[148:151], a[156:159], v[164:167], v[148:151]
buffer_load_dwordx4 v[68:71], v80, s[16:19], s96 offen offset:256 sc1
s_waitcnt lgkmcnt(4)
v_mfma_f32_16x16x32_bf16 v[104:107], a[160:163], v[168:171], v[104:107]
ds_read_b128 v[152:155], v9 offset:0
global_load_dwordx4 a[220:223], v2, s[92:93] offset:1024
v_mfma_f32_16x16x32_bf16 v[108:111], a[160:163], v[172:175], v[108:111]
ds_read_b128 v[156:159], v9 offset:256
buffer_load_dwordx4 v[72:75], v80, s[16:19], s96 offen offset:512 sc1
v_mfma_f32_16x16x32_bf16 v[112:115], a[160:163], v[176:179], v[112:115]
ds_read_b128 v[160:163], v9 offset:512
global_load_dwordx4 a[224:227], v2, s[92:93] offset:2048
v_mfma_f32_16x16x32_bf16 v[116:119], a[160:163], v[180:183], v[116:119]
ds_read_b128 v[164:167], v9 offset:768
global_load_dwordx4 a[228:231], v2, s[92:93] offset:3072
v_mfma_f32_16x16x32_bf16 v[120:123], a[164:167], v[168:171], v[120:123]
ds_read_b128 v[200:203], v22 offset:0
ds_read_b128 v[204:207], v22 offset:256
v_mfma_f32_16x16x32_bf16 v[124:127], a[164:167], v[172:175], v[124:127]
ds_read_b128 v[208:211], v22 offset:512
ds_read_b128 v[212:215], v22 offset:768
v_mfma_f32_16x16x32_bf16 v[128:131], a[164:167], v[176:179], v[128:131]
s_add_u32 s92, s92, 4096
s_addc_u32 s93, s93, 0
global_load_dwordx4 a[232:235], v2, s[92:93] offset:0
v_mfma_f32_16x16x32_bf16 v[132:135], a[164:167], v[180:183], v[132:135]
global_load_dwordx4 a[236:239], v2, s[92:93] offset:1024
v_mfma_f32_16x16x32_bf16 v[136:139], a[168:171], v[168:171], v[136:139]
v_mfma_f32_16x16x32_bf16 v[140:143], a[168:171], v[172:175], v[140:143]
v_mfma_f32_16x16x32_bf16 v[144:147], a[168:171], v[176:179], v[144:147]
v_mfma_f32_16x16x32_bf16 v[148:151], a[168:171], v[180:183], v[148:151]
s_waitcnt lgkmcnt(8)
v_mfma_f32_16x16x32_bf16 v[104:107], a[172:175], v[184:187], v[104:107]
ds_read_b128 v[168:171], v10 offset:0
global_load_dwordx4 a[240:243], v2, s[92:93] offset:2048
v_mfma_f32_16x16x32_bf16 v[108:111], a[172:175], v[188:191], v[108:111]
ds_read_b128 v[172:175], v10 offset:256
global_load_dwordx4 a[244:247], v2, s[92:93] offset:3072
v_mfma_f32_16x16x32_bf16 v[112:115], a[172:175], v[192:195], v[112:115]
ds_read_b128 v[176:179], v10 offset:512
s_add_u32 s92, s92, 4096
s_addc_u32 s93, s93, 0
global_load_dwordx4 a[248:251], v2, s[92:93] offset:0
v_mfma_f32_16x16x32_bf16 v[116:119], a[172:175], v[196:199], v[116:119]
ds_read_b128 v[180:183], v10 offset:768
s_waitcnt vmcnt(22)
v_mfma_f32_16x16x32_bf16 v[120:123], a[176:179], v[184:187], v[120:123]
v_mfma_f32_16x16x32_bf16 v[124:127], a[176:179], v[188:191], v[124:127]
v_mfma_f32_16x16x32_bf16 v[128:131], a[176:179], v[192:195], v[128:131]
v_mfma_f32_16x16x32_bf16 v[132:135], a[176:179], v[196:199], v[132:135]
s_waitcnt vmcnt(21)
v_mfma_f32_16x16x32_bf16 v[136:139], a[180:183], v[184:187], v[136:139]
v_mfma_f32_16x16x32_bf16 v[140:143], a[180:183], v[188:191], v[140:143]
v_mfma_f32_16x16x32_bf16 v[144:147], a[180:183], v[192:195], v[144:147]
v_mfma_f32_16x16x32_bf16 v[148:151], a[180:183], v[196:199], v[148:151]
s_waitcnt vmcnt(19) lgkmcnt(8)
v_mfma_f32_16x16x32_bf16 v[104:107], a[184:187], v[152:155], v[104:107]
global_load_dwordx4 a[252:255], v2, s[92:93] offset:1024
v_mfma_f32_16x16x32_bf16 v[108:111], a[184:187], v[156:159], v[108:111]
global_load_dwordx4 v[224:227], v2, s[92:93] offset:2048
v_mfma_f32_16x16x32_bf16 v[112:115], a[184:187], v[160:163], v[112:115]
global_load_dwordx4 v[228:231], v2, s[92:93] offset:3072
v_mfma_f32_16x16x32_bf16 v[116:119], a[184:187], v[164:167], v[116:119]
s_waitcnt vmcnt(21)
v_mfma_f32_16x16x32_bf16 v[120:123], a[188:191], v[152:155], v[120:123]
v_mfma_f32_16x16x32_bf16 v[124:127], a[188:191], v[156:159], v[124:127]
v_mfma_f32_16x16x32_bf16 v[128:131], a[188:191], v[160:163], v[128:131]
v_mfma_f32_16x16x32_bf16 v[132:135], a[188:191], v[164:167], v[132:135]
s_waitcnt vmcnt(20)
v_mfma_f32_16x16x32_bf16 v[136:139], a[192:195], v[152:155], v[136:139]
v_mfma_f32_16x16x32_bf16 v[140:143], a[192:195], v[156:159], v[140:143]
v_mfma_f32_16x16x32_bf16 v[144:147], a[192:195], v[160:163], v[144:147]
v_mfma_f32_16x16x32_bf16 v[148:151], a[192:195], v[164:167], v[148:151]
s_waitcnt vmcnt(19) lgkmcnt(0)
v_mfma_f32_16x16x32_bf16 v[104:107], a[196:199], v[168:171], v[104:107]
s_add_u32 s92, s92, 4096
s_addc_u32 s93, s93, 0
global_load_dwordx4 v[232:235], v2, s[92:93] offset:0
v_mfma_f32_16x16x32_bf16 v[108:111], a[196:199], v[172:175], v[108:111]
s_waitcnt vmcnt(11)
v_add_f32 v92, v92, v64
v_mfma_f32_16x16x32_bf16 v[112:115], a[196:199], v[176:179], v[112:115]
v_add_f32 v93, v93, v65
v_add_f32 v94, v94, v66
v_mfma_f32_16x16x32_bf16 v[116:119], a[196:199], v[180:183], v[116:119]
v_add_f32 v95, v95, v67
v_add_f32 v96, v96, v68
v_mfma_f32_16x16x32_bf16 v[120:123], a[200:203], v[168:171], v[120:123]
v_add_f32 v97, v97, v69
v_add_f32 v98, v98, v70
v_mfma_f32_16x16x32_bf16 v[124:127], a[200:203], v[172:175], v[124:127]
v_add_f32 v99, v99, v71
v_add_f32 v100, v100, v72
v_mfma_f32_16x16x32_bf16 v[128:131], a[200:203], v[176:179], v[128:131]
v_add_f32 v101, v101, v73
v_add_f32 v102, v102, v74
v_mfma_f32_16x16x32_bf16 v[132:135], a[200:203], v[180:183], v[132:135]
v_add_f32 v103, v103, v75
v_mfma_f32_16x16x32_bf16 v[136:139], a[204:207], v[168:171], v[136:139]
global_load_dwordx4 v[236:239], v2, s[92:93] offset:1024
v_mfma_f32_16x16x32_bf16 v[140:143], a[204:207], v[172:175], v[140:143]
global_load_dwordx4 v[240:243], v2, s[92:93] offset:2048
v_mfma_f32_16x16x32_bf16 v[144:147], a[204:207], v[176:179], v[144:147]
v_mfma_f32_16x16x32_bf16 v[148:151], a[204:207], v[180:183], v[148:151]
s_waitcnt lgkmcnt(0)
global_load_dwordx4 v[244:247], v2, s[92:93] offset:3072
v_pk_fma_f32 v[104:105], v[92:93], v[200:201], v[104:105] op_sel_hi:[1,0,1] neg_lo:[0,1,0] neg_hi:[0,1,0]
v_pk_fma_f32 v[106:107], v[94:95], v[200:201], v[106:107] op_sel_hi:[1,0,1] neg_lo:[0,1,0] neg_hi:[0,1,0]
v_pk_mul_f32 v[172:173], v[104:105], v[104:105]
v_pk_mul_f32 v[174:175], v[106:107], v[106:107]
v_pk_fma_f32 v[172:173], v[172:173], v[202:203], v[202:203] op_sel:[0,1,0] op_sel_hi:[1,1,0]
v_pk_fma_f32 v[174:175], v[174:175], v[202:203], v[202:203] op_sel:[0,1,0] op_sel_hi:[1,1,0]
v_pk_mul_f32 v[172:173], v[172:173], v[104:105]
v_pk_mul_f32 v[174:175], v[174:175], v[106:107]
v_exp_f32 v172, v172
v_exp_f32 v173, v173
v_exp_f32 v174, v174
v_exp_f32 v175, v175
v_pk_fma_f32 v[172:173], v[172:173], v[200:201], v[200:201] op_sel:[0,1,1] op_sel_hi:[1,1,1]
v_pk_fma_f32 v[174:175], v[174:175], v[200:201], v[200:201] op_sel:[0,1,1] op_sel_hi:[1,1,1]
v_rcp_f32 v172, v172
v_rcp_f32 v173, v173
v_rcp_f32 v174, v174
v_rcp_f32 v175, v175
v_pk_mul_f32 v[104:105], v[104:105], v[172:173]
v_pk_mul_f32 v[106:107], v[106:107], v[174:175]
v_cvt_pk_bf16_f32 v176, v104, v105
v_cvt_pk_bf16_f32 v177, v106, v107
s_cmp_lg_u32 s23, 0
s_cbranch_scc1 slow_78
global_store_dwordx2 v13, v[176:177], s[16:17] offset:0
back_79:
s_add_u32 s92, s92, 4096
s_addc_u32 s93, s93, 0
global_load_dwordx4 v[248:251], v2, s[92:93] offset:0
v_pk_fma_f32 v[108:109], v[92:93], v[204:205], v[108:109] op_sel_hi:[1,0,1] neg_lo:[0,1,0] neg_hi:[0,1,0]
v_pk_fma_f32 v[110:111], v[94:95], v[204:205], v[110:111] op_sel_hi:[1,0,1] neg_lo:[0,1,0] neg_hi:[0,1,0]
v_pk_mul_f32 v[172:173], v[108:109], v[108:109]
v_pk_mul_f32 v[174:175], v[110:111], v[110:111]
v_pk_fma_f32 v[172:173], v[172:173], v[206:207], v[206:207] op_sel:[0,1,0] op_sel_hi:[1,1,0]
v_pk_fma_f32 v[174:175], v[174:175], v[206:207], v[206:207] op_sel:[0,1,0] op_sel_hi:[1,1,0]
v_pk_mul_f32 v[172:173], v[172:173], v[108:109]
v_pk_mul_f32 v[174:175], v[174:175], v[110:111]
v_exp_f32 v172, v172
v_exp_f32 v173, v173
v_exp_f32 v174, v174
v_exp_f32 v175, v175
v_pk_fma_f32 v[172:173], v[172:173], v[204:205], v[204:205] op_sel:[0,1,1] op_sel_hi:[1,1,1]
v_pk_fma_f32 v[174:175], v[174:175], v[204:205], v[204:205] op_sel:[0,1,1] op_sel_hi:[1,1,1]
v_rcp_f32 v172, v172
v_rcp_f32 v173, v173
v_rcp_f32 v174, v174
v_rcp_f32 v175, v175
v_pk_mul_f32 v[108:109], v[108:109], v[172:173]
v_pk_mul_f32 v[110:111], v[110:111], v[174:175]
v_cvt_pk_bf16_f32 v178, v108, v109
v_cvt_pk_bf16_f32 v179, v110, v111
s_cmp_lg_u32 s23, 0
s_cbranch_scc1 slow_80
global_store_dwordx2 v13, v[178:179], s[16:17] offset:256
back_81:
global_load_dwordx4 v[252:255], v2, s[92:93] offset:1024
v_pk_fma_f32 v[112:113], v[92:93], v[208:209], v[112:113] op_sel_hi:[1,0,1] neg_lo:[0,1,0] neg_hi:[0,1,0]
v_pk_fma_f32 v[114:115], v[94:95], v[208:209], v[114:115] op_sel_hi:[1,0,1] neg_lo:[0,1,0] neg_hi:[0,1,0]
v_pk_mul_f32 v[172:173], v[112:113], v[112:113]
v_pk_mul_f32 v[174:175], v[114:115], v[114:115]
v_pk_fma_f32 v[172:173], v[172:173], v[210:211], v[210:211] op_sel:[0,1,0] op_sel_hi:[1,1,0]
v_pk_fma_f32 v[174:175], v[174:175], v[210:211], v[210:211] op_sel:[0,1,0] op_sel_hi:[1,1,0]
v_pk_mul_f32 v[172:173], v[172:173], v[112:113]
v_pk_mul_f32 v[174:175], v[174:175], v[114:115]
v_exp_f32 v172, v172
v_exp_f32 v173, v173
v_exp_f32 v174, v174
v_exp_f32 v175, v175
v_pk_fma_f32 v[172:173], v[172:173], v[208:209], v[208:209] op_sel:[0,1,1] op_sel_hi:[1,1,1]
v_pk_fma_f32 v[174:175], v[174:175], v[208:209], v[208:209] op_sel:[0,1,1] op_sel_hi:[1,1,1]
v_rcp_f32 v172, v172
v_rcp_f32 v173, v173
v_rcp_f32 v174, v174
v_rcp_f32 v175, v175
v_pk_mul_f32 v[112:113], v[112:113], v[172:173]
v_pk_mul_f32 v[114:115], v[114:115], v[174:175]
v_cvt_pk_bf16_f32 v180, v112, v113
v_cvt_pk_bf16_f32 v181, v114, v115
s_cbranch_scc1 slow_82
global_store_dwordx2 v13, v[180:181], s[16:17] offset:512
back_83:
global_load_dwordx4 a[128:131], v2, s[92:93] offset:2048
v_pk_fma_f32 v[116:117], v[92:93], v[212:213], v[116:117] op_sel_hi:[1,0,1] neg_lo:[0,1,0] neg_hi:[0,1,0]
v_pk_fma_f32 v[118:119], v[94:95], v[212:213], v[118:119] op_sel_hi:[1,0,1] neg_lo:[0,1,0] neg_hi:[0,1,0]
v_pk_mul_f32 v[172:173], v[116:117], v[116:117]
v_pk_mul_f32 v[174:175], v[118:119], v[118:119]
v_pk_fma_f32 v[172:173], v[172:173], v[214:215], v[214:215] op_sel:[0,1,0] op_sel_hi:[1,1,0]
v_pk_fma_f32 v[174:175], v[174:175], v[214:215], v[214:215] op_sel:[0,1,0] op_sel_hi:[1,1,0]
v_pk_mul_f32 v[172:173], v[172:173], v[116:117]
v_pk_mul_f32 v[174:175], v[174:175], v[118:119]
v_exp_f32 v172, v172
v_exp_f32 v173, v173
v_exp_f32 v174, v174
v_exp_f32 v175, v175
v_pk_fma_f32 v[172:173], v[172:173], v[212:213], v[212:213] op_sel:[0,1,1] op_sel_hi:[1,1,1]
v_pk_fma_f32 v[174:175], v[174:175], v[212:213], v[212:213] op_sel:[0,1,1] op_sel_hi:[1,1,1]
v_rcp_f32 v172, v172
v_rcp_f32 v173, v173
v_rcp_f32 v174, v174
v_rcp_f32 v175, v175
v_pk_mul_f32 v[116:117], v[116:117], v[172:173]
v_pk_mul_f32 v[118:119], v[118:119], v[174:175]
v_cvt_pk_bf16_f32 v182, v116, v117
v_cvt_pk_bf16_f32 v183, v118, v119
s_cbranch_scc1 slow_84
global_store_dwordx2 v13, v[182:183], s[16:17] offset:768
back_85:
global_load_dwordx4 a[132:135], v2, s[92:93] offset:3072
v_pk_fma_f32 v[120:121], v[96:97], v[200:201], v[120:121] op_sel_hi:[1,0,1] neg_lo:[0,1,0] neg_hi:[0,1,0]
v_pk_fma_f32 v[122:123], v[98:99], v[200:201], v[122:123] op_sel_hi:[1,0,1] neg_lo:[0,1,0] neg_hi:[0,1,0]
v_pk_mul_f32 v[172:173], v[120:121], v[120:121]
v_pk_mul_f32 v[174:175], v[122:123], v[122:123]
v_pk_fma_f32 v[172:173], v[172:173], v[202:203], v[202:203] op_sel:[0,1,0] op_sel_hi:[1,1,0]
v_pk_fma_f32 v[174:175], v[174:175], v[202:203], v[202:203] op_sel:[0,1,0] op_sel_hi:[1,1,0]
v_pk_mul_f32 v[172:173], v[172:173], v[120:121]
v_pk_mul_f32 v[174:175], v[174:175], v[122:123]
v_exp_f32 v172, v172
v_exp_f32 v173, v173
v_exp_f32 v174, v174
v_exp_f32 v175, v175
v_pk_fma_f32 v[172:173], v[172:173], v[200:201], v[200:201] op_sel:[0,1,1] op_sel_hi:[1,1,1]
v_pk_fma_f32 v[174:175], v[174:175], v[200:201], v[200:201] op_sel:[0,1,1] op_sel_hi:[1,1,1]
v_rcp_f32 v172, v172
v_rcp_f32 v173, v173
v_rcp_f32 v174, v174
v_rcp_f32 v175, v175
v_pk_mul_f32 v[120:121], v[120:121], v[172:173]
v_pk_mul_f32 v[122:123], v[122:123], v[174:175]
v_cvt_pk_bf16_f32 v184, v120, v121
v_cvt_pk_bf16_f32 v185, v122, v123
s_cbranch_scc1 slow_86
global_store_dwordx2 v13, v[184:185], s[84:85] offset:0
back_87:
s_add_u32 s92, s92, 4096
s_addc_u32 s93, s93, 0
global_load_dwordx4 a[136:139], v2, s[92:93] offset:0
v_pk_fma_f32 v[124:125], v[96:97], v[204:205], v[124:125] op_sel_hi:[1,0,1] neg_lo:[0,1,0] neg_hi:[0,1,0]
v_pk_fma_f32 v[126:127], v[98:99], v[204:205], v[126:127] op_sel_hi:[1,0,1] neg_lo:[0,1,0] neg_hi:[0,1,0]
v_pk_mul_f32 v[172:173], v[124:125], v[124:125]
v_pk_mul_f32 v[174:175], v[126:127], v[126:127]
v_pk_fma_f32 v[172:173], v[172:173], v[206:207], v[206:207] op_sel:[0,1,0] op_sel_hi:[1,1,0]
v_pk_fma_f32 v[174:175], v[174:175], v[206:207], v[206:207] op_sel:[0,1,0] op_sel_hi:[1,1,0]
v_pk_mul_f32 v[172:173], v[172:173], v[124:125]
v_pk_mul_f32 v[174:175], v[174:175], v[126:127]
v_exp_f32 v172, v172
v_exp_f32 v173, v173
v_exp_f32 v174, v174
v_exp_f32 v175, v175
v_pk_fma_f32 v[172:173], v[172:173], v[204:205], v[204:205] op_sel:[0,1,1] op_sel_hi:[1,1,1]
v_pk_fma_f32 v[174:175], v[174:175], v[204:205], v[204:205] op_sel:[0,1,1] op_sel_hi:[1,1,1]
v_rcp_f32 v172, v172
v_rcp_f32 v173, v173
v_rcp_f32 v174, v174
v_rcp_f32 v175, v175
v_pk_mul_f32 v[124:125], v[124:125], v[172:173]
v_pk_mul_f32 v[126:127], v[126:127], v[174:175]
v_cvt_pk_bf16_f32 v186, v124, v125
v_cvt_pk_bf16_f32 v187, v126, v127
s_cmp_lg_u32 s23, 0
s_cbranch_scc1 slow_88
global_store_dwordx2 v13, v[186:187], s[84:85] offset:256
back_89:
global_load_dwordx4 a[140:143], v2, s[92:93] offset:1024
v_pk_fma_f32 v[128:129], v[96:97], v[208:209], v[128:129] op_sel_hi:[1,0,1] neg_lo:[0,1,0] neg_hi:[0,1,0]
v_pk_fma_f32 v[130:131], v[98:99], v[208:209], v[130:131] op_sel_hi:[1,0,1] neg_lo:[0,1,0] neg_hi:[0,1,0]
v_pk_mul_f32 v[172:173], v[128:129], v[128:129]
v_pk_mul_f32 v[174:175], v[130:131], v[130:131]
v_pk_fma_f32 v[172:173], v[172:173], v[210:211], v[210:211] op_sel:[0,1,0] op_sel_hi:[1,1,0]
v_pk_fma_f32 v[174:175], v[174:175], v[210:211], v[210:211] op_sel:[0,1,0] op_sel_hi:[1,1,0]
v_pk_mul_f32 v[172:173], v[172:173], v[128:129]
v_pk_mul_f32 v[174:175], v[174:175], v[130:131]
v_exp_f32 v172, v172
v_exp_f32 v173, v173
v_exp_f32 v174, v174
v_exp_f32 v175, v175
v_pk_fma_f32 v[172:173], v[172:173], v[208:209], v[208:209] op_sel:[0,1,1] op_sel_hi:[1,1,1]
v_pk_fma_f32 v[174:175], v[174:175], v[208:209], v[208:209] op_sel:[0,1,1] op_sel_hi:[1,1,1]
v_rcp_f32 v172, v172
v_rcp_f32 v173, v173
v_rcp_f32 v174, v174
v_rcp_f32 v175, v175
v_pk_mul_f32 v[128:129], v[128:129], v[172:173]
v_pk_mul_f32 v[130:131], v[130:131], v[174:175]
v_cvt_pk_bf16_f32 v188, v128, v129
v_cvt_pk_bf16_f32 v189, v130, v131
s_cbranch_scc1 slow_90
global_store_dwordx2 v13, v[188:189], s[84:85] offset:512
back_91:
global_load_dwordx4 a[144:147], v2, s[92:93] offset:2048
v_pk_fma_f32 v[132:133], v[96:97], v[212:213], v[132:133] op_sel_hi:[1,0,1] neg_lo:[0,1,0] neg_hi:[0,1,0]
v_pk_fma_f32 v[134:135], v[98:99], v[212:213], v[134:135] op_sel_hi:[1,0,1] neg_lo:[0,1,0] neg_hi:[0,1,0]
v_pk_mul_f32 v[172:173], v[132:133], v[132:133]
v_pk_mul_f32 v[174:175], v[134:135], v[134:135]
v_pk_fma_f32 v[172:173], v[172:173], v[214:215], v[214:215] op_sel:[0,1,0] op_sel_hi:[1,1,0]
v_pk_fma_f32 v[174:175], v[174:175], v[214:215], v[214:215] op_sel:[0,1,0] op_sel_hi:[1,1,0]
v_pk_mul_f32 v[172:173], v[172:173], v[132:133]
v_pk_mul_f32 v[174:175], v[174:175], v[134:135]
v_exp_f32 v172, v172
v_exp_f32 v173, v173
v_exp_f32 v174, v174
v_exp_f32 v175, v175
v_pk_fma_f32 v[172:173], v[172:173], v[212:213], v[212:213] op_sel:[0,1,1] op_sel_hi:[1,1,1]
v_pk_fma_f32 v[174:175], v[174:175], v[212:213], v[212:213] op_sel:[0,1,1] op_sel_hi:[1,1,1]
v_rcp_f32 v172, v172
v_rcp_f32 v173, v173
v_rcp_f32 v174, v174
v_rcp_f32 v175, v175
v_pk_mul_f32 v[132:133], v[132:133], v[172:173]
v_pk_mul_f32 v[134:135], v[134:135], v[174:175]
v_cvt_pk_bf16_f32 v190, v132, v133
v_cvt_pk_bf16_f32 v191, v134, v135
s_cbranch_scc1 slow_92
global_store_dwordx2 v13, v[190:191], s[84:85] offset:768
back_93:
global_load_dwordx4 a[148:151], v2, s[92:93] offset:3072
v_pk_fma_f32 v[136:137], v[100:101], v[200:201], v[136:137] op_sel_hi:[1,0,1] neg_lo:[0,1,0] neg_hi:[0,1,0]
v_pk_fma_f32 v[138:139], v[102:103], v[200:201], v[138:139] op_sel_hi:[1,0,1] neg_lo:[0,1,0] neg_hi:[0,1,0]
v_pk_mul_f32 v[172:173], v[136:137], v[136:137]
v_pk_mul_f32 v[174:175], v[138:139], v[138:139]
v_pk_fma_f32 v[172:173], v[172:173], v[202:203], v[202:203] op_sel:[0,1,0] op_sel_hi:[1,1,0]
v_pk_fma_f32 v[174:175], v[174:175], v[202:203], v[202:203] op_sel:[0,1,0] op_sel_hi:[1,1,0]
v_pk_mul_f32 v[172:173], v[172:173], v[136:137]
v_pk_mul_f32 v[174:175], v[174:175], v[138:139]
v_exp_f32 v172, v172
v_exp_f32 v173, v173
v_exp_f32 v174, v174
v_exp_f32 v175, v175
v_pk_fma_f32 v[172:173], v[172:173], v[200:201], v[200:201] op_sel:[0,1,1] op_sel_hi:[1,1,1]
v_pk_fma_f32 v[174:175], v[174:175], v[200:201], v[200:201] op_sel:[0,1,1] op_sel_hi:[1,1,1]
v_rcp_f32 v172, v172
v_rcp_f32 v173, v173
v_rcp_f32 v174, v174
v_rcp_f32 v175, v175
v_pk_mul_f32 v[136:137], v[136:137], v[172:173]
v_pk_mul_f32 v[138:139], v[138:139], v[174:175]
v_cvt_pk_bf16_f32 v192, v136, v137
v_cvt_pk_bf16_f32 v193, v138, v139
s_cbranch_scc1 slow_94
global_store_dwordx2 v13, v[192:193], s[10:11] offset:0
back_95:
s_add_u32 s92, s92, 4096
s_addc_u32 s93, s93, 0
global_load_dwordx4 a[152:155], v2, s[92:93] offset:0
v_pk_fma_f32 v[140:141], v[100:101], v[204:205], v[140:141] op_sel_hi:[1,0,1] neg_lo:[0,1,0] neg_hi:[0,1,0]
v_pk_fma_f32 v[142:143], v[102:103], v[204:205], v[142:143] op_sel_hi:[1,0,1] neg_lo:[0,1,0] neg_hi:[0,1,0]
v_pk_mul_f32 v[172:173], v[140:141], v[140:141]
v_pk_mul_f32 v[174:175], v[142:143], v[142:143]
v_pk_fma_f32 v[172:173], v[172:173], v[206:207], v[206:207] op_sel:[0,1,0] op_sel_hi:[1,1,0]
v_pk_fma_f32 v[174:175], v[174:175], v[206:207], v[206:207] op_sel:[0,1,0] op_sel_hi:[1,1,0]
v_pk_mul_f32 v[172:173], v[172:173], v[140:141]
v_pk_mul_f32 v[174:175], v[174:175], v[142:143]
v_exp_f32 v172, v172
v_exp_f32 v173, v173
v_exp_f32 v174, v174
v_exp_f32 v175, v175
v_pk_fma_f32 v[172:173], v[172:173], v[204:205], v[204:205] op_sel:[0,1,1] op_sel_hi:[1,1,1]
v_pk_fma_f32 v[174:175], v[174:175], v[204:205], v[204:205] op_sel:[0,1,1] op_sel_hi:[1,1,1]
v_rcp_f32 v172, v172
v_rcp_f32 v173, v173
v_rcp_f32 v174, v174
v_rcp_f32 v175, v175
v_pk_mul_f32 v[140:141], v[140:141], v[172:173]
v_pk_mul_f32 v[142:143], v[142:143], v[174:175]
v_cvt_pk_bf16_f32 v194, v140, v141
v_cvt_pk_bf16_f32 v195, v142, v143
s_cmp_lg_u32 s23, 0
s_cbranch_scc1 slow_96
global_store_dwordx2 v13, v[194:195], s[10:11] offset:256
back_97:
global_load_dwordx4 a[156:159], v2, s[92:93] offset:1024
v_pk_fma_f32 v[144:145], v[100:101], v[208:209], v[144:145] op_sel_hi:[1,0,1] neg_lo:[0,1,0] neg_hi:[0,1,0]
v_pk_fma_f32 v[146:147], v[102:103], v[208:209], v[146:147] op_sel_hi:[1,0,1] neg_lo:[0,1,0] neg_hi:[0,1,0]
v_pk_mul_f32 v[172:173], v[144:145], v[144:145]
v_pk_mul_f32 v[174:175], v[146:147], v[146:147]
v_pk_fma_f32 v[172:173], v[172:173], v[210:211], v[210:211] op_sel:[0,1,0] op_sel_hi:[1,1,0]
v_pk_fma_f32 v[174:175], v[174:175], v[210:211], v[210:211] op_sel:[0,1,0] op_sel_hi:[1,1,0]
v_pk_mul_f32 v[172:173], v[172:173], v[144:145]
v_pk_mul_f32 v[174:175], v[174:175], v[146:147]
v_exp_f32 v172, v172
v_exp_f32 v173, v173
v_exp_f32 v174, v174
v_exp_f32 v175, v175
v_pk_fma_f32 v[172:173], v[172:173], v[208:209], v[208:209] op_sel:[0,1,1] op_sel_hi:[1,1,1]
v_pk_fma_f32 v[174:175], v[174:175], v[208:209], v[208:209] op_sel:[0,1,1] op_sel_hi:[1,1,1]
v_rcp_f32 v172, v172
v_rcp_f32 v173, v173
v_rcp_f32 v174, v174
v_rcp_f32 v175, v175
v_pk_mul_f32 v[144:145], v[144:145], v[172:173]
v_pk_mul_f32 v[146:147], v[146:147], v[174:175]
v_cvt_pk_bf16_f32 v196, v144, v145
v_cvt_pk_bf16_f32 v197, v146, v147
s_cbranch_scc1 slow_98
global_store_dwordx2 v13, v[196:197], s[10:11] offset:512
back_99:
global_load_dwordx4 a[160:163], v2, s[92:93] offset:2048
v_pk_fma_f32 v[148:149], v[100:101], v[212:213], v[148:149] op_sel_hi:[1,0,1] neg_lo:[0,1,0] neg_hi:[0,1,0]
v_pk_fma_f32 v[150:151], v[102:103], v[212:213], v[150:151] op_sel_hi:[1,0,1] neg_lo:[0,1,0] neg_hi:[0,1,0]
v_pk_mul_f32 v[172:173], v[148:149], v[148:149]
v_pk_mul_f32 v[174:175], v[150:151], v[150:151]
v_pk_fma_f32 v[172:173], v[172:173], v[214:215], v[214:215] op_sel:[0,1,0] op_sel_hi:[1,1,0]
v_pk_fma_f32 v[174:175], v[174:175], v[214:215], v[214:215] op_sel:[0,1,0] op_sel_hi:[1,1,0]
v_pk_mul_f32 v[172:173], v[172:173], v[148:149]
v_pk_mul_f32 v[174:175], v[174:175], v[150:151]
v_exp_f32 v172, v172
v_exp_f32 v173, v173
v_exp_f32 v174, v174
v_exp_f32 v175, v175
v_pk_fma_f32 v[172:173], v[172:173], v[212:213], v[212:213] op_sel:[0,1,1] op_sel_hi:[1,1,1]
v_pk_fma_f32 v[174:175], v[174:175], v[212:213], v[212:213] op_sel:[0,1,1] op_sel_hi:[1,1,1]
v_rcp_f32 v172, v172
v_rcp_f32 v173, v173
v_rcp_f32 v174, v174
v_rcp_f32 v175, v175
v_pk_mul_f32 v[148:149], v[148:149], v[172:173]
v_pk_mul_f32 v[150:151], v[150:151], v[174:175]
v_cvt_pk_bf16_f32 v198, v148, v149
v_cvt_pk_bf16_f32 v199, v150, v151
s_cbranch_scc1 slow_100
global_store_dwordx2 v13, v[198:199], s[10:11] offset:768
back_101:
global_load_dwordx4 a[164:167], v2, s[92:93] offset:3072
s_add_u32 s92, s92, 4096
s_addc_u32 s93, s93, 0
global_load_dwordx4 a[168:171], v2, s[92:93] offset:0
global_load_dwordx4 a[172:175], v2, s[92:93] offset:1024
global_load_dwordx4 a[176:179], v2, s[92:93] offset:2048
v_lshlrev_b32 v64, 16, v42
v_and_b32 v65, s64, v42
v_lshlrev_b32 v66, 16, v43
v_and_b32 v67, s64, v43
v_lshlrev_b32 v68, 16, v44
v_and_b32 v69, s64, v44
v_lshlrev_b32 v70, 16, v45
v_and_b32 v71, s64, v45
v_lshlrev_b32 v72, 16, v46
v_and_b32 v73, s64, v46
v_lshlrev_b32 v74, 16, v47
v_and_b32 v75, s64, v47
v_lshlrev_b32 v76, 16, v48
v_and_b32 v77, s64, v48
v_lshlrev_b32 v78, 16, v49
v_and_b32 v79, s64, v49
v_lshlrev_b32 v80, 16, v50
v_and_b32 v81, s64, v50
v_lshlrev_b32 v82, 16, v51
v_and_b32 v83, s64, v51
v_lshlrev_b32 v152, 16, v52
v_and_b32 v153, s64, v52
v_lshlrev_b32 v154, 16, v53
v_and_b32 v155, s64, v53
v_lshlrev_b32 v156, 16, v54
v_and_b32 v157, s64, v54
v_lshlrev_b32 v158, 16, v55
v_and_b32 v159, s64, v55
v_lshlrev_b32 v160, 16, v56
v_and_b32 v161, s64, v56
v_lshlrev_b32 v162, 16, v57
v_and_b32 v163, s64, v57
v_lshlrev_b32 v164, 16, v58
v_and_b32 v165, s64, v58
v_lshlrev_b32 v166, 16, v59
v_and_b32 v167, s64, v59
v_lshlrev_b32 v168, 16, v60
v_and_b32 v169, s64, v60
v_lshlrev_b32 v170, 16, v61
v_and_b32 v171, s64, v61
v_pk_add_f32 v[64:65], v[64:65], v[152:153]
v_pk_add_f32 v[66:67], v[66:67], v[154:155]
v_pk_add_f32 v[68:69], v[68:69], v[156:157]
v_pk_add_f32 v[70:71], v[70:71], v[158:159]
v_pk_add_f32 v[72:73], v[72:73], v[160:161]
v_pk_add_f32 v[74:75], v[74:75], v[162:163]
v_pk_add_f32 v[76:77], v[76:77], v[164:165]
v_pk_add_f32 v[78:79], v[78:79], v[166:167]
v_pk_add_f32 v[80:81], v[80:81], v[168:169]
v_pk_add_f32 v[82:83], v[82:83], v[170:171]
s_add_u32 s26, s75, 6
v_mov_b32 v63, s26
s_waitcnt vmcnt(4) lgkmcnt(0)
s_barrier
s_cmp_lg_u32 s23, 0
s_cbranch_scc1 slow_102
buffer_store_dword v63, v17, s[16:19], s27 offen
back_103:
s_add_u32 s73, s38, 81920
s_add_u32 s73, s73, s24
s_add_u32 s90, s16, s73
s_addc_u32 s91, s17, 0
s_mov_b32 m0, s38
s_mov_b32 s36, 0
s_add_u32 s26, s75, 6
poll_104:
global_load_dword v63, v16, s[16:17] sc1
s_add_u32 s36, s36, 1
s_cmp_gt_u32 s36, 0x200000
s_cbranch_scc1 k2_bail
s_waitcnt vmcnt(0)
v_subrev_u32 v63, s26, v63
v_cmp_lt_u32 vcc, 15, v63
s_cbranch_vccnz poll_104
global_load_lds_dwordx4 v2, s[90:91] offset:0 sc1
global_load_lds_dwordx4 v2, s[90:91] offset:1024 sc1
global_load_lds_dwordx4 v2, s[90:91] offset:2048 sc1
global_load_lds_dwordx4 v2, s[90:91] offset:3072 sc1
s_add_u32 s90, s90, 16384
s_addc_u32 s91, s91, 0
s_add_u32 m0, m0, 16384
s_nop 0
global_load_lds_dwordx4 v2, s[90:91] offset:0 sc1
global_load_lds_dwordx4 v2, s[90:91] offset:1024 sc1
global_load_lds_dwordx4 v2, s[90:91] offset:2048 sc1
global_load_lds_dwordx4 v2, s[90:91] offset:3072 sc1
s_waitcnt vmcnt(4) lgkmcnt(0)
s_barrier
ds_read_b128 v[152:155], v3 offset:0
ds_read_b128 v[156:159], v3 offset:256
ds_read_b128 v[160:163], v3 offset:512
ds_read_b128 v[164:167], v3 offset:768
ds_read_b128 v[168:171], v4 offset:0
ds_read_b128 v[172:175], v4 offset:256
ds_read_b128 v[176:179], v4 offset:512
ds_read_b128 v[180:183], v4 offset:768
s_waitcnt lgkmcnt(4)
v_mfma_f32_16x16x32_bf16 v[104:107], a[208:211], v[152:155], v[64:67]
ds_read_b128 v[184:187], v5 offset:0
v_mfma_f32_16x16x32_bf16 v[108:111], a[208:211], v[156:159], v[68:71]
ds_read_b128 v[188:191], v5 offset:256
s_add_u32 s90, s90, 16384
s_addc_u32 s91, s91, 0
s_add_u32 m0, m0, 16384
s_nop 0
global_load_lds_dwordx4 v2, s[90:91] offset:0 sc1
v_mfma_f32_16x16x32_bf16 v[112:115], a[208:211], v[160:163], v[72:75]
ds_read_b128 v[192:195], v5 offset:512
v_mfma_f32_16x16x32_bf16 v[116:119], a[208:211], v[164:167], v[76:79]
ds_read_b128 v[196:199], v5 offset:768
global_load_lds_dwordx4 v2, s[90:91] offset:1024 sc1
v_mfma_f32_16x16x32_bf16 v[120:123], a[212:215], v[152:155], 0
v_mfma_f32_16x16x32_bf16 v[124:127], a[212:215], v[156:159], 0
v_mfma_f32_16x16x32_bf16 v[128:131], a[212:215], v[160:163], 0
v_mfma_f32_16x16x32_bf16 v[132:135], a[212:215], v[164:167], 0
s_waitcnt lgkmcnt(4)
v_mfma_f32_16x16x32_bf16 v[104:107], a[216:219], v[168:171], v[104:107]
ds_read_b128 v[152:155], v6 offset:0
v_mfma_f32_16x16x32_bf16 v[108:111], a[216:219], v[172:175], v[108:111]
ds_read_b128 v[156:159], v6 offset:256
global_load_lds_dwordx4 v2, s[90:91] offset:2048 sc1
v_mfma_f32_16x16x32_bf16 v[112:115], a[216:219], v[176:179], v[112:115]
ds_read_b128 v[160:163], v6 offset:512
v_mfma_f32_16x16x32_bf16 v[116:119], a[216:219], v[180:183], v[116:119]
ds_read_b128 v[164:167], v6 offset:768
global_load_lds_dwordx4 v2, s[90:91] offset:3072 sc1
s_waitcnt vmcnt(4)
s_barrier
s_waitcnt lgkmcnt(4)
v_mfma_f32_16x16x32_bf16 v[104:107], a[220:223], v[184:187], v[104:107]
ds_read_b128 v[168:171], v3 offset:16384
v_mfma_f32_16x16x32_bf16 v[108:111], a[220:223], v[188:191], v[108:111]
ds_read_b128 v[172:175], v3 offset:16640
s_add_u32 s90, s90, 16384
s_addc_u32 s91, s91, 0
s_add_u32 m0, m0, 16384
s_nop 0
global_load_lds_dwordx4 v2, s[90:91] offset:0 sc1
v_mfma_f32_16x16x32_bf16 v[112:115], a[220:223], v[192:195], v[112:115]
ds_read_b128 v[176:179], v3 offset:16896
v_mfma_f32_16x16x32_bf16 v[116:119], a[220:223], v[196:199], v[116:119]
ds_read_b128 v[180:183], v3 offset:17152
global_load_lds_dwordx4 v2, s[90:91] offset:1024 sc1
s_waitcnt lgkmcnt(4)
v_mfma_f32_16x16x32_bf16 v[104:107], a[224:227], v[152:155], v[104:107]
ds_read_b128 v[184:187], v4 offset:16384
v_mfma_f32_16x16x32_bf16 v[108:111], a[224:227], v[156:159], v[108:111]
ds_read_b128 v[188:191], v4 offset:16640
global_load_lds_dwordx4 v2, s[90:91] offset:2048 sc1
v_mfma_f32_16x16x32_bf16 v[112:115], a[224:227], v[160:163], v[112:115]
ds_read_b128 v[192:195], v4 offset:16896
v_mfma_f32_16x16x32_bf16 v[116:119], a[224:227], v[164:167], v[116:119]
ds_read_b128 v[196:199], v4 offset:17152
global_load_lds_dwordx4 v2, s[90:91] offset:3072 sc1
s_waitcnt lgkmcnt(4)
v_mfma_f32_16x16x32_bf16 v[104:107], a[228:231], v[168:171], v[104:107]
ds_read_b128 v[152:155], v5 offset:16384
v_mfma_f32_16x16x32_bf16 v[108:111], a[228:231], v[172:175], v[108:111]
ds_read_b128 v[156:159], v5 offset:16640
s_add_u32 s90, s90, 16384
s_addc_u32 s91, s91, 0
s_add_u32 m0, m0, 16384
s_nop 0
global_load_lds_dwordx4 v2, s[90:91] offset:0 sc1
v_mfma_f32_16x16x32_bf16 v[112:115], a[228:231], v[176:179], v[112:115]
ds_read_b128 v[160:163], v5 offset:16896
v_mfma_f32_16x16x32_bf16 v[116:119], a[228:231], v[180:183], v[116:119]
ds_read_b128 v[164:167], v5 offset:17152
global_load_lds_dwordx4 v2, s[90:91] offset:1024 sc1
v_mfma_f32_16x16x32_bf16 v[120:123], a[232:235], v[168:171], v[120:123]
v_mfma_f32_16x16x32_bf16 v[124:127], a[232:235], v[172:175], v[124:127]
v_mfma_f32_16x16x32_bf16 v[128:131], a[232:235], v[176:179], v[128:131]
v_mfma_f32_16x16x32_bf16 v[132:135], a[232:235], v[180:183], v[132:135]
s_waitcnt lgkmcnt(4)
v_mfma_f32_16x16x32_bf16 v[104:107], a[236:239], v[184:187], v[104:107]
ds_read_b128 v[168:171], v6 offset:16384
v_mfma_f32_16x16x32_bf16 v[108:111], a[236:239], v[188:191], v[108:111]
ds_read_b128 v[172:175], v6 offset:16640
global_load_lds_dwordx4 v2, s[90:91] offset:2048 sc1
v_mfma_f32_16x16x32_bf16 v[112:115], a[236:239], v[192:195], v[112:115]
ds_read_b128 v[176:179], v6 offset:16896
v_mfma_f32_16x16x32_bf16 v[116:119], a[236:239], v[196:199], v[116:119]
ds_read_b128 v[180:183], v6 offset:17152
global_load_lds_dwordx4 v2, s[90:91] offset:3072 sc1
s_waitcnt vmcnt(8)
s_barrier
s_waitcnt lgkmcnt(4)
v_mfma_f32_16x16x32_bf16 v[104:107], a[240:243], v[152:155], v[104:107]
ds_read_b128 v[184:187], v3 offset:32768
v_mfma_f32_16x16x32_bf16 v[108:111], a[240:243], v[156:159], v[108:111]
ds_read_b128 v[188:191], v3 offset:33024
s_add_u32 s90, s90, 16384
s_addc_u32 s91, s91, 0
s_mov_b32 m0, s38
s_nop 0
global_load_lds_dwordx4 v2, s[90:91] offset:0 sc1
v_mfma_f32_16x16x32_bf16 v[112:115], a[240:243], v[160:163], v[112:115]
ds_read_b128 v[192:195], v3 offset:33280
v_mfma_f32_16x16x32_bf16 v[116:119], a[240:243], v[164:167], v[116:119]
ds_read_b128 v[196:199], v3 offset:33536
global_load_lds_dwordx4 v2, s[90:91] offset:1024 sc1
s_waitcnt lgkmcnt(4)
v_mfma_f32_16x16x32_bf16 v[104:107], a[244:247], v[168:171], v[104:107]
ds_read_b128 v[152:155], v4 offset:32768
v_mfma_f32_16x16x32_bf16 v[108:111], a[244:247], v[172:175], v[108:111]
ds_read_b128 v[156:159], v4 offset:33024
global_load_lds_dwordx4 v2, s[90:91] offset:2048 sc1
v_mfma_f32_16x16x32_bf16 v[112:115], a[244:247], v[176:179], v[112:115]
ds_read_b128 v[160:163], v4 offset:33280
v_mfma_f32_16x16x32_bf16 v[116:119], a[244:247], v[180:183], v[116:119]
ds_read_b128 v[164:167], v4 offset:33536
global_load_lds_dwordx4 v2, s[90:91] offset:3072 sc1
s_waitcnt lgkmcnt(4)
v_mfma_f32_16x16x32_bf16 v[104:107], a[248:251], v[184:187], v[104:107]
ds_read_b128 v[168:171], v5 offset:32768
v_mfma_f32_16x16x32_bf16 v[108:111], a[248:251], v[188:191], v[108:111]
ds_read_b128 v[172:175], v5 offset:33024
v_mfma_f32_16x16x32_bf16 v[112:115], a[248:251], v[192:195], v[112:115]
ds_read_b128 v[176:179], v5 offset:33280
v_mfma_f32_16x16x32_bf16 v[116:119], a[248:251], v[196:199], v[116:119]
ds_read_b128 v[180:183], v5 offset:33536
v_mfma_f32_16x16x32_bf16 v[120:123], a[252:255], v[184:187], v[120:123]
v_mfma_f32_16x16x32_bf16 v[124:127], a[252:255], v[188:191], v[124:127]
v_mfma_f32_16x16x32_bf16 v[128:131], a[252:255], v[192:195], v[128:131]
v_mfma_f32_16x16x32_bf16 v[132:135], a[252:255], v[196:199], v[132:135]
s_waitcnt lgkmcnt(4)
v_mfma_f32_16x16x32_bf16 v[104:107], v[224:227], v[152:155], v[104:107]
ds_read_b128 v[184:187], v6 offset:32768
v_mfma_f32_16x16x32_bf16 v[108:111], v[224:227], v[156:159], v[108:111]
ds_read_b128 v[188:191], v6 offset:33024
v_mfma_f32_16x16x32_bf16 v[112:115], v[224:227], v[160:163], v[112:115]
ds_read_b128 v[192:195], v6 offset:33280
v_mfma_f32_16x16x32_bf16 v[116:119], v[224:227], v[164:167], v[116:119]
ds_read_b128 v[196:199], v6 offset:33536
s_waitcnt vmcnt(8)
s_barrier
s_waitcnt lgkmcnt(4)
v_mfma_f32_16x16x32_bf16 v[104:107], v[228:231], v[168:171], v[104:107]
ds_read_b128 v[152:155], v3 offset:49152
v_mfma_f32_16x16x32_bf16 v[108:111], v[228:231], v[172:175], v[108:111]
ds_read_b128 v[156:159], v3 offset:49408
s_add_u32 s90, s90, 16384
s_addc_u32 s91, s91, 0
s_add_u32 m0, m0, 16384
s_nop 0
global_load_lds_dwordx4 v2, s[90:91] offset:0 sc1
v_mfma_f32_16x16x32_bf16 v[112:115], v[228:231], v[176:179], v[112:115]
ds_read_b128 v[160:163], v3 offset:49664
v_mfma_f32_16x16x32_bf16 v[116:119], v[228:231], v[180:183], v[116:119]
ds_read_b128 v[164:167], v3 offset:49920
s_waitcnt lgkmcnt(4)
v_mfma_f32_16x16x32_bf16 v[104:107], v[232:235], v[184:187], v[104:107]
ds_read_b128 v[168:171], v4 offset:49152
v_mfma_f32_16x16x32_bf16 v[108:111], v[232:235], v[188:191], v[108:111]
ds_read_b128 v[172:175], v4 offset:49408
global_load_lds_dwordx4 v2, s[90:91] offset:1024 sc1
v_mfma_f32_16x16x32_bf16 v[112:115], v[232:235], v[192:195], v[112:115]
ds_read_b128 v[176:179], v4 offset:49664
v_mfma_f32_16x16x32_bf16 v[116:119], v[232:235], v[196:199], v[116:119]
ds_read_b128 v[180:183], v4 offset:49920
s_waitcnt lgkmcnt(4)
v_mfma_f32_16x16x32_bf16 v[104:107], v[236:239], v[152:155], v[104:107]
ds_read_b128 v[184:187], v5 offset:49152
v_mfma_f32_16x16x32_bf16 v[108:111], v[236:239], v[156:159], v[108:111]
ds_read_b128 v[188:191], v5 offset:49408
global_load_lds_dwordx4 v2, s[90:91] offset:2048 sc1
v_mfma_f32_16x16x32_bf16 v[112:115], v[236:239], v[160:163], v[112:115]
ds_read_b128 v[192:195], v5 offset:49664
v_mfma_f32_16x16x32_bf16 v[116:119], v[236:239], v[164:167], v[116:119]
ds_read_b128 v[196:199], v5 offset:49920
v_mfma_f32_16x16x32_bf16 v[120:123], v[240:243], v[152:155], v[120:123]
v_mfma_f32_16x16x32_bf16 v[124:127], v[240:243], v[156:159], v[124:127]
v_mfma_f32_16x16x32_bf16 v[128:131], v[240:243], v[160:163], v[128:131]
v_mfma_f32_16x16x32_bf16 v[132:135], v[240:243], v[164:167], v[132:135]
s_waitcnt lgkmcnt(4)
v_mfma_f32_16x16x32_bf16 v[104:107], v[244:247], v[168:171], v[104:107]
ds_read_b128 v[152:155], v6 offset:49152
v_mfma_f32_16x16x32_bf16 v[108:111], v[244:247], v[172:175], v[108:111]
ds_read_b128 v[156:159], v6 offset:49408
global_load_lds_dwordx4 v2, s[90:91] offset:3072 sc1
v_mfma_f32_16x16x32_bf16 v[112:115], v[244:247], v[176:179], v[112:115]
ds_read_b128 v[160:163], v6 offset:49664
v_mfma_f32_16x16x32_bf16 v[116:119], v[244:247], v[180:183], v[116:119]
ds_read_b128 v[164:167], v6 offset:49920
s_waitcnt vmcnt(8)
s_barrier
s_waitcnt lgkmcnt(4)
v_mfma_f32_16x16x32_bf16 v[104:107], v[248:251], v[184:187], v[104:107]
ds_read_b128 v[168:171], v7 offset:0
v_mfma_f32_16x16x32_bf16 v[108:111], v[248:251], v[188:191], v[108:111]
ds_read_b128 v[172:175], v7 offset:256
s_add_u32 s90, s90, 16384
s_addc_u32 s91, s91, 0
s_add_u32 m0, m0, 16384
s_nop 0
global_load_lds_dwordx4 v2, s[90:91] offset:0 sc1
v_mfma_f32_16x16x32_bf16 v[112:115], v[248:251], v[192:195], v[112:115]
ds_read_b128 v[176:179], v7 offset:512
v_mfma_f32_16x16x32_bf16 v[116:119], v[248:251], v[196:199], v[116:119]
ds_read_b128 v[180:183], v7 offset:768
s_waitcnt lgkmcnt(4)
v_mfma_f32_16x16x32_bf16 v[104:107], v[252:255], v[152:155], v[104:107]
ds_read_b128 v[184:187], v8 offset:0
v_mfma_f32_16x16x32_bf16 v[108:111], v[252:255], v[156:159], v[108:111]
ds_read_b128 v[188:191], v8 offset:256
global_load_lds_dwordx4 v2, s[90:91] offset:1024 sc1
v_mfma_f32_16x16x32_bf16 v[112:115], v[252:255], v[160:163], v[112:115]
ds_read_b128 v[192:195], v8 offset:512
v_mfma_f32_16x16x32_bf16 v[116:119], v[252:255], v[164:167], v[116:119]
ds_read_b128 v[196:199], v8 offset:768
s_waitcnt lgkmcnt(4)
v_mfma_f32_16x16x32_bf16 v[104:107], a[128:131], v[168:171], v[104:107]
ds_read_b128 v[152:155], v9 offset:0
v_mfma_f32_16x16x32_bf16 v[108:111], a[128:131], v[172:175], v[108:111]
ds_read_b128 v[156:159], v9 offset:256
global_load_lds_dwordx4 v2, s[90:91] offset:2048 sc1
v_mfma_f32_16x16x32_bf16 v[112:115], a[128:131], v[176:179], v[112:115]
ds_read_b128 v[160:163], v9 offset:512
v_mfma_f32_16x16x32_bf16 v[116:119], a[128:131], v[180:183], v[116:119]
ds_read_b128 v[164:167], v9 offset:768
v_mfma_f32_16x16x32_bf16 v[120:123], a[132:135], v[168:171], v[120:123]
v_mfma_f32_16x16x32_bf16 v[124:127], a[132:135], v[172:175], v[124:127]
v_mfma_f32_16x16x32_bf16 v[128:131], a[132:135], v[176:179], v[128:131]
v_mfma_f32_16x16x32_bf16 v[132:135], a[132:135], v[180:183], v[132:135]
s_waitcnt lgkmcnt(4)
v_mfma_f32_16x16x32_bf16 v[104:107], a[136:139], v[184:187], v[104:107]
ds_read_b128 v[168:171], v10 offset:0
v_mfma_f32_16x16x32_bf16 v[108:111], a[136:139], v[188:191], v[108:111]
ds_read_b128 v[172:175], v10 offset:256
global_load_lds_dwordx4 v2, s[90:91] offset:3072 sc1
v_mfma_f32_16x16x32_bf16 v[112:115], a[136:139], v[192:195], v[112:115]
ds_read_b128 v[176:179], v10 offset:512
v_mfma_f32_16x16x32_bf16 v[116:119], a[136:139], v[196:199], v[116:119]
ds_read_b128 v[180:183], v10 offset:768
s_waitcnt vmcnt(8)
s_barrier
s_waitcnt lgkmcnt(4)
v_mfma_f32_16x16x32_bf16 v[104:107], a[140:143], v[152:155], v[104:107]
ds_read_b128 v[184:187], v3 offset:0
v_mfma_f32_16x16x32_bf16 v[108:111], a[140:143], v[156:159], v[108:111]
ds_read_b128 v[188:191], v3 offset:256
s_add_u32 s90, s90, 16384
s_addc_u32 s91, s91, 0
s_add_u32 m0, m0, 16384
s_nop 0
global_load_lds_dwordx4 v2, s[90:91] offset:0 sc1
v_mfma_f32_16x16x32_bf16 v[112:115], a[140:143], v[160:163], v[112:115]
ds_read_b128 v[192:195], v3 offset:512
v_mfma_f32_16x16x32_bf16 v[116:119], a[140:143], v[164:167], v[116:119]
ds_read_b128 v[196:199], v3 offset:768
s_waitcnt lgkmcnt(4)
v_mfma_f32_16x16x32_bf16 v[104:107], a[144:147], v[168:171], v[104:107]
ds_read_b128 v[152:155], v4 offset:0
global_load_dwordx4 a[180:183], v2, s[92:93] offset:3072
v_mfma_f32_16x16x32_bf16 v[108:111], a[144:147], v[172:175], v[108:111]
ds_read_b128 v[156:159], v4 offset:256
global_load_lds_dwordx4 v2, s[90:91] offset:1024 sc1
v_mfma_f32_16x16x32_bf16 v[112:115], a[144:147], v[176:179], v[112:115]
ds_read_b128 v[160:163], v4 offset:512
v_mfma_f32_16x16x32_bf16 v[116:119], a[144:147], v[180:183], v[116:119]
ds_read_b128 v[164:167], v4 offset:768
s_waitcnt lgkmcnt(4)
v_mfma_f32_16x16x32_bf16 v[104:107], a[148:151], v[184:187], v[104:107]
ds_read_b128 v[168:171], v5 offset:0
s_add_u32 s92, s92, 4096
s_addc_u32 s93, s93, 0
global_load_dwordx4 a[184:187], v2, s[92:93] offset:0
v_mfma_f32_16x16x32_bf16 v[108:111], a[148:151], v[188:191], v[108:111]
ds_read_b128 v[172:175], v5 offset:256
global_load_lds_dwordx4 v2, s[90:91] offset:2048 sc1
v_mfma_f32_16x16x32_bf16 v[112:115], a[148:151], v[192:195], v[112:115]
ds_read_b128 v[176:179], v5 offset:512
v_mfma_f32_16x16x32_bf16 v[116:119], a[148:151], v[196:199], v[116:119]
ds_read_b128 v[180:183], v5 offset:768
v_mfma_f32_16x16x32_bf16 v[120:123], a[152:155], v[184:187], v[120:123]
v_mfma_f32_16x16x32_bf16 v[124:127], a[152:155], v[188:191], v[124:127]
v_mfma_f32_16x16x32_bf16 v[128:131], a[152:155], v[192:195], v[128:131]
v_mfma_f32_16x16x32_bf16 v[132:135], a[152:155], v[196:199], v[132:135]
s_waitcnt lgkmcnt(4)
v_mfma_f32_16x16x32_bf16 v[104:107], a[156:159], v[152:155], v[104:107]
ds_read_b128 v[184:187], v6 offset:0
global_load_dwordx4 a[188:191], v2, s[92:93] offset:1024
v_mfma_f32_16x16x32_bf16 v[108:111], a[156:159], v[156:159], v[108:111]
ds_read_b128 v[188:191], v6 offset:256
global_load_lds_dwordx4 v2, s[90:91] offset:3072 sc1
v_mfma_f32_16x16x32_bf16 v[112:115], a[156:159], v[160:163], v[112:115]
ds_read_b128 v[192:195], v6 offset:512
global_load_dwordx4 a[192:195], v2, s[92:93] offset:2048
v_mfma_f32_16x16x32_bf16 v[116:119], a[156:159], v[164:167], v[116:119]
ds_read_b128 v[196:199], v6 offset:768
s_waitcnt vmcnt(12)
s_barrier
s_waitcnt lgkmcnt(4)
v_mfma_f32_16x16x32_bf16 v[104:107], a[160:163], v[168:171], v[104:107]
ds_read_b128 v[152:155], v3 offset:16384
global_load_dwordx4 a[196:199], v2, s[92:93] offset:3072
v_mfma_f32_16x16x32_bf16 v[108:111], a[160:163], v[172:175], v[108:111]
ds_read_b128 v[156:159], v3 offset:16640
s_add_u32 s90, s90, 16384
s_addc_u32 s91, s91, 0
s_add_u32 m0, m0, 16384
s_nop 0
global_load_lds_dwordx4 v2, s[90:91] offset:0 sc1
v_mfma_f32_16x16x32_bf16 v[112:115], a[160:163], v[176:179], v[112:115]
ds_read_b128 v[160:163], v3 offset:16896
v_mfma_f32_16x16x32_bf16 v[116:119], a[160:163], v[180:183], v[116:119]
ds_read_b128 v[164:167], v3 offset:17152
s_waitcnt lgkmcnt(4)
v_mfma_f32_16x16x32_bf16 v[104:107], a[164:167], v[184:187], v[104:107]
ds_read_b128 v[168:171], v4 offset:16384
s_add_u32 s92, s92, 4096
s_addc_u32 s93, s93, 0
global_load_dwordx4 a[200:203], v2, s[92:93] offset:0
v_mfma_f32_16x16x32_bf16 v[108:111], a[164:167], v[188:191], v[108:111]
ds_read_b128 v[172:175], v4 offset:16640
global_load_lds_dwordx4 v2, s[90:91] offset:1024 sc1
v_mfma_f32_16x16x32_bf16 v[112:115], a[164:167], v[192:195], v[112:115]
ds_read_b128 v[176:179], v4 offset:16896
v_mfma_f32_16x16x32_bf16 v[116:119], a[164:167], v[196:199], v[116:119]
ds_read_b128 v[180:183], v4 offset:17152
s_waitcnt lgkmcnt(4)
v_mfma_f32_16x16x32_bf16 v[104:107], a[168:171], v[152:155], v[104:107]
ds_read_b128 v[184:187], v5 offset:16384
global_load_dwordx4 a[204:207], v2, s[92:93] offset:1024
v_mfma_f32_16x16x32_bf16 v[108:111], a[168:171], v[156:159], v[108:111]
ds_read_b128 v[188:191], v5 offset:16640
global_load_lds_dwordx4 v2, s[90:91] offset:2048 sc1
v_mfma_f32_16x16x32_bf16 v[112:115], a[168:171], v[160:163], v[112:115]
ds_read_b128 v[192:195], v5 offset:16896
v_mfma_f32_16x16x32_bf16 v[116:119], a[168:171], v[164:167], v[116:119]
ds_read_b128 v[196:199], v5 offset:17152
v_mfma_f32_16x16x32_bf16 v[120:123], a[172:175], v[152:155], v[120:123]
v_mfma_f32_16x16x32_bf16 v[124:127], a[172:175], v[156:159], v[124:127]
v_mfma_f32_16x16x32_bf16 v[128:131], a[172:175], v[160:163], v[128:131]
v_mfma_f32_16x16x32_bf16 v[132:135], a[172:175], v[164:167], v[132:135]
s_waitcnt lgkmcnt(4)
v_mfma_f32_16x16x32_bf16 v[104:107], a[176:179], v[168:171], v[104:107]
ds_read_b128 v[152:155], v6 offset:16384
global_load_dwordx4 a[208:211], v2, s[92:93] offset:2048
v_mfma_f32_16x16x32_bf16 v[108:111], a[176:179], v[172:175], v[108:111]
ds_read_b128 v[156:159], v6 offset:16640
global_load_lds_dwordx4 v2, s[90:91] offset:3072 sc1
v_mfma_f32_16x16x32_bf16 v[112:115], a[176:179], v[176:179], v[112:115]
ds_read_b128 v[160:163], v6 offset:16896
global_load_dwordx4 a[212:215], v2, s[92:93] offset:3072
v_mfma_f32_16x16x32_bf16 v[116:119], a[176:179], v[180:183], v[116:119]
ds_read_b128 v[164:167], v6 offset:17152
s_waitcnt vmcnt(17)
s_barrier
s_waitcnt vmcnt(15) lgkmcnt(4)
v_mfma_f32_16x16x32_bf16 v[104:107], a[180:183], v[184:187], v[104:107]
ds_read_b128 v[168:171], v3 offset:32768
s_add_u32 s92, s92, 4096
s_addc_u32 s93, s93, 0
global_load_dwordx4 a[216:219], v2, s[92:93] offset:0
v_mfma_f32_16x16x32_bf16 v[108:111], a[180:183], v[188:191], v[108:111]
ds_read_b128 v[172:175], v3 offset:33024
s_add_u32 s90, s90, 16384
s_addc_u32 s91, s91, 0
s_mov_b32 m0, s38
s_nop 0
global_load_lds_dwordx4 v2, s[90:91] offset:0 sc1
v_mfma_f32_16x16x32_bf16 v[112:115], a[180:183], v[192:195], v[112:115]
ds_read_b128 v[176:179], v3 offset:33280
v_mfma_f32_16x16x32_bf16 v[116:119], a[180:183], v[196:199], v[116:119]
ds_read_b128 v[180:183], v3 offset:33536
s_waitcnt vmcnt(15) lgkmcnt(4)
v_mfma_f32_16x16x32_bf16 v[104:107], a[184:187], v[152:155], v[104:107]
ds_read_b128 v[184:187], v4 offset:32768
global_load_dwordx4 a[220:223], v2, s[92:93] offset:1024
v_mfma_f32_16x16x32_bf16 v[108:111], a[184:187], v[156:159], v[108:111]
ds_read_b128 v[188:191], v4 offset:33024
global_load_lds_dwordx4 v2, s[90:91] offset:1024 sc1
v_mfma_f32_16x16x32_bf16 v[112:115], a[184:187], v[160:163], v[112:115]
ds_read_b128 v[192:195], v4 offset:33280
v_mfma_f32_16x16x32_bf16 v[116:119], a[184:187], v[164:167], v[116:119]
ds_read_b128 v[196:199], v4 offset:33536
s_waitcnt vmcnt(15) lgkmcnt(4)
v_mfma_f32_16x16x32_bf16 v[104:107], a[188:191], v[168:171], v[104:107]
ds_read_b128 v[152:155], v5 offset:32768
global_load_dwordx4 a[224:227], v2, s[92:93] offset:2048
v_mfma_f32_16x16x32_bf16 v[108:111], a[188:191], v[172:175], v[108:111]
ds_read_b128 v[156:159], v5 offset:33024
global_load_lds_dwordx4 v2, s[90:91] offset:2048 sc1
v_mfma_f32_16x16x32_bf16 v[112:115], a[188:191], v[176:179], v[112:115]
ds_read_b128 v[160:163], v5 offset:33280
v_mfma_f32_16x16x32_bf16 v[116:119], a[188:191], v[180:183], v[116:119]
ds_read_b128 v[164:167], v5 offset:33536
s_waitcnt vmcnt(15)
v_mfma_f32_16x16x32_bf16 v[120:123], a[192:195], v[168:171], v[120:123]
v_mfma_f32_16x16x32_bf16 v[124:127], a[192:195], v[172:175], v[124:127]
v_mfma_f32_16x16x32_bf16 v[128:131], a[192:195], v[176:179], v[128:131]
v_mfma_f32_16x16x32_bf16 v[132:135], a[192:195], v[180:183], v[132:135]
s_waitcnt vmcnt(14) lgkmcnt(4)
v_mfma_f32_16x16x32_bf16 v[104:107], a[196:199], v[184:187], v[104:107]
ds_read_b128 v[168:171], v6 offset:32768
global_load_dwordx4 a[228:231], v2, s[92:93] offset:3072
v_mfma_f32_16x16x32_bf16 v[108:111], a[196:199], v[188:191], v[108:111]
ds_read_b128 v[172:175], v6 offset:33024
global_load_lds_dwordx4 v2, s[90:91] offset:3072 sc1
v_mfma_f32_16x16x32_bf16 v[112:115], a[196:199], v[192:195], v[112:115]
ds_read_b128 v[176:179], v6 offset:33280
s_add_u32 s92, s92, 4096
s_addc_u32 s93, s93, 0
global_load_dwordx4 a[232:235], v2, s[92:93] offset:0
v_mfma_f32_16x16x32_bf16 v[116:119], a[196:199], v[196:199], v[116:119]
ds_read_b128 v[180:183], v6 offset:33536
s_barrier
s_waitcnt vmcnt(15) lgkmcnt(4)
v_mfma_f32_16x16x32_bf16 v[104:107], a[200:203], v[152:155], v[104:107]
ds_read_b128 v[184:187], v3 offset:49152
global_load_dwordx4 a[236:239], v2, s[92:93] offset:1024
v_mfma_f32_16x16x32_bf16 v[108:111], a[200:203], v[156:159], v[108:111]
ds_read_b128 v[188:191], v3 offset:49408
s_add_u32 s90, s90, 16384
s_addc_u32 s91, s91, 0
s_add_u32 m0, m0, 16384
s_nop 0
global_load_lds_dwordx4 v2, s[90:91] offset:0 sc1
v_mfma_f32_16x16x32_bf16 v[112:115], a[200:203], v[160:163], v[112:115]
ds_read_b128 v[192:195], v3 offset:49664
global_load_dwordx4 a[240:243], v2, s[92:93] offset:2048
v_mfma_f32_16x16x32_bf16 v[116:119], a[200:203], v[164:167], v[116:119]
ds_read_b128 v[196:199], v3 offset:49920
s_waitcnt vmcnt(16) lgkmcnt(4)
v_mfma_f32_16x16x32_bf16 v[104:107], a[204:207], v[168:171], v[104:107]
ds_read_b128 v[152:155], v4 offset:49152
global_load_dwordx4 a[244:247], v2, s[92:93] offset:3072
v_mfma_f32_16x16x32_bf16 v[108:111], a[204:207], v[172:175], v[108:111]
ds_read_b128 v[156:159], v4 offset:49408
global_load_lds_dwordx4 v2, s[90:91] offset:1024 sc1
v_mfma_f32_16x16x32_bf16 v[112:115], a[204:207], v[176:179], v[112:115]
ds_read_b128 v[160:163], v4 offset:49664
v_mfma_f32_16x16x32_bf16 v[116:119], a[204:207], v[180:183], v[116:119]
ds_read_b128 v[164:167], v4 offset:49920
s_waitcnt vmcnt(16) lgkmcnt(4)
v_mfma_f32_16x16x32_bf16 v[104:107], a[208:211], v[184:187], v[104:107]
ds_read_b128 v[168:171], v5 offset:49152
s_add_u32 s92, s92, 4096
s_addc_u32 s93, s93, 0
global_load_dwordx4 a[248:251], v2, s[92:93] offset:0
v_mfma_f32_16x16x32_bf16 v[108:111], a[208:211], v[188:191], v[108:111]
ds_read_b128 v[172:175], v5 offset:49408
global_load_lds_dwordx4 v2, s[90:91] offset:2048 sc1
v_mfma_f32_16x16x32_bf16 v[112:115], a[208:211], v[192:195], v[112:115]
ds_read_b128 v[176:179], v5 offset:49664
v_mfma_f32_16x16x32_bf16 v[116:119], a[208:211], v[196:199], v[116:119]
ds_read_b128 v[180:183], v5 offset:49920
s_waitcnt vmcnt(16)
v_mfma_f32_16x16x32_bf16 v[120:123], a[212:215], v[184:187], v[120:123]
v_mfma_f32_16x16x32_bf16 v[124:127], a[212:215], v[188:191], v[124:127]
v_mfma_f32_16x16x32_bf16 v[128:131], a[212:215], v[192:195], v[128:131]
v_mfma_f32_16x16x32_bf16 v[132:135], a[212:215], v[196:199], v[132:135]
s_waitcnt vmcnt(15) lgkmcnt(4)
v_mfma_f32_16x16x32_bf16 v[104:107], a[216:219], v[152:155], v[104:107]
ds_read_b128 v[184:187], v6 offset:49152
global_load_dwordx4 a[252:255], v2, s[92:93] offset:1024
v_mfma_f32_16x16x32_bf16 v[108:111], a[216:219], v[156:159], v[108:111]
ds_read_b128 v[188:191], v6 offset:49408
global_load_lds_dwordx4 v2, s[90:91] offset:3072 sc1
v_mfma_f32_16x16x32_bf16 v[112:115], a[216:219], v[160:163], v[112:115]
ds_read_b128 v[192:195], v6 offset:49664
global_load_dwordx4 v[224:227], v2, s[92:93] offset:2048
v_mfma_f32_16x16x32_bf16 v[116:119], a[216:219], v[164:167], v[116:119]
ds_read_b128 v[196:199], v6 offset:49920
s_barrier
s_waitcnt vmcnt(16) lgkmcnt(4)
v_mfma_f32_16x16x32_bf16 v[104:107], a[220:223], v[168:171], v[104:107]
ds_read_b128 v[152:155], v7 offset:0
global_load_dwordx4 v[228:231], v2, s[92:93] offset:3072
v_mfma_f32_16x16x32_bf16 v[108:111], a[220:223], v[172:175], v[108:111]
ds_read_b128 v[156:159], v7 offset:256
v_mfma_f32_16x16x32_bf16 v[112:115], a[220:223], v[176:179], v[112:115]
ds_read_b128 v[160:163], v7 offset:512
v_mfma_f32_16x16x32_bf16 v[116:119], a[220:223], v[180:183], v[116:119]
ds_read_b128 v[164:167], v7 offset:768
s_waitcnt vmcnt(15) lgkmcnt(4)
v_mfma_f32_16x16x32_bf16 v[104:107], a[224:227], v[184:187], v[104:107]
ds_read_b128 v[168:171], v8 offset:0
s_add_u32 s92, s92, 4096
s_addc_u32 s93, s93, 0
global_load_dwordx4 v[232:235], v2, s[92:93] offset:0
v_mfma_f32_16x16x32_bf16 v[108:111], a[224:227], v[188:191], v[108:111]
ds_read_b128 v[172:175], v8 offset:256
v_mfma_f32_16x16x32_bf16 v[112:115], a[224:227], v[192:195], v[112:115]
ds_read_b128 v[176:179], v8 offset:512
v_mfma_f32_16x16x32_bf16 v[116:119], a[224:227], v[196:199], v[116:119]
ds_read_b128 v[180:183], v8 offset:768
s_waitcnt vmcnt(14) lgkmcnt(4)
v_mfma_f32_16x16x32_bf16 v[104:107], a[228:231], v[152:155], v[104:107]
ds_read_b128 v[184:187], v9 offset:0
global_load_dwordx4 v[236:239], v2, s[92:93] offset:1024
v_mfma_f32_16x16x32_bf16 v[108:111], a[228:231], v[156:159], v[108:111]
ds_read_b128 v[188:191], v9 offset:256
v_mfma_f32_16x16x32_bf16 v[112:115], a[228:231], v[160:163], v[112:115]
ds_read_b128 v[192:195], v9 offset:512
v_mfma_f32_16x16x32_bf16 v[116:119], a[228:231], v[164:167], v[116:119]
ds_read_b128 v[196:199], v9 offset:768
s_waitcnt vmcnt(13)
v_mfma_f32_16x16x32_bf16 v[120:123], a[232:235], v[152:155], v[120:123]
v_mfma_f32_16x16x32_bf16 v[124:127], a[232:235], v[156:159], v[124:127]
v_mfma_f32_16x16x32_bf16 v[128:131], a[232:235], v[160:163], v[128:131]
v_mfma_f32_16x16x32_bf16 v[132:135], a[232:235], v[164:167], v[132:135]
s_waitcnt vmcnt(12) lgkmcnt(4)
v_mfma_f32_16x16x32_bf16 v[104:107], a[236:239], v[168:171], v[104:107]
ds_read_b128 v[152:155], v10 offset:0
global_load_dwordx4 v[240:243], v2, s[92:93] offset:2048
v_mfma_f32_16x16x32_bf16 v[108:111], a[236:239], v[172:175], v[108:111]
ds_read_b128 v[156:159], v10 offset:256
global_load_dwordx4 v[244:247], v2, s[92:93] offset:3072
v_mfma_f32_16x16x32_bf16 v[112:115], a[236:239], v[176:179], v[112:115]
ds_read_b128 v[160:163], v10 offset:512
v_mfma_f32_16x16x32_bf16 v[116:119], a[236:239], v[180:183], v[116:119]
ds_read_b128 v[164:167], v10 offset:768
s_barrier
s_waitcnt vmcnt(12) lgkmcnt(4)
v_mfma_f32_16x16x32_bf16 v[104:107], a[240:243], v[184:187], v[104:107]
ds_read_b128 v[168:171], v3 offset:0
s_add_u32 s92, s92, 4096
s_addc_u32 s93, s93, 0
global_load_dwordx4 v[248:251], v2, s[92:93] offset:0
v_mfma_f32_16x16x32_bf16 v[108:111], a[240:243], v[188:191], v[108:111]
ds_read_b128 v[172:175], v3 offset:256
v_mfma_f32_16x16x32_bf16 v[112:115], a[240:243], v[192:195], v[112:115]
ds_read_b128 v[176:179], v3 offset:512
v_mfma_f32_16x16x32_bf16 v[116:119], a[240:243], v[196:199], v[116:119]
ds_read_b128 v[180:183], v3 offset:768
s_waitcnt vmcnt(12) lgkmcnt(4)
v_mfma_f32_16x16x32_bf16 v[104:107], a[244:247], v[152:155], v[104:107]
ds_read_b128 v[184:187], v4 offset:0
global_load_dwordx4 v[252:255], v2, s[92:93] offset:1024
v_mfma_f32_16x16x32_bf16 v[108:111], a[244:247], v[156:159], v[108:111]
ds_read_b128 v[188:191], v4 offset:256
v_mfma_f32_16x16x32_bf16 v[112:115], a[244:247], v[160:163], v[112:115]
ds_read_b128 v[192:195], v4 offset:512
v_mfma_f32_16x16x32_bf16 v[116:119], a[244:247], v[164:167], v[116:119]
ds_read_b128 v[196:199], v4 offset:768
s_waitcnt vmcnt(11) lgkmcnt(4)
v_mfma_f32_16x16x32_bf16 v[104:107], a[248:251], v[168:171], v[104:107]
ds_read_b128 v[152:155], v5 offset:0
s_mul_i32 s26, s22, 10240
v_mfma_f32_16x16x32_bf16 v[108:111], a[248:251], v[172:175], v[108:111]
ds_read_b128 v[156:159], v5 offset:256
s_mul_i32 s31, s20, 2560
v_mfma_f32_16x16x32_bf16 v[112:115], a[248:251], v[176:179], v[112:115]
ds_read_b128 v[160:163], v5 offset:512
s_add_u32 s26, s26, s31
v_mfma_f32_16x16x32_bf16 v[116:119], a[248:251], v[180:183], v[116:119]
ds_read_b128 v[164:167], v5 offset:768
s_add_u32 s26, s26, s24
s_waitcnt vmcnt(9)
v_mfma_f32_16x16x32_bf16 v[120:123], a[252:255], v[168:171], v[120:123]
s_add_u32 s26, s26, 0
v_mfma_f32_16x16x32_bf16 v[124:127], a[252:255], v[172:175], v[124:127]
buffer_load_dword v62, v30, s[16:19], s26 offen sc1
v_mfma_f32_16x16x32_bf16 v[128:131], a[252:255], v[176:179], v[128:131]
s_sub_u32 s92, s92, 73728
s_subb_u32 s93, s93, 0
global_load_dwordx4 a[128:131], v2, s[92:93] offset:2048
v_mfma_f32_16x16x32_bf16 v[132:135], a[252:255], v[180:183], v[132:135]
s_waitcnt vmcnt(9) lgkmcnt(4)
v_mfma_f32_16x16x32_bf16 v[104:107], v[224:227], v[184:187], v[104:107]
ds_read_b128 v[168:171], v6 offset:0
global_load_dwordx4 a[132:135], v2, s[92:93] offset:3072
v_mfma_f32_16x16x32_bf16 v[108:111], v[224:227], v[188:191], v[108:111]
ds_read_b128 v[172:175], v6 offset:256
v_mfma_f32_16x16x32_bf16 v[112:115], v[224:227], v[192:195], v[112:115]
ds_read_b128 v[176:179], v6 offset:512
v_mfma_f32_16x16x32_bf16 v[116:119], v[224:227], v[196:199], v[116:119]
ds_read_b128 v[180:183], v6 offset:768
s_barrier
s_waitcnt vmcnt(9) lgkmcnt(4)
v_mfma_f32_16x16x32_bf16 v[104:107], v[228:231], v[152:155], v[104:107]
ds_read_b128 v[184:187], v3 offset:16384
s_add_u32 s92, s92, 4096
s_addc_u32 s93, s93, 0
global_load_dwordx4 a[136:139], v2, s[92:93] offset:0
v_mfma_f32_16x16x32_bf16 v[108:111], v[228:231], v[156:159], v[108:111]
ds_read_b128 v[188:191], v3 offset:16640
v_mfma_f32_16x16x32_bf16 v[112:115], v[228:231], v[160:163], v[112:115]
ds_read_b128 v[192:195], v3 offset:16896
v_mfma_f32_16x16x32_bf16 v[116:119], v[228:231], v[164:167], v[116:119]
ds_read_b128 v[196:199], v3 offset:17152
s_waitcnt vmcnt(9) lgkmcnt(4)
v_mfma_f32_16x16x32_bf16 v[104:107], v[232:235], v[168:171], v[104:107]
ds_read_b128 v[152:155], v4 offset:16384
global_load_dwordx4 a[140:143], v2, s[92:93] offset:1024
v_mfma_f32_16x16x32_bf16 v[108:111], v[232:235], v[172:175], v[108:111]
ds_read_b128 v[156:159], v4 offset:16640
v_mfma_f32_16x16x32_bf16 v[112:115], v[232:235], v[176:179], v[112:115]
ds_read_b128 v[160:163], v4 offset:16896
v_mfma_f32_16x16x32_bf16 v[116:119], v[232:235], v[180:183], v[116:119]
ds_read_b128 v[164:167], v4 offset:17152
s_waitcnt vmcnt(9) lgkmcnt(4)
v_mfma_f32_16x16x32_bf16 v[104:107], v[236:239], v[184:187], v[104:107]
ds_read_b128 v[168:171], v5 offset:16384
global_load_dwordx4 a[144:147], v2, s[92:93] offset:2048
v_mfma_f32_16x16x32_bf16 v[108:111], v[236:239], v[188:191], v[108:111]
ds_read_b128 v[172:175], v5 offset:16640
v_mfma_f32_16x16x32_bf16 v[112:115], v[236:239], v[192:195], v[112:115]
ds_read_b128 v[176:179], v5 offset:16896
v_mfma_f32_16x16x32_bf16 v[116:119], v[236:239], v[196:199], v[116:119]
ds_read_b128 v[180:183], v5 offset:17152
s_waitcnt vmcnt(9)
v_mfma_f32_16x16x32_bf16 v[120:123], v[240:243], v[184:187], v[120:123]
v_mfma_f32_16x16x32_bf16 v[124:127], v[240:243], v[188:191], v[124:127]
v_mfma_f32_16x16x32_bf16 v[128:131], v[240:243], v[192:195], v[128:131]
v_mfma_f32_16x16x32_bf16 v[132:135], v[240:243], v[196:199], v[132:135]
s_waitcnt vmcnt(8) lgkmcnt(4)
v_mfma_f32_16x16x32_bf16 v[104:107], v[244:247], v[152:155], v[104:107]
ds_read_b128 v[184:187], v6 offset:16384
global_load_dwordx4 a[148:151], v2, s[92:93] offset:3072
v_mfma_f32_16x16x32_bf16 v[108:111], v[244:247], v[156:159], v[108:111]
ds_read_b128 v[188:191], v6 offset:16640
v_mfma_f32_16x16x32_bf16 v[112:115], v[244:247], v[160:163], v[112:115]
ds_read_b128 v[192:195], v6 offset:16896
v_mfma_f32_16x16x32_bf16 v[116:119], v[244:247], v[164:167], v[116:119]
ds_read_b128 v[196:199], v6 offset:17152
s_waitcnt vmcnt(8) lgkmcnt(4)
v_mfma_f32_16x16x32_bf16 v[104:107], v[248:251], v[168:171], v[104:107]
ds_write_b128 v23, v[120:123] offset:0
ds_write_b128 v23, v[124:127] offset:1024
v_mfma_f32_16x16x32_bf16 v[108:111], v[248:251], v[172:175], v[108:111]
ds_write_b128 v23, v[128:131] offset:2048
ds_write_b128 v23, v[132:135] offset:3072
v_mfma_f32_16x16x32_bf16 v[112:115], v[248:251], v[176:179], v[112:115]
s_add_u32 s92, s92, 4096
s_addc_u32 s93, s93, 0
global_load_dwordx4 a[152:155], v2, s[92:93] offset:0
v_mfma_f32_16x16x32_bf16 v[116:119], v[248:251], v[180:183], v[116:119]
s_waitcnt vmcnt(8) lgkmcnt(4)
v_mfma_f32_16x16x32_bf16 v[104:107], v[252:255], v[184:187], v[104:107]
global_load_dwordx4 a[156:159], v2, s[92:93] offset:1024
v_mfma_f32_16x16x32_bf16 v[108:111], v[252:255], v[188:191], v[108:111]
v_mfma_f32_16x16x32_bf16 v[112:115], v[252:255], v[192:195], v[112:115]
v_mfma_f32_16x16x32_bf16 v[116:119], v[252:255], v[196:199], v[116:119]
s_waitcnt lgkmcnt(0)
s_barrier
ds_read_b128 v[152:155], v24 offset:0
ds_read_b128 v[156:159], v24 offset:4096
ds_read_b128 v[160:163], v24 offset:8192
ds_read_b128 v[164:167], v24 offset:12288
s_waitcnt lgkmcnt(0)
v_pk_add_f32 v[152:153], v[152:153], v[156:157]
v_pk_add_f32 v[160:161], v[160:161], v[164:165]
v_pk_add_f32 v[154:155], v[154:155], v[158:159]
v_pk_add_f32 v[162:163], v[162:163], v[166:167]
v_pk_add_f32 v[152:153], v[152:153], v[80:81]
v_pk_add_f32 v[154:155], v[154:155], v[82:83]
v_pk_add_f32 v[120:121], v[152:153], v[160:161]
v_pk_add_f32 v[122:123], v[154:155], v[162:163]
v_pk_add_f32 v[152:153], v[104:105], v[106:107]
v_pk_mul_f32 v[154:155], v[104:105], v[104:105]
v_pk_add_f32 v[156:157], v[108:109], v[110:111]
v_pk_mul_f32 v[158:159], v[108:109], v[108:109]
v_pk_add_f32 v[160:161], v[112:113], v[114:115]
v_pk_mul_f32 v[162:163], v[112:113], v[112:113]
v_pk_add_f32 v[164:165], v[116:117], v[118:119]
v_pk_mul_f32 v[166:167], v[116:117], v[116:117]
v_pk_add_f32 v[168:169], v[120:121], v[122:123]
v_pk_mul_f32 v[170:171], v[120:121], v[120:121]
v_pk_fma_f32 v[154:155], v[106:107], v[106:107], v[154:155]
v_add_f32 v152, v152, v153
v_pk_fma_f32 v[158:159], v[110:111], v[110:111], v[158:159]
v_add_f32 v156, v156, v157
v_pk_fma_f32 v[162:163], v[114:115], v[114:115], v[162:163]
v_add_f32 v160, v160, v161
v_pk_fma_f32 v[166:167], v[118:119], v[118:119], v[166:167]
v_add_f32 v164, v164, v165
v_pk_fma_f32 v[170:171], v[122:123], v[122:123], v[170:171]
v_add_f32 v168, v168, v169
v_add_f32 v153, v154, v155
v_add_f32 v157, v158, v159
v_add_f32 v161, v162, v163
v_add_f32 v165, v166, v167
v_add_f32 v169, v170, v171
v_fmac_f32 v152, s60, v168
v_fmac_f32 v153, s60, v169
v_fmac_f32 v156, s61, v168
v_fmac_f32 v157, s61, v169
v_fmac_f32 v160, s62, v168
v_fmac_f32 v161, s62, v169
v_fmac_f32 v164, s63, v168
v_fmac_f32 v165, s63, v169
v_permlane32_swap_b32 v152, v160
v_permlane32_swap_b32 v156, v164
v_permlane32_swap_b32 v153, v161
v_permlane32_swap_b32 v157, v165
v_pk_add_f32 v[152:153], v[152:153], v[160:161]
v_pk_add_f32 v[156:157], v[156:157], v[164:165]
s_nop 1
v_permlane16_swap_b32 v152, v156
v_permlane16_swap_b32 v153, v157
v_pk_add_f32 v[152:153], v[152:153], v[156:157]
ds_write_b64 v20, v[152:153]
s_waitcnt lgkmcnt(0)
s_barrier
ds_read_b64 v[184:185], v19 offset:0
ds_read_b64 v[186:187], v19 offset:512
ds_read_b64 v[188:189], v19 offset:1024
ds_read_b64 v[190:191], v19 offset:1536
s_add_u32 s74, s28, 262144
s_add_u32 s65, s75, 19
v_mov_b32 v193, s65
v_mov_b32 v195, s65
s_waitcnt lgkmcnt(0)
v_pk_add_f32 v[184:185], v[184:185], v[186:187]
v_pk_add_f32 v[188:189], v[188:189], v[190:191]
v_add_f32 v192, v184, v188
v_add_f32 v194, v185, v189
s_cmp_lg_u32 s23, 0
s_cbranch_scc1 slow_105
buffer_store_dwordx4 v[192:195], v220, s[16:19], s74 offen
back_106:
global_load_dwordx4 a[160:163], v2, s[92:93] offset:2048
global_load_dwordx4 a[164:167], v2, s[92:93] offset:3072
s_add_u32 s92, s92, 4096
s_addc_u32 s93, s93, 0
global_load_dwordx4 a[168:171], v2, s[92:93] offset:0
v_cvt_pk_bf16_f32 v152, v104, v105
v_cvt_pk_bf16_f32 v153, v106, v107
v_cvt_pk_bf16_f32 v154, v108, v109
v_cvt_pk_bf16_f32 v155, v110, v111
v_cvt_pk_bf16_f32 v156, v112, v113
v_cvt_pk_bf16_f32 v157, v114, v115
v_cvt_pk_bf16_f32 v158, v116, v117
v_cvt_pk_bf16_f32 v159, v118, v119
v_cvt_pk_bf16_f32 v160, v120, v121
v_cvt_pk_bf16_f32 v161, v122, v123
v_lshlrev_b32 v104, 16, v152
v_and_b32 v105, s64, v152
v_lshlrev_b32 v106, 16, v153
v_and_b32 v107, s64, v153
v_lshlrev_b32 v108, 16, v154
v_and_b32 v109, s64, v154
v_lshlrev_b32 v110, 16, v155
v_and_b32 v111, s64, v155
v_lshlrev_b32 v112, 16, v156
v_and_b32 v113, s64, v156
v_lshlrev_b32 v114, 16, v157
v_and_b32 v115, s64, v157
v_lshlrev_b32 v116, 16, v158
v_and_b32 v117, s64, v158
v_lshlrev_b32 v118, 16, v159
v_and_b32 v119, s64, v159
v_lshlrev_b32 v120, 16, v160
v_and_b32 v121, s64, v160
v_lshlrev_b32 v122, 16, v161
v_and_b32 v123, s64, v161
v_lshlrev_b32 v64, 16, v32
v_and_b32 v65, s64, v32
v_lshlrev_b32 v66, 16, v33
v_and_b32 v67, s64, v33
v_lshlrev_b32 v68, 16, v34
v_and_b32 v69, s64, v34
v_lshlrev_b32 v70, 16, v35
v_and_b32 v71, s64, v35
v_lshlrev_b32 v72, 16, v36
v_and_b32 v73, s64, v36
v_lshlrev_b32 v74, 16, v37
v_and_b32 v75, s64, v37
v_lshlrev_b32 v76, 16, v38
v_and_b32 v77, s64, v38
v_lshlrev_b32 v78, 16, v39
v_and_b32 v79, s64, v39
v_lshlrev_b32 v80, 16, v40
v_and_b32 v81, s64, v40
v_lshlrev_b32 v82, 16, v41
v_and_b32 v83, s64, v41
global_load_dwordx4 v[184:187], v18, s[8:9] offset:0 sc1
global_load_dwordx4 v[188:191], v18, s[8:9] offset:1024 sc1
s_waitcnt vmcnt(0)
v_xor_b32 v192, v185, v187
v_xor_b32 v193, v189, v191
v_xor_b32 v194, s65, v185
v_xor_b32 v195, s65, v189
v_or3_b32 v192, v192, v193, v194
v_or_b32 v192, v192, v195
v_cmp_ne_u32 vcc, 0, v192
s_cbranch_vccnz retry_107
got_108:
v_add_f32 v184, v184, v188
v_add_f32 v185, v186, v190
v_mov_b32 v186, v184
v_mov_b32 v187, v185
s_nop 0
v_permlane32_swap_b32 v184, v186
v_permlane32_swap_b32 v185, v187
v_pk_add_f32 v[184:185], v[184:185], v[186:187]
v_mov_b32 v186, v184
v_mov_b32 v187, v185
s_nop 0
v_permlane16_swap_b32 v184, v186
v_permlane16_swap_b32 v185, v187
v_pk_add_f32 v[184:185], v[184:185], v[186:187]
v_mul_f32 v184, 0x3acccccd, v184
v_mul_f32 v185, 0x3acccccd, v185
v_fma_f32 v188, -v184, v184, v185
v_max_f32 v188, 0, v188
v_add_f32 v189, 0x3727c5ac, v188
v_rsq_f32 v185, v189
s_nop 0
ds_write_b64 v21, v[184:185]
s_waitcnt lgkmcnt(0)
s_barrier
ds_read_b64 v[200:201], v22 offset:0
ds_read_b64 v[204:205], v22 offset:256
ds_read_b64 v[208:209], v22 offset:512
ds_read_b64 v[212:213], v22 offset:768
ds_read_b64 v[216:217], v21 offset:0
s_waitcnt lgkmcnt(4)
v_pk_add_f32 v[192:193], v[104:105], v[200:201] op_sel_hi:[1,0] neg_lo:[0,1] neg_hi:[0,1]
v_pk_add_f32 v[194:195], v[106:107], v[200:201] op_sel_hi:[1,0] neg_lo:[0,1] neg_hi:[0,1]
v_pk_mul_f32 v[192:193], v[192:193], v[200:201] op_sel:[0,1] op_sel_hi:[1,1]
v_pk_mul_f32 v[194:195], v[194:195], v[200:201] op_sel:[0,1] op_sel_hi:[1,1]
v_pk_fma_f32 v[104:105], v[192:193], v[64:65], v[104:105]
v_pk_fma_f32 v[106:107], v[194:195], v[66:67], v[106:107]
v_cvt_pk_bf16_f32 v42, v104, v105
v_cvt_pk_bf16_f32 v43, v106, v107
s_cmp_lg_u32 s23, 0
s_cbranch_scc1 slow_109
global_store_dwordx2 v11, v[42:43], s[16:17] offset:0
back_110:
s_waitcnt lgkmcnt(3)
v_pk_add_f32 v[192:193], v[108:109], v[204:205] op_sel_hi:[1,0] neg_lo:[0,1] neg_hi:[0,1]
v_pk_add_f32 v[194:195], v[110:111], v[204:205] op_sel_hi:[1,0] neg_lo:[0,1] neg_hi:[0,1]
v_pk_mul_f32 v[192:193], v[192:193], v[204:205] op_sel:[0,1] op_sel_hi:[1,1]
v_pk_mul_f32 v[194:195], v[194:195], v[204:205] op_sel:[0,1] op_sel_hi:[1,1]
v_pk_fma_f32 v[108:109], v[192:193], v[68:69], v[108:109]
v_pk_fma_f32 v[110:111], v[194:195], v[70:71], v[110:111]
v_cvt_pk_bf16_f32 v44, v108, v109
v_cvt_pk_bf16_f32 v45, v110, v111
s_cbranch_scc1 slow_111
global_store_dwordx2 v11, v[44:45], s[16:17] offset:256
back_112:
s_waitcnt lgkmcnt(2)
v_pk_add_f32 v[192:193], v[112:113], v[208:209] op_sel_hi:[1,0] neg_lo:[0,1] neg_hi:[0,1]
v_pk_add_f32 v[194:195], v[114:115], v[208:209] op_sel_hi:[1,0] neg_lo:[0,1] neg_hi:[0,1]
v_pk_mul_f32 v[192:193], v[192:193], v[208:209] op_sel:[0,1] op_sel_hi:[1,1]
v_pk_mul_f32 v[194:195], v[194:195], v[208:209] op_sel:[0,1] op_sel_hi:[1,1]
v_pk_fma_f32 v[112:113], v[192:193], v[72:73], v[112:113]
v_pk_fma_f32 v[114:115], v[194:195], v[74:75], v[114:115]
v_cvt_pk_bf16_f32 v46, v112, v113
v_cvt_pk_bf16_f32 v47, v114, v115
s_cbranch_scc1 slow_113
global_store_dwordx2 v11, v[46:47], s[16:17] offset:512
back_114:
s_waitcnt lgkmcnt(1)
v_pk_add_f32 v[192:193], v[116:117], v[212:213] op_sel_hi:[1,0] neg_lo:[0,1] neg_hi:[0,1]
v_pk_add_f32 v[194:195], v[118:119], v[212:213] op_sel_hi:[1,0] neg_lo:[0,1] neg_hi:[0,1]
v_pk_mul_f32 v[192:193], v[192:193], v[212:213] op_sel:[0,1] op_sel_hi:[1,1]
v_pk_mul_f32 v[194:195], v[194:195], v[212:213] op_sel:[0,1] op_sel_hi:[1,1]
v_pk_fma_f32 v[116:117], v[192:193], v[76:77], v[116:117]
v_pk_fma_f32 v[118:119], v[194:195], v[78:79], v[118:119]
v_cvt_pk_bf16_f32 v48, v116, v117
v_cvt_pk_bf16_f32 v49, v118, v119
s_cbranch_scc1 slow_115
global_store_dwordx2 v11, v[48:49], s[16:17] offset:768
back_116:
s_waitcnt lgkmcnt(0)
v_pk_add_f32 v[192:193], v[120:121], v[216:217] op_sel_hi:[1,0] neg_lo:[0,1] neg_hi:[0,1]
v_pk_add_f32 v[194:195], v[122:123], v[216:217] op_sel_hi:[1,0] neg_lo:[0,1] neg_hi:[0,1]
v_pk_mul_f32 v[192:193], v[192:193], v[216:217] op_sel:[0,1] op_sel_hi:[1,1]
v_pk_mul_f32 v[194:195], v[194:195], v[216:217] op_sel:[0,1] op_sel_hi:[1,1]
v_pk_fma_f32 v[120:121], v[192:193], v[80:81], v[120:121]
v_pk_fma_f32 v[122:123], v[194:195], v[82:83], v[122:123]
v_cvt_pk_bf16_f32 v50, v120, v121
v_cvt_pk_bf16_f32 v51, v122, v123
s_cbranch_scc1 slow_117
global_store_dwordx2 v12, v[50:51], s[16:17] offset:0
back_118:
v_pk_add_f32 v[152:153], v[104:105], v[106:107]
v_pk_mul_f32 v[154:155], v[104:105], v[104:105]
v_pk_add_f32 v[156:157], v[108:109], v[110:111]
v_pk_mul_f32 v[158:159], v[108:109], v[108:109]
v_pk_add_f32 v[160:161], v[112:113], v[114:115]
v_pk_mul_f32 v[162:163], v[112:113], v[112:113]
v_pk_add_f32 v[164:165], v[116:117], v[118:119]
v_pk_mul_f32 v[166:167], v[116:117], v[116:117]
v_pk_add_f32 v[168:169], v[120:121], v[122:123]
v_pk_mul_f32 v[170:171], v[120:121], v[120:121]
v_pk_fma_f32 v[154:155], v[106:107], v[106:107], v[154:155]
v_add_f32 v152, v152, v153
v_pk_fma_f32 v[158:159], v[110:111], v[110:111], v[158:159]
v_add_f32 v156, v156, v157
v_pk_fma_f32 v[162:163], v[114:115], v[114:115], v[162:163]
v_add_f32 v160, v160, v161
v_pk_fma_f32 v[166:167], v[118:119], v[118:119], v[166:167]
v_add_f32 v164, v164, v165
v_pk_fma_f32 v[170:171], v[122:123], v[122:123], v[170:171]
v_add_f32 v168, v168, v169
v_add_f32 v153, v154, v155
v_add_f32 v157, v158, v159
v_add_f32 v161, v162, v163
v_add_f32 v165, v166, v167
v_add_f32 v169, v170, v171
v_fmac_f32 v152, s60, v168
v_fmac_f32 v153, s60, v169
v_fmac_f32 v156, s61, v168
v_fmac_f32 v157, s61, v169
v_fmac_f32 v160, s62, v168
v_fmac_f32 v161, s62, v169
v_fmac_f32 v164, s63, v168
v_fmac_f32 v165, s63, v169
v_permlane32_swap_b32 v152, v160
v_permlane32_swap_b32 v156, v164
v_permlane32_swap_b32 v153, v161
v_permlane32_swap_b32 v157, v165
v_pk_add_f32 v[152:153], v[152:153], v[160:161]
v_pk_add_f32 v[156:157], v[156:157], v[164:165]
s_nop 1
v_permlane16_swap_b32 v152, v156
v_permlane16_swap_b32 v153, v157
v_pk_add_f32 v[152:153], v[152:153], v[156:157]
ds_write_b64 v20, v[152:153]
s_waitcnt lgkmcnt(0)
s_barrier
ds_read_b64 v[184:185], v19 offset:0
ds_read_b64 v[186:187], v19 offset:512
ds_read_b64 v[188:189], v19 offset:1024
ds_read_b64 v[190:191], v19 offset:1536
s_add_u32 s74, s28, 0
s_add_u32 s65, s75, 20
v_mov_b32 v193, s65
v_mov_b32 v195, s65
s_waitcnt lgkmcnt(0)
v_pk_add_f32 v[184:185], v[184:185], v[186:187]
v_pk_add_f32 v[188:189], v[188:189], v[190:191]
v_add_f32 v192, v184, v188
v_add_f32 v194, v185, v189
s_cmp_lg_u32 s23, 0
s_cbranch_scc1 slow_119
buffer_store_dwordx4 v[192:195], v220, s[16:19], s74 offen
back_120:
s_add_u32 s26, s75, 7
v_mov_b32 v63, s26
s_waitcnt vmcnt(1) lgkmcnt(0)
s_barrier
s_cmp_lg_u32 s23, 0
s_cbranch_scc1 slow_121
buffer_store_dword v63, v17, s[16:19], s27 offen
back_122:
s_add_u32 s73, s38, 0
s_add_u32 s73, s73, s24
s_add_u32 s90, s16, s73
s_addc_u32 s91, s17, 0
s_mov_b32 m0, s38
s_mov_b32 s36, 0
s_add_u32 s26, s75, 7
poll_123:
global_load_dword v63, v16, s[16:17] sc1
global_load_dwordx4 v[184:187], v18, s[16:17] offset:0 sc1
global_load_dwordx4 v[188:191], v18, s[16:17] offset:1024 sc1
s_add_u32 s36, s36, 1
s_cmp_gt_u32 s36, 0x200000
s_cbranch_scc1 k2_bail
s_waitcnt vmcnt(2)
v_subrev_u32 v63, s26, v63
v_cmp_lt_u32 vcc, 15, v63
s_cbranch_vccnz poll_123
global_load_lds_dwordx4 v2, s[90:91] offset:0 sc1
global_load_lds_dwordx4 v2, s[90:91] offset:1024 sc1
global_load_lds_dwordx4 v2, s[90:91] offset:2048 sc1
global_load_lds_dwordx4 v2, s[90:91] offset:3072 sc1
s_waitcnt vmcnt(4)
v_xor_b32 v192, v185, v187
v_xor_b32 v193, v189, v191
v_xor_b32 v194, s65, v185
v_xor_b32 v195, s65, v189
v_or3_b32 v192, v192, v193, v194
v_or_b32 v192, v192, v195
s_add_u32 s90, s90, 16384
s_addc_u32 s91, s91, 0
s_add_u32 m0, m0, 16384
s_nop 0
global_load_lds_dwordx4 v2, s[90:91] offset:0 sc1
v_cmp_ne_u32 vcc, 0, v192
s_cbranch_vccnz retry_124
got_125:
v_add_f32 v184, v184, v188
v_add_f32 v185, v186, v190
v_mov_b32 v186, v184
v_mov_b32 v187, v185
s_nop 0
v_permlane32_swap_b32 v184, v186
global_load_lds_dwordx4 v2, s[90:91] offset:1024 sc1
v_permlane32_swap_b32 v185, v187
v_pk_add_f32 v[184:185], v[184:185], v[186:187]
v_mov_b32 v186, v184
v_mov_b32 v187, v185
s_nop 0
v_permlane16_swap_b32 v184, v186
v_permlane16_swap_b32 v185, v187
v_pk_add_f32 v[184:185], v[184:185], v[186:187]
global_load_lds_dwordx4 v2, s[90:91] offset:2048 sc1
v_mul_f32 v184, 0x3acccccd, v184
v_mul_f32 v185, 0x3acccccd, v185
v_fma_f32 v188, -v184, v184, v185
v_max_f32 v188, 0, v188
v_add_f32 v189, 0x3727c5ac, v188
v_rsq_f32 v190, v189
v_fmamk_f32 v189, v189, 0x3727c5ac, v188
global_load_lds_dwordx4 v2, s[90:91] offset:3072 sc1
ds_write_b32 v21, v190 offset:1024
v_rsq_f32 v188, v189
s_nop 0
v_mul_f32 v185, v189, v188
v_mul_f32 v186, 0xc0135761, v188
v_mul_f32 v187, 0xbdd2d3e8, v188
v_mul_f32 v188, v188, v188
v_mul_f32 v187, v187, v188
ds_write_b128 v21, v[184:187]
s_waitcnt vmcnt(4) lgkmcnt(0)
s_barrier
ds_read_b128 v[152:155], v3 offset:0
ds_read_b128 v[156:159], v3 offset:256
ds_read_b128 v[160:163], v3 offset:512
ds_read_b128 v[164:167], v3 offset:768
ds_read_b128 v[168:171], v4 offset:0
ds_read_b128 v[172:175], v4 offset:256
ds_read_b128 v[176:179], v4 offset:512
ds_read_b128 v[180:183], v4 offset:768
s_waitcnt lgkmcnt(4)
v_mfma_f32_16x16x32_bf16 v[104:107], a[0:3], v[152:155], 0
ds_read_b128 v[184:187], v5 offset:0
v_mfma_f32_16x16x32_bf16 v[108:111], a[0:3], v[156:159], 0
ds_read_b128 v[188:191], v5 offset:256
s_add_u32 s90, s90, 16384
s_addc_u32 s91, s91, 0
s_add_u32 m0, m0, 16384
s_nop 0
global_load_lds_dwordx4 v2, s[90:91] offset:0 sc1
v_mfma_f32_16x16x32_bf16 v[112:115], a[0:3], v[160:163], 0
ds_read_b128 v[192:195], v5 offset:512
v_mfma_f32_16x16x32_bf16 v[116:119], a[0:3], v[164:167], 0
ds_read_b128 v[196:199], v5 offset:768
global_load_lds_dwordx4 v2, s[90:91] offset:1024 sc1
v_mfma_f32_16x16x32_bf16 v[120:123], a[4:7], v[152:155], 0
v_mfma_f32_16x16x32_bf16 v[124:127], a[4:7], v[156:159], 0
v_mfma_f32_16x16x32_bf16 v[128:131], a[4:7], v[160:163], 0
v_mfma_f32_16x16x32_bf16 v[132:135], a[4:7], v[164:167], 0
s_waitcnt lgkmcnt(4)
v_mfma_f32_16x16x32_bf16 v[104:107], a[8:11], v[168:171], v[104:107]
ds_read_b128 v[152:155], v6 offset:0
v_mfma_f32_16x16x32_bf16 v[108:111], a[8:11], v[172:175], v[108:111]
ds_read_b128 v[156:159], v6 offset:256
global_load_lds_dwordx4 v2, s[90:91] offset:2048 sc1
v_mfma_f32_16x16x32_bf16 v[112:115], a[8:11], v[176:179], v[112:115]
ds_read_b128 v[160:163], v6 offset:512
v_mfma_f32_16x16x32_bf16 v[116:119], a[8:11], v[180:183], v[116:119]
ds_read_b128 v[164:167], v6 offset:768
global_load_lds_dwordx4 v2, s[90:91] offset:3072 sc1
s_waitcnt vmcnt(4)
s_barrier
s_waitcnt lgkmcnt(4)
v_mfma_f32_16x16x32_bf16 v[104:107], a[12:15], v[184:187], v[104:107]
ds_read_b128 v[168:171], v3 offset:16384
v_mfma_f32_16x16x32_bf16 v[108:111], a[12:15], v[188:191], v[108:111]
ds_read_b128 v[172:175], v3 offset:16640
s_add_u32 s90, s90, 16384
s_addc_u32 s91, s91, 0
s_add_u32 m0, m0, 16384
s_nop 0
global_load_lds_dwordx4 v2, s[90:91] offset:0 sc1
v_mfma_f32_16x16x32_bf16 v[112:115], a[12:15], v[192:195], v[112:115]
ds_read_b128 v[176:179], v3 offset:16896
v_mfma_f32_16x16x32_bf16 v[116:119], a[12:15], v[196:199], v[116:119]
ds_read_b128 v[180:183], v3 offset:17152
global_load_lds_dwordx4 v2, s[90:91] offset:1024 sc1
s_waitcnt lgkmcnt(4)
v_mfma_f32_16x16x32_bf16 v[104:107], a[16:19], v[152:155], v[104:107]
ds_read_b128 v[184:187], v4 offset:16384
v_mfma_f32_16x16x32_bf16 v[108:111], a[16:19], v[156:159], v[108:111]
ds_read_b128 v[188:191], v4 offset:16640
global_load_lds_dwordx4 v2, s[90:91] offset:2048 sc1
v_mfma_f32_16x16x32_bf16 v[112:115], a[16:19], v[160:163], v[112:115]
ds_read_b128 v[192:195], v4 offset:16896
v_mfma_f32_16x16x32_bf16 v[116:119], a[16:19], v[164:167], v[116:119]
ds_read_b128 v[196:199], v4 offset:17152
global_load_lds_dwordx4 v2, s[90:91] offset:3072 sc1
s_waitcnt lgkmcnt(4)
v_mfma_f32_16x16x32_bf16 v[104:107], a[20:23], v[168:171], v[104:107]
ds_read_b128 v[152:155], v5 offset:16384
v_mfma_f32_16x16x32_bf16 v[108:111], a[20:23], v[172:175], v[108:111]
ds_read_b128 v[156:159], v5 offset:16640
s_add_u32 s90, s90, 16384
s_addc_u32 s91, s91, 0
s_add_u32 m0, m0, 16384
s_nop 0
global_load_lds_dwordx4 v2, s[90:91] offset:0 sc1
v_mfma_f32_16x16x32_bf16 v[112:115], a[20:23], v[176:179], v[112:115]
ds_read_b128 v[160:163], v5 offset:16896
v_mfma_f32_16x16x32_bf16 v[116:119], a[20:23], v[180:183], v[116:119]
ds_read_b128 v[164:167], v5 offset:17152
global_load_lds_dwordx4 v2, s[90:91] offset:1024 sc1
v_mfma_f32_16x16x32_bf16 v[120:123], a[24:27], v[168:171], v[120:123]
v_mfma_f32_16x16x32_bf16 v[124:127], a[24:27], v[172:175], v[124:127]
v_mfma_f32_16x16x32_bf16 v[128:131], a[24:27], v[176:179], v[128:131]
v_mfma_f32_16x16x32_bf16 v[132:135], a[24:27], v[180:183], v[132:135]
s_waitcnt lgkmcnt(4)
v_mfma_f32_16x16x32_bf16 v[104:107], a[28:31], v[184:187], v[104:107]
ds_read_b128 v[168:171], v6 offset:16384
v_mfma_f32_16x16x32_bf16 v[108:111], a[28:31], v[188:191], v[108:111]
ds_read_b128 v[172:175], v6 offset:16640
global_load_lds_dwordx4 v2, s[90:91] offset:2048 sc1
v_mfma_f32_16x16x32_bf16 v[112:115], a[28:31], v[192:195], v[112:115]
ds_read_b128 v[176:179], v6 offset:16896
v_mfma_f32_16x16x32_bf16 v[116:119], a[28:31], v[196:199], v[116:119]
ds_read_b128 v[180:183], v6 offset:17152
global_load_lds_dwordx4 v2, s[90:91] offset:3072 sc1
s_waitcnt vmcnt(8)
s_barrier
s_waitcnt lgkmcnt(4)
v_mfma_f32_16x16x32_bf16 v[104:107], a[32:35], v[152:155], v[104:107]
ds_read_b128 v[184:187], v3 offset:32768
v_mfma_f32_16x16x32_bf16 v[108:111], a[32:35], v[156:159], v[108:111]
ds_read_b128 v[188:191], v3 offset:33024
v_mfma_f32_16x16x32_bf16 v[112:115], a[32:35], v[160:163], v[112:115]
ds_read_b128 v[192:195], v3 offset:33280
v_mfma_f32_16x16x32_bf16 v[116:119], a[32:35], v[164:167], v[116:119]
ds_read_b128 v[196:199], v3 offset:33536
s_waitcnt lgkmcnt(4)
v_mfma_f32_16x16x32_bf16 v[104:107], a[36:39], v[168:171], v[104:107]
ds_read_b128 v[152:155], v4 offset:32768
v_mfma_f32_16x16x32_bf16 v[108:111], a[36:39], v[172:175], v[108:111]
ds_read_b128 v[156:159], v4 offset:33024
v_mfma_f32_16x16x32_bf16 v[112:115], a[36:39], v[176:179], v[112:115]
ds_read_b128 v[160:163], v4 offset:33280
v_mfma_f32_16x16x32_bf16 v[116:119], a[36:39], v[180:183], v[116:119]
ds_read_b128 v[164:167], v4 offset:33536
s_waitcnt lgkmcnt(4)
v_mfma_f32_16x16x32_bf16 v[104:107], a[40:43], v[184:187], v[104:107]
ds_read_b128 v[168:171], v5 offset:32768
global_load_dwordx4 a[172:175], v2, s[92:93] offset:1024
v_mfma_f32_16x16x32_bf16 v[108:111], a[40:43], v[188:191], v[108:111]
ds_read_b128 v[172:175], v5 offset:33024
v_mfma_f32_16x16x32_bf16 v[112:115], a[40:43], v[192:195], v[112:115]
ds_read_b128 v[176:179], v5 offset:33280
v_mfma_f32_16x16x32_bf16 v[116:119], a[40:43], v[196:199], v[116:119]
ds_read_b128 v[180:183], v5 offset:33536
v_mfma_f32_16x16x32_bf16 v[120:123], a[44:47], v[184:187], v[120:123]
v_mfma_f32_16x16x32_bf16 v[124:127], a[44:47], v[188:191], v[124:127]
v_mfma_f32_16x16x32_bf16 v[128:131], a[44:47], v[192:195], v[128:131]
v_mfma_f32_16x16x32_bf16 v[132:135], a[44:47], v[196:199], v[132:135]
s_waitcnt lgkmcnt(4)
v_mfma_f32_16x16x32_bf16 v[104:107], a[48:51], v[152:155], v[104:107]
ds_read_b128 v[184:187], v6 offset:32768
s_sub_u32 s92, s92, 24576
s_subb_u32 s93, s93, 0
global_load_dwordx4 a[176:179], v2, s[92:93] offset:2048
v_mfma_f32_16x16x32_bf16 v[108:111], a[48:51], v[156:159], v[108:111]
ds_read_b128 v[188:191], v6 offset:33024
v_mfma_f32_16x16x32_bf16 v[112:115], a[48:51], v[160:163], v[112:115]
ds_read_b128 v[192:195], v6 offset:33280
v_mfma_f32_16x16x32_bf16 v[116:119], a[48:51], v[164:167], v[116:119]
ds_read_b128 v[196:199], v6 offset:33536
s_waitcnt vmcnt(6)
s_barrier
s_waitcnt lgkmcnt(4)
v_mfma_f32_16x16x32_bf16 v[104:107], a[52:55], v[168:171], v[104:107]
ds_read_b128 v[152:155], v3 offset:49152
global_load_dwordx4 a[180:183], v2, s[92:93] offset:3072
v_mfma_f32_16x16x32_bf16 v[108:111], a[52:55], v[172:175], v[108:111]
ds_read_b128 v[156:159], v3 offset:49408
v_mfma_f32_16x16x32_bf16 v[112:115], a[52:55], v[176:179], v[112:115]
ds_read_b128 v[160:163], v3 offset:49664
v_mfma_f32_16x16x32_bf16 v[116:119], a[52:55], v[180:183], v[116:119]
ds_read_b128 v[164:167], v3 offset:49920
s_waitcnt lgkmcnt(4)
v_mfma_f32_16x16x32_bf16 v[104:107], a[56:59], v[184:187], v[104:107]
ds_read_b128 v[168:171], v4 offset:49152
s_add_u32 s92, s92, 4096
s_addc_u32 s93, s93, 0
global_load_dwordx4 a[184:187], v2, s[92:93] offset:0
v_mfma_f32_16x16x32_bf16 v[108:111], a[56:59], v[188:191], v[108:111]
ds_read_b128 v[172:175], v4 offset:49408
global_load_dwordx4 a[188:191], v2, s[92:93] offset:1024
v_mfma_f32_16x16x32_bf16 v[112:115], a[56:59], v[192:195], v[112:115]
ds_read_b128 v[176:179], v4 offset:49664
v_mfma_f32_16x16x32_bf16 v[116:119], a[56:59], v[196:199], v[116:119]
ds_read_b128 v[180:183], v4 offset:49920
s_waitcnt lgkmcnt(4)
v_mfma_f32_16x16x32_bf16 v[104:107], a[60:63], v[152:155], v[104:107]
ds_read_b128 v[184:187], v5 offset:49152
s_mul_i32 s26, s22, 10240
v_mfma_f32_16x16x32_bf16 v[108:111], a[60:63], v[156:159], v[108:111]
ds_read_b128 v[188:191], v5 offset:49408
s_mul_i32 s31, s20, 2560
v_mfma_f32_16x16x32_bf16 v[112:115], a[60:63], v[160:163], v[112:115]
ds_read_b128 v[192:195], v5 offset:49664
s_add_u32 s26, s26, s31
v_mfma_f32_16x16x32_bf16 v[116:119], a[60:63], v[164:167], v[116:119]
ds_read_b128 v[196:199], v5 offset:49920
s_add_u32 s26, s26, s24
v_mfma_f32_16x16x32_bf16 v[120:123], a[64:67], v[152:155], v[120:123]
s_add_u32 s26, s26, 81920
v_mfma_f32_16x16x32_bf16 v[124:127], a[64:67], v[156:159], v[124:127]
buffer_load_dword v62, v30, s[16:19], s26 offen sc1
v_mfma_f32_16x16x32_bf16 v[128:131], a[64:67], v[160:163], v[128:131]
global_load_dwordx4 a[192:195], v2, s[92:93] offset:2048
v_mfma_f32_16x16x32_bf16 v[132:135], a[64:67], v[164:167], v[132:135]
s_waitcnt lgkmcnt(4)
v_mfma_f32_16x16x32_bf16 v[104:107], a[68:71], v[168:171], v[104:107]
ds_read_b128 v[152:155], v6 offset:49152
global_load_dwordx4 a[196:199], v2, s[92:93] offset:3072
v_mfma_f32_16x16x32_bf16 v[108:111], a[68:71], v[172:175], v[108:111]
ds_read_b128 v[156:159], v6 offset:49408
v_mfma_f32_16x16x32_bf16 v[112:115], a[68:71], v[176:179], v[112:115]
ds_read_b128 v[160:163], v6 offset:49664
v_mfma_f32_16x16x32_bf16 v[116:119], a[68:71], v[180:183], v[116:119]
ds_read_b128 v[164:167], v6 offset:49920
s_waitcnt vmcnt(8)
s_barrier
s_waitcnt lgkmcnt(4)
v_mfma_f32_16x16x32_bf16 v[104:107], a[72:75], v[184:187], v[104:107]
ds_read_b128 v[168:171], v7 offset:0
s_add_u32 s92, s92, 4096
s_addc_u32 s93, s93, 0
global_load_dwordx4 a[200:203], v2, s[92:93] offset:0
v_mfma_f32_16x16x32_bf16 v[108:111], a[72:75], v[188:191], v[108:111]
ds_read_b128 v[172:175], v7 offset:256
v_mfma_f32_16x16x32_bf16 v[112:115], a[72:75], v[192:195], v[112:115]
ds_read_b128 v[176:179], v7 offset:512
v_mfma_f32_16x16x32_bf16 v[116:119], a[72:75], v[196:199], v[116:119]
ds_read_b128 v[180:183], v7 offset:768
s_waitcnt lgkmcnt(4)
v_mfma_f32_16x16x32_bf16 v[104:107], a[76:79], v[152:155], v[104:107]
ds_read_b128 v[184:187], v8 offset:0
global_load_dwordx4 a[204:207], v2, s[92:93] offset:1024
v_mfma_f32_16x16x32_bf16 v[108:111], a[76:79], v[156:159], v[108:111]
ds_read_b128 v[188:191], v8 offset:256
global_load_dwordx4 a[208:211], v2, s[92:93] offset:2048
v_mfma_f32_16x16x32_bf16 v[112:115], a[76:79], v[160:163], v[112:115]
ds_read_b128 v[192:195], v8 offset:512
v_mfma_f32_16x16x32_bf16 v[116:119], a[76:79], v[164:167], v[116:119]
ds_read_b128 v[196:199], v8 offset:768
s_waitcnt lgkmcnt(4)
v_mfma_f32_16x16x32_bf16 v[104:107], a[80:83], v[168:171], v[104:107]
ds_read_b128 v[152:155], v9 offset:0
ds_read_b128 v[200:203], v22 offset:0
v_mfma_f32_16x16x32_bf16 v[108:111], a[80:83], v[172:175], v[108:111]
ds_read_b128 v[156:159], v9 offset:256
ds_read_b128 v[204:207], v22 offset:256
v_mfma_f32_16x16x32_bf16 v[112:115], a[80:83], v[176:179], v[112:115]
ds_read_b128 v[160:163], v9 offset:512
ds_read_b128 v[208:211], v22 offset:512
v_mfma_f32_16x16x32_bf16 v[116:119], a[80:83], v[180:183], v[116:119]
ds_read_b128 v[164:167], v9 offset:768
ds_read_b128 v[212:215], v22 offset:768
v_mfma_f32_16x16x32_bf16 v[120:123], a[84:87], v[168:171], v[120:123]
ds_read_b128 v[216:219], v21 offset:0
v_mfma_f32_16x16x32_bf16 v[124:127], a[84:87], v[172:175], v[124:127]
global_load_dwordx4 a[212:215], v2, s[92:93] offset:3072
v_mfma_f32_16x16x32_bf16 v[128:131], a[84:87], v[176:179], v[128:131]
v_mfma_f32_16x16x32_bf16 v[132:135], a[84:87], v[180:183], v[132:135]
s_waitcnt lgkmcnt(9)
v_mfma_f32_16x16x32_bf16 v[104:107], a[88:91], v[184:187], v[104:107]
ds_read_b128 v[168:171], v10 offset:0
s_add_u32 s92, s92, 4096
s_addc_u32 s93, s93, 0
global_load_dwordx4 a[216:219], v2, s[92:93] offset:0
v_mfma_f32_16x16x32_bf16 v[108:111], a[88:91], v[188:191], v[108:111]
ds_read_b128 v[172:175], v10 offset:256
v_mfma_f32_16x16x32_bf16 v[112:115], a[88:91], v[192:195], v[112:115]
ds_read_b128 v[176:179], v10 offset:512
v_mfma_f32_16x16x32_bf16 v[116:119], a[88:91], v[196:199], v[116:119]
ds_read_b128 v[180:183], v10 offset:768
s_waitcnt lgkmcnt(6)
v_mfma_f32_16x16x32_bf16 v[104:107], a[92:95], v[152:155], v[104:107]
ds_write_b128 v23, v[120:123] offset:0
ds_write_b128 v23, v[124:127] offset:1024
v_mfma_f32_16x16x32_bf16 v[108:111], a[92:95], v[156:159], v[108:111]
ds_write_b128 v23, v[128:131] offset:2048
ds_write_b128 v23, v[132:135] offset:3072
v_mfma_f32_16x16x32_bf16 v[112:115], a[92:95], v[160:163], v[112:115]
global_load_dwordx4 a[220:223], v2, s[92:93] offset:1024
v_mfma_f32_16x16x32_bf16 v[116:119], a[92:95], v[164:167], v[116:119]
s_waitcnt lgkmcnt(4)
v_mfma_f32_16x16x32_bf16 v[104:107], a[96:99], v[168:171], v[104:107]
s_sub_u32 s92, s92, 24576
s_subb_u32 s93, s93, 0
global_load_dwordx4 a[224:227], v2, s[92:93] offset:2048
v_mfma_f32_16x16x32_bf16 v[108:111], a[96:99], v[172:175], v[108:111]
global_load_dwordx4 a[228:231], v2, s[92:93] offset:3072
v_mfma_f32_16x16x32_bf16 v[112:115], a[96:99], v[176:179], v[112:115]
v_mfma_f32_16x16x32_bf16 v[116:119], a[96:99], v[180:183], v[116:119]
s_waitcnt lgkmcnt(0)
s_barrier
ds_read_b128 v[152:155], v24 offset:0
ds_read_b128 v[156:159], v24 offset:4096
ds_read_b128 v[160:163], v24 offset:8192
ds_read_b128 v[164:167], v24 offset:12288
s_add_u32 s92, s92, 4096
s_addc_u32 s93, s93, 0
global_load_dwordx4 a[232:235], v2, s[92:93] offset:0
global_load_dwordx4 a[236:239], v2, s[92:93] offset:1024
global_load_dwordx4 a[240:243], v2, s[92:93] offset:2048
s_add_u32 s26, s24, s35
s_add_u32 s26, s26, 81920
s_add_u32 s31, s30, 163840
s_add_u32 s65, s75, 25
v_pk_fma_f32 v[104:105], v[84:85], v[200:201], v[104:105] op_sel_hi:[1,0,1] neg_lo:[0,1,0] neg_hi:[0,1,0]
v_pk_fma_f32 v[106:107], v[86:87], v[200:201], v[106:107] op_sel_hi:[1,0,1] neg_lo:[0,1,0] neg_hi:[0,1,0]
v_pk_mul_f32 v[188:189], v[104:105], v[104:105]
v_pk_mul_f32 v[190:191], v[106:107], v[106:107]
v_pk_fma_f32 v[188:189], v[188:189], v[202:203], v[202:203] op_sel:[0,1,0] op_sel_hi:[1,1,0]
v_pk_fma_f32 v[190:191], v[190:191], v[202:203], v[202:203] op_sel:[0,1,0] op_sel_hi:[1,1,0]
v_pk_mul_f32 v[188:189], v[188:189], v[104:105]
v_pk_mul_f32 v[190:191], v[190:191], v[106:107]
v_exp_f32 v188, v188
v_exp_f32 v189, v189
v_exp_f32 v190, v190
v_exp_f32 v191, v191
v_pk_fma_f32 v[188:189], v[188:189], v[200:201], v[200:201] op_sel:[0,1,1] op_sel_hi:[1,1,1]
v_pk_fma_f32 v[190:191], v[190:191], v[200:201], v[200:201] op_sel:[0,1,1] op_sel_hi:[1,1,1]
v_rcp_f32 v188, v188
v_rcp_f32 v189, v189
v_rcp_f32 v190, v190
v_rcp_f32 v191, v191
v_pk_mul_f32 v[104:105], v[104:105], v[188:189]
v_pk_mul_f32 v[106:107], v[106:107], v[190:191]
v_cvt_pk_bf16_f32 v136, v104, v105
v_cvt_pk_bf16_f32 v137, v106, v107
s_mov_b64 exec, s[50:51]
s_cmp_lg_u32 s23, 0
s_cbranch_scc1 slow_126
global_store_dwordx2 v11, v[136:137], s[82:83] offset:0
back_127:
s_mov_b64 exec, -1
v_pk_fma_f32 v[116:117], v[84:85], v[212:213], v[116:117] op_sel_hi:[1,0,1] neg_lo:[0,1,0] neg_hi:[0,1,0]
v_pk_fma_f32 v[118:119], v[86:87], v[212:213], v[118:119] op_sel_hi:[1,0,1] neg_lo:[0,1,0] neg_hi:[0,1,0]
v_pk_mul_f32 v[188:189], v[116:117], v[116:117]
v_pk_mul_f32 v[190:191], v[118:119], v[118:119]
v_pk_fma_f32 v[188:189], v[188:189], v[214:215], v[214:215] op_sel:[0,1,0] op_sel_hi:[1,1,0]
v_pk_fma_f32 v[190:191], v[190:191], v[214:215], v[214:215] op_sel:[0,1,0] op_sel_hi:[1,1,0]
v_pk_mul_f32 v[188:189], v[188:189], v[116:117]
v_pk_mul_f32 v[190:191], v[190:191], v[118:119]
v_exp_f32 v188, v188
v_exp_f32 v189, v189
v_exp_f32 v190, v190
v_exp_f32 v191, v191
v_pk_fma_f32 v[188:189], v[188:189], v[212:213], v[212:213] op_sel:[0,1,1] op_sel_hi:[1,1,1]
v_pk_fma_f32 v[190:191], v[190:191], v[212:213], v[212:213] op_sel:[0,1,1] op_sel_hi:[1,1,1]
v_rcp_f32 v188, v188
v_rcp_f32 v189, v189
v_rcp_f32 v190, v190
v_rcp_f32 v191, v191
v_pk_mul_f32 v[116:117], v[116:117], v[188:189]
v_pk_mul_f32 v[118:119], v[118:119], v[190:191]
v_cvt_pk_bf16_f32 v142, v116, v117
v_cvt_pk_bf16_f32 v143, v118, v119
v_cndmask_b32 v192, v142, v136, s[66:67]
v_mov_b32 v193, s65
v_cndmask_b32 v194, v143, v137, s[66:67]
v_mov_b32 v195, s65
buffer_store_dwordx4 v[192:195], v27, s[16:19], s31 offen sc1
s_mov_b64 exec, s[52:53]
s_cbranch_scc1 slow_128
global_store_dwordx2 v11, v[142:143], s[82:83] offset:768
back_129:
s_mov_b64 exec, -1
s_waitcnt lgkmcnt(0)
v_pk_add_f32 v[152:153], v[152:153], v[156:157]
v_pk_add_f32 v[160:161], v[160:161], v[164:165]
v_pk_add_f32 v[154:155], v[154:155], v[158:159]
v_pk_add_f32 v[162:163], v[162:163], v[166:167]
v_pk_add_f32 v[120:121], v[152:153], v[160:161]
v_pk_add_f32 v[122:123], v[154:155], v[162:163]
v_pk_fma_f32 v[120:121], v[88:89], v[216:217], v[120:121] op_sel_hi:[1,0,1] neg_lo:[0,1,0] neg_hi:[0,1,0]
v_pk_fma_f32 v[122:123], v[90:91], v[216:217], v[122:123] op_sel_hi:[1,0,1] neg_lo:[0,1,0] neg_hi:[0,1,0]
v_pk_mul_f32 v[188:189], v[120:121], v[120:121]
v_pk_mul_f32 v[190:191], v[122:123], v[122:123]
v_pk_fma_f32 v[188:189], v[188:189], v[218:219], v[218:219] op_sel:[0,1,0] op_sel_hi:[1,1,0]
v_pk_fma_f32 v[190:191], v[190:191], v[218:219], v[218:219] op_sel:[0,1,0] op_sel_hi:[1,1,0]
v_pk_mul_f32 v[188:189], v[188:189], v[120:121]
v_pk_mul_f32 v[190:191], v[190:191], v[122:123]
v_exp_f32 v188, v188
v_exp_f32 v189, v189
v_exp_f32 v190, v190
v_exp_f32 v191, v191
v_pk_fma_f32 v[188:189], v[188:189], v[216:217], v[216:217] op_sel:[0,1,1] op_sel_hi:[1,1,1]
v_pk_fma_f32 v[190:191], v[190:191], v[216:217], v[216:217] op_sel:[0,1,1] op_sel_hi:[1,1,1]
v_rcp_f32 v188, v188
v_rcp_f32 v189, v189
v_rcp_f32 v190, v190
v_rcp_f32 v191, v191
v_pk_mul_f32 v[120:121], v[120:121], v[188:189]
v_pk_mul_f32 v[122:123], v[122:123], v[190:191]
v_cvt_pk_bf16_f32 v144, v120, v121
v_cvt_pk_bf16_f32 v145, v122, v123
v_mov_b32 v196, v144
v_mov_b32 v197, s65
v_mov_b32 v198, v145
v_mov_b32 v199, s65
buffer_store_dwordx4 v[196:199], v28, s[16:19], s31 offen sc1
s_mov_b64 exec, s[54:55]
s_cbranch_scc1 slow_130
global_store_dwordx2 v12, v[144:145], s[82:83] offset:0
back_131:
s_mov_b64 exec, -1
v_pk_fma_f32 v[108:109], v[84:85], v[204:205], v[108:109] op_sel_hi:[1,0,1] neg_lo:[0,1,0] neg_hi:[0,1,0]
v_pk_fma_f32 v[110:111], v[86:87], v[204:205], v[110:111] op_sel_hi:[1,0,1] neg_lo:[0,1,0] neg_hi:[0,1,0]
v_pk_mul_f32 v[188:189], v[108:109], v[108:109]
v_pk_mul_f32 v[190:191], v[110:111], v[110:111]
v_pk_fma_f32 v[188:189], v[188:189], v[206:207], v[206:207] op_sel:[0,1,0] op_sel_hi:[1,1,0]
v_pk_fma_f32 v[190:191], v[190:191], v[206:207], v[206:207] op_sel:[0,1,0] op_sel_hi:[1,1,0]
v_pk_mul_f32 v[188:189], v[188:189], v[108:109]
v_pk_mul_f32 v[190:191], v[190:191], v[110:111]
v_exp_f32 v188, v188
v_exp_f32 v189, v189
v_exp_f32 v190, v190
v_exp_f32 v191, v191
v_pk_fma_f32 v[188:189], v[188:189], v[204:205], v[204:205] op_sel:[0,1,1] op_sel_hi:[1,1,1]
v_pk_fma_f32 v[190:191], v[190:191], v[204:205], v[204:205] op_sel:[0,1,1] op_sel_hi:[1,1,1]
v_rcp_f32 v188, v188
v_rcp_f32 v189, v189
v_rcp_f32 v190, v190
v_rcp_f32 v191, v191
v_pk_mul_f32 v[108:109], v[108:109], v[188:189]
v_pk_mul_f32 v[110:111], v[110:111], v[190:191]
v_cvt_pk_bf16_f32 v138, v108, v109
v_cvt_pk_bf16_f32 v139, v110, v111
s_cbranch_scc1 slow_132
global_store_dwordx2 v11, v[138:139], s[82:83] offset:256
back_133:
v_pk_fma_f32 v[112:113], v[84:85], v[208:209], v[112:113] op_sel_hi:[1,0,1] neg_lo:[0,1,0] neg_hi:[0,1,0]
v_pk_fma_f32 v[114:115], v[86:87], v[208:209], v[114:115] op_sel_hi:[1,0,1] neg_lo:[0,1,0] neg_hi:[0,1,0]
v_pk_mul_f32 v[188:189], v[112:113], v[112:113]
v_pk_mul_f32 v[190:191], v[114:115], v[114:115]
v_pk_fma_f32 v[188:189], v[188:189], v[210:211], v[210:211] op_sel:[0,1,0] op_sel_hi:[1,1,0]
v_pk_fma_f32 v[190:191], v[190:191], v[210:211], v[210:211] op_sel:[0,1,0] op_sel_hi:[1,1,0]
v_pk_mul_f32 v[188:189], v[188:189], v[112:113]
v_pk_mul_f32 v[190:191], v[190:191], v[114:115]
v_exp_f32 v188, v188
v_exp_f32 v189, v189
v_exp_f32 v190, v190
v_exp_f32 v191, v191
v_pk_fma_f32 v[188:189], v[188:189], v[208:209], v[208:209] op_sel:[0,1,1] op_sel_hi:[1,1,1]
v_pk_fma_f32 v[190:191], v[190:191], v[208:209], v[208:209] op_sel:[0,1,1] op_sel_hi:[1,1,1]
v_rcp_f32 v188, v188
v_rcp_f32 v189, v189
v_rcp_f32 v190, v190
v_rcp_f32 v191, v191
v_pk_mul_f32 v[112:113], v[112:113], v[188:189]
v_pk_mul_f32 v[114:115], v[114:115], v[190:191]
v_cvt_pk_bf16_f32 v140, v112, v113
v_cvt_pk_bf16_f32 v141, v114, v115
s_cbranch_scc1 slow_134
global_store_dwordx2 v11, v[140:141], s[82:83] offset:512
back_135:
ds_read_b32 v201, v22 offset:1024
ds_read_b32 v205, v22 offset:1280
ds_read_b32 v209, v22 offset:1536
ds_read_b32 v213, v22 offset:1792
ds_read_b32 v217, v21 offset:1024
v_lshlrev_b32 v64, 16, v42
v_and_b32 v65, s64, v42
v_lshlrev_b32 v66, 16, v43
v_and_b32 v67, s64, v43
v_lshlrev_b32 v68, 16, v44
v_and_b32 v69, s64, v44
v_lshlrev_b32 v70, 16, v45
v_and_b32 v71, s64, v45
v_lshlrev_b32 v72, 16, v46
v_and_b32 v73, s64, v46
v_lshlrev_b32 v74, 16, v47
v_and_b32 v75, s64, v47
v_lshlrev_b32 v76, 16, v48
v_and_b32 v77, s64, v48
v_lshlrev_b32 v78, 16, v49
v_and_b32 v79, s64, v49
v_lshlrev_b32 v80, 16, v50
v_and_b32 v81, s64, v50
v_lshlrev_b32 v82, 16, v51
v_and_b32 v83, s64, v51
s_waitcnt lgkmcnt(4)
v_pk_add_f32 v[64:65], v[64:65], v[200:201] op_sel_hi:[1,0] neg_lo:[0,1] neg_hi:[0,1]
v_pk_add_f32 v[66:67], v[66:67], v[200:201] op_sel_hi:[1,0] neg_lo:[0,1] neg_hi:[0,1]
v_pk_mul_f32 v[64:65], v[64:65], v[200:201] op_sel:[0,1] op_sel_hi:[1,1]
v_pk_mul_f32 v[66:67], v[66:67], v[200:201] op_sel:[0,1] op_sel_hi:[1,1]
s_waitcnt lgkmcnt(3)
v_pk_add_f32 v[68:69], v[68:69], v[204:205] op_sel_hi:[1,0] neg_lo:[0,1] neg_hi:[0,1]
v_pk_add_f32 v[70:71], v[70:71], v[204:205] op_sel_hi:[1,0] neg_lo:[0,1] neg_hi:[0,1]
v_pk_mul_f32 v[68:69], v[68:69], v[204:205] op_sel:[0,1] op_sel_hi:[1,1]
v_pk_mul_f32 v[70:71], v[70:71], v[204:205] op_sel:[0,1] op_sel_hi:[1,1]
s_waitcnt lgkmcnt(2)
v_pk_add_f32 v[72:73], v[72:73], v[208:209] op_sel_hi:[1,0] neg_lo:[0,1] neg_hi:[0,1]
v_pk_add_f32 v[74:75], v[74:75], v[208:209] op_sel_hi:[1,0] neg_lo:[0,1] neg_hi:[0,1]
v_pk_mul_f32 v[72:73], v[72:73], v[208:209] op_sel:[0,1] op_sel_hi:[1,1]
v_pk_mul_f32 v[74:75], v[74:75], v[208:209] op_sel:[0,1] op_sel_hi:[1,1]
s_waitcnt lgkmcnt(1)
v_pk_add_f32 v[76:77], v[76:77], v[212:213] op_sel_hi:[1,0] neg_lo:[0,1] neg_hi:[0,1]
v_pk_add_f32 v[78:79], v[78:79], v[212:213] op_sel_hi:[1,0] neg_lo:[0,1] neg_hi:[0,1]
v_pk_mul_f32 v[76:77], v[76:77], v[212:213] op_sel:[0,1] op_sel_hi:[1,1]
v_pk_mul_f32 v[78:79], v[78:79], v[212:213] op_sel:[0,1] op_sel_hi:[1,1]
s_waitcnt lgkmcnt(0)
v_pk_add_f32 v[80:81], v[80:81], v[216:217] op_sel_hi:[1,0] neg_lo:[0,1] neg_hi:[0,1]
v_pk_add_f32 v[82:83], v[82:83], v[216:217] op_sel_hi:[1,0] neg_lo:[0,1] neg_hi:[0,1]
v_pk_mul_f32 v[80:81], v[80:81], v[216:217] op_sel:[0,1] op_sel_hi:[1,1]
v_pk_mul_f32 v[82:83], v[82:83], v[216:217] op_sel:[0,1] op_sel_hi:[1,1]
s_add_u32 s26, s75, 8
v_mov_b32 v63, s26
s_waitcnt vmcnt(0) lgkmcnt(0)
s_barrier
s_cmp_lg_u32 s23, 0
s_cbranch_scc1 slow_136
buffer_store_dword v63, v17, s[16:19], s27 offen
back_137:
s_add_u32 s72, s29, 163840
s_add_u32 s73, s38, 81920
s_add_u32 s73, s73, s24
s_add_u32 s90, s16, s73
s_addc_u32 s91, s17, 0
s_mov_b32 m0, s38
s_mov_b32 s36, 0
s_add_u32 s26, s75, 8
poll_138:
global_load_dword v63, v16, s[16:17] sc1
buffer_load_dwordx4 v[184:187], v25, s[16:19], s72 offen sc1
buffer_load_dwordx4 v[188:191], v221, s[16:19], s72 offen sc1
s_add_u32 s36, s36, 1
s_cmp_gt_u32 s36, 0x200000
s_cbranch_scc1 k2_bail
s_waitcnt vmcnt(2)
v_subrev_u32 v63, s26, v63
v_cmp_lt_u32 vcc, 15, v63
s_cbranch_vccnz poll_138
s_mov_b64 exec, s[40:41]
global_load_lds_dwordx4 v2, s[90:91] offset:0 sc1
global_load_lds_dwordx4 v2, s[90:91] offset:1024 sc1
global_load_lds_dwordx4 v2, s[90:91] offset:2048 sc1
global_load_lds_dwordx4 v2, s[90:91] offset:3072 sc1
s_mov_b64 exec, -1
s_waitcnt vmcnt(4)
v_xor_b32 v192, v185, v187
v_xor_b32 v193, s65, v185
s_add_u32 s90, s90, 16384
s_addc_u32 s91, s91, 0
s_add_u32 m0, m0, 16384
s_mov_b64 exec, s[42:43]
global_load_lds_dwordx4 v2, s[90:91] offset:0 sc1
s_mov_b64 exec, -1
v_or_b32 v192, v192, v193
v_xor_b32 v193, v189, v191
v_xor_b32 v194, s65, v189
s_mov_b64 exec, s[42:43]
global_load_lds_dwordx4 v2, s[90:91] offset:1024 sc1
s_mov_b64 exec, -1
v_or_b32 v193, v193, v194
v_cmp_ne_u32 vcc, 0, v192
v_cmp_ne_u32 s[98:99], 0, v193
s_mov_b64 exec, s[42:43]
global_load_lds_dwordx4 v2, s[90:91] offset:2048 sc1
s_mov_b64 exec, -1
s_and_b64 vcc, vcc, s[56:57]
s_and_b64 s[98:99], s[98:99], s[58:59]
s_or_b64 vcc, vcc, s[98:99]
s_mov_b64 exec, s[42:43]
global_load_lds_dwordx4 v2, s[90:91] offset:3072 sc1
s_mov_b64 exec, -1
s_cbranch_vccnz hretry_139
hgot_140:
v_mov_b32 v185, v186
v_mov_b32 v189, v190
ds_write_b64 v26, v[184:185]
ds_write_b64 v222, v[188:189]
s_waitcnt vmcnt(4) lgkmcnt(0)
s_barrier
ds_read_b128 v[152:155], v3 offset:0
ds_read_b128 v[156:159], v3 offset:256
ds_read_b128 v[160:163], v3 offset:512
ds_read_b128 v[164:167], v3 offset:768
ds_read_b128 v[168:171], v4 offset:0
ds_read_b128 v[172:175], v4 offset:256
ds_read_b128 v[176:179], v4 offset:512
ds_read_b128 v[180:183], v4 offset:768
s_waitcnt lgkmcnt(4)
v_mfma_f32_16x16x32_bf16 v[104:107], a[100:103], v[152:155], v[64:67]
ds_read_b128 v[144:147], v0 offset:0
v_mfma_f32_16x16x32_bf16 v[108:111], a[100:103], v[156:159], v[68:71]
ds_read_b128 v[184:187], v5 offset:0
s_add_u32 s90, s90, 16384
s_addc_u32 s91, s91, 0
s_add_u32 m0, m0, 16384
s_mov_b64 exec, s[44:45]
global_load_lds_dwordx4 v2, s[90:91] offset:0 sc1
s_mov_b64 exec, -1
v_mfma_f32_16x16x32_bf16 v[112:115], a[100:103], v[160:163], v[72:75]
ds_read_b128 v[188:191], v5 offset:256
v_mfma_f32_16x16x32_bf16 v[116:119], a[100:103], v[164:167], v[76:79]
ds_read_b128 v[192:195], v5 offset:512
s_mov_b64 exec, s[44:45]
global_load_lds_dwordx4 v2, s[90:91] offset:1024 sc1
s_mov_b64 exec, -1
v_mfma_f32_16x16x32_bf16 v[120:123], a[104:107], v[152:155], 0
ds_read_b128 v[196:199], v5 offset:768
v_mfma_f32_16x16x32_bf16 v[124:127], a[104:107], v[156:159], 0
v_mfma_f32_16x16x32_bf16 v[128:131], a[104:107], v[160:163], 0
v_mfma_f32_16x16x32_bf16 v[132:135], a[104:107], v[164:167], 0
s_waitcnt lgkmcnt(5)
v_mfma_f32_16x16x32_bf16 v[104:107], a[108:111], v[168:171], v[104:107]
ds_read_b128 v[136:139], v0 offset:1024
ds_read_b128 v[152:155], v6 offset:0
v_mfma_f32_16x16x32_bf16 v[108:111], a[108:111], v[172:175], v[108:111]
ds_read_b128 v[156:159], v6 offset:256
s_mov_b64 exec, s[44:45]
global_load_lds_dwordx4 v2, s[90:91] offset:2048 sc1
s_mov_b64 exec, -1
v_mfma_f32_16x16x32_bf16 v[112:115], a[108:111], v[176:179], v[112:115]
ds_read_b128 v[160:163], v6 offset:512
v_mfma_f32_16x16x32_bf16 v[116:119], a[108:111], v[180:183], v[116:119]
ds_read_b128 v[164:167], v6 offset:768
s_mov_b64 exec, s[44:45]
global_load_lds_dwordx4 v2, s[90:91] offset:3072 sc1
s_mov_b64 exec, -1
s_waitcnt vmcnt(4)
s_barrier
s_waitcnt lgkmcnt(5)
v_mfma_f32_16x16x32_bf16 v[104:107], v[144:147], v[184:187], v[104:107]
ds_read_b128 v[140:143], v0 offset:2048
ds_read_b128 v[168:171], v3 offset:16384
v_mfma_f32_16x16x32_bf16 v[108:111], v[144:147], v[188:191], v[108:111]
ds_read_b128 v[172:175], v3 offset:16640
s_add_u32 s90, s90, 16384
s_addc_u32 s91, s91, 0
s_add_u32 m0, m0, 16384
s_mov_b64 exec, s[46:47]
global_load_lds_dwordx4 v2, s[90:91] offset:0 sc1
s_mov_b64 exec, -1
v_mfma_f32_16x16x32_bf16 v[112:115], v[144:147], v[192:195], v[112:115]
ds_read_b128 v[176:179], v3 offset:16896
v_mfma_f32_16x16x32_bf16 v[116:119], v[144:147], v[196:199], v[116:119]
ds_read_b128 v[180:183], v3 offset:17152
s_mov_b64 exec, s[46:47]
global_load_lds_dwordx4 v2, s[90:91] offset:1024 sc1
s_mov_b64 exec, -1
s_waitcnt lgkmcnt(5)
v_mfma_f32_16x16x32_bf16 v[104:107], v[136:139], v[152:155], v[104:107]
ds_read_b128 v[144:147], v0 offset:3072
ds_read_b128 v[184:187], v4 offset:16384
v_mfma_f32_16x16x32_bf16 v[108:111], v[136:139], v[156:159], v[108:111]
ds_read_b128 v[188:191], v4 offset:16640
s_mov_b64 exec, s[46:47]
global_load_lds_dwordx4 v2, s[90:91] offset:2048 sc1
s_mov_b64 exec, -1
v_mfma_f32_16x16x32_bf16 v[112:115], v[136:139], v[160:163], v[112:115]
ds_read_b128 v[192:195], v4 offset:16896
v_mfma_f32_16x16x32_bf16 v[116:119], v[136:139], v[164:167], v[116:119]
ds_read_b128 v[196:199], v4 offset:17152
s_mov_b64 exec, s[46:47]
global_load_lds_dwordx4 v2, s[90:91] offset:3072 sc1
s_mov_b64 exec, -1
s_waitcnt lgkmcnt(5)
v_mfma_f32_16x16x32_bf16 v[104:107], v[140:143], v[168:171], v[104:107]
ds_read_b128 v[136:139], v0 offset:4096
v_mfma_f32_16x16x32_bf16 v[108:111], v[140:143], v[172:175], v[108:111]
ds_read_b128 v[152:155], v5 offset:16384
s_add_u32 s90, s90, 16384
s_addc_u32 s91, s91, 0
s_add_u32 m0, m0, 16384
s_mov_b64 exec, s[48:49]
global_load_lds_dwordx4 v2, s[90:91] offset:0 sc1
s_mov_b64 exec, -1
v_mfma_f32_16x16x32_bf16 v[112:115], v[140:143], v[176:179], v[112:115]
ds_read_b128 v[156:159], v5 offset:16640
v_mfma_f32_16x16x32_bf16 v[116:119], v[140:143], v[180:183], v[116:119]
ds_read_b128 v[160:163], v5 offset:16896
s_mov_b64 exec, s[48:49]
global_load_lds_dwordx4 v2, s[90:91] offset:1024 sc1
s_mov_b64 exec, -1
v_mfma_f32_16x16x32_bf16 v[120:123], a[112:115], v[168:171], v[120:123]
ds_read_b128 v[164:167], v5 offset:17152
v_mfma_f32_16x16x32_bf16 v[124:127], a[112:115], v[172:175], v[124:127]
v_mfma_f32_16x16x32_bf16 v[128:131], a[112:115], v[176:179], v[128:131]
v_mfma_f32_16x16x32_bf16 v[132:135], a[112:115], v[180:183], v[132:135]
s_waitcnt lgkmcnt(5)
v_mfma_f32_16x16x32_bf16 v[104:107], v[144:147], v[184:187], v[104:107]
ds_read_b128 v[140:143], v0 offset:5120
ds_read_b128 v[168:171], v6 offset:16384
v_mfma_f32_16x16x32_bf16 v[108:111], v[144:147], v[188:191], v[108:111]
ds_read_b128 v[172:175], v6 offset:16640
s_mov_b64 exec, s[48:49]
global_load_lds_dwordx4 v2, s[90:91] offset:2048 sc1
s_mov_b64 exec, -1
v_mfma_f32_16x16x32_bf16 v[112:115], v[144:147], v[192:195], v[112:115]
ds_read_b128 v[176:179], v6 offset:16896
v_mfma_f32_16x16x32_bf16 v[116:119], v[144:147], v[196:199], v[116:119]
ds_read_b128 v[180:183], v6 offset:17152
s_mov_b64 exec, s[48:49]
global_load_lds_dwordx4 v2, s[90:91] offset:3072 sc1
s_mov_b64 exec, -1
s_waitcnt vmcnt(8)
s_barrier
s_waitcnt lgkmcnt(5)
v_mfma_f32_16x16x32_bf16 v[104:107], v[136:139], v[152:155], v[104:107]
ds_read_b128 v[144:147], v0 offset:6144
ds_read_b128 v[184:187], v3 offset:32768
v_mfma_f32_16x16x32_bf16 v[108:111], v[136:139], v[156:159], v[108:111]
ds_read_b128 v[188:191], v3 offset:33024
v_mfma_f32_16x16x32_bf16 v[112:115], v[136:139], v[160:163], v[112:115]
ds_read_b128 v[192:195], v3 offset:33280
v_mfma_f32_16x16x32_bf16 v[116:119], v[136:139], v[164:167], v[116:119]
ds_read_b128 v[196:199], v3 offset:33536
s_waitcnt lgkmcnt(5)
v_mfma_f32_16x16x32_bf16 v[104:107], v[140:143], v[168:171], v[104:107]
ds_read_b128 v[136:139], v0 offset:7168
ds_read_b128 v[152:155], v4 offset:32768
v_mfma_f32_16x16x32_bf16 v[108:111], v[140:143], v[172:175], v[108:111]
ds_read_b128 v[156:159], v4 offset:33024
v_mfma_f32_16x16x32_bf16 v[112:115], v[140:143], v[176:179], v[112:115]
ds_read_b128 v[160:163], v4 offset:33280
v_mfma_f32_16x16x32_bf16 v[116:119], v[140:143], v[180:183], v[116:119]
ds_read_b128 v[164:167], v4 offset:33536
s_waitcnt lgkmcnt(5)
v_mfma_f32_16x16x32_bf16 v[104:107], v[144:147], v[184:187], v[104:107]
ds_read_b128 v[140:143], v0 offset:8192
global_load_dwordx4 a[244:247], v2, s[92:93] offset:3072
v_mfma_f32_16x16x32_bf16 v[108:111], v[144:147], v[188:191], v[108:111]
ds_read_b128 v[168:171], v5 offset:32768
v_mfma_f32_16x16x32_bf16 v[112:115], v[144:147], v[192:195], v[112:115]
ds_read_b128 v[172:175], v5 offset:33024
v_mfma_f32_16x16x32_bf16 v[116:119], v[144:147], v[196:199], v[116:119]
ds_read_b128 v[176:179], v5 offset:33280
v_mfma_f32_16x16x32_bf16 v[120:123], a[116:119], v[184:187], v[120:123]
ds_read_b128 v[180:183], v5 offset:33536
v_mfma_f32_16x16x32_bf16 v[124:127], a[116:119], v[188:191], v[124:127]
v_mfma_f32_16x16x32_bf16 v[128:131], a[116:119], v[192:195], v[128:131]
v_mfma_f32_16x16x32_bf16 v[132:135], a[116:119], v[196:199], v[132:135]
s_waitcnt lgkmcnt(5)
v_mfma_f32_16x16x32_bf16 v[104:107], v[136:139], v[152:155], v[104:107]
ds_read_b128 v[144:147], v0 offset:9216
ds_read_b128 v[184:187], v6 offset:32768
s_add_u32 s92, s92, 4096
s_addc_u32 s93, s93, 0
global_load_dwordx4 a[248:251], v2, s[92:93] offset:0
v_mfma_f32_16x16x32_bf16 v[108:111], v[136:139], v[156:159], v[108:111]
ds_read_b128 v[188:191], v6 offset:33024
v_mfma_f32_16x16x32_bf16 v[112:115], v[136:139], v[160:163], v[112:115]
ds_read_b128 v[192:195], v6 offset:33280
v_mfma_f32_16x16x32_bf16 v[116:119], v[136:139], v[164:167], v[116:119]
ds_read_b128 v[196:199], v6 offset:33536
s_waitcnt vmcnt(6)
s_barrier
s_waitcnt lgkmcnt(5)
v_mfma_f32_16x16x32_bf16 v[104:107], v[140:143], v[168:171], v[104:107]
ds_read_b128 v[136:139], v0 offset:10240
ds_read_b128 v[152:155], v3 offset:49152
global_load_dwordx4 a[252:255], v2, s[92:93] offset:1024
v_mfma_f32_16x16x32_bf16 v[108:111], v[140:143], v[172:175], v[108:111]
ds_read_b128 v[156:159], v3 offset:49408
v_mfma_f32_16x16x32_bf16 v[112:115], v[140:143], v[176:179], v[112:115]
ds_read_b128 v[160:163], v3 offset:49664
v_mfma_f32_16x16x32_bf16 v[116:119], v[140:143], v[180:183], v[116:119]
ds_read_b128 v[164:167], v3 offset:49920
s_waitcnt lgkmcnt(5)
v_mfma_f32_16x16x32_bf16 v[104:107], v[144:147], v[184:187], v[104:107]
ds_read_b128 v[140:143], v0 offset:11264
ds_read_b128 v[168:171], v4 offset:49152
global_load_dwordx4 v[224:227], v2, s[92:93] offset:2048
v_mfma_f32_16x16x32_bf16 v[108:111], v[144:147], v[188:191], v[108:111]
ds_read_b128 v[172:175], v4 offset:49408
global_load_dwordx4 v[228:231], v2, s[92:93] offset:3072
v_mfma_f32_16x16x32_bf16 v[112:115], v[144:147], v[192:195], v[112:115]
ds_read_b128 v[176:179], v4 offset:49664
v_mfma_f32_16x16x32_bf16 v[116:119], v[144:147], v[196:199], v[116:119]
ds_read_b128 v[180:183], v4 offset:49920
s_waitcnt lgkmcnt(5)
v_mfma_f32_16x16x32_bf16 v[104:107], v[136:139], v[152:155], v[104:107]
ds_read_b128 v[144:147], v0 offset:12288
s_add_u32 s92, s92, 4096
s_addc_u32 s93, s93, 0
global_load_dwordx4 v[232:235], v2, s[92:93] offset:0
v_mfma_f32_16x16x32_bf16 v[108:111], v[136:139], v[156:159], v[108:111]
ds_read_b128 v[184:187], v5 offset:49152
v_mfma_f32_16x16x32_bf16 v[112:115], v[136:139], v[160:163], v[112:115]
ds_read_b128 v[188:191], v5 offset:49408
v_mfma_f32_16x16x32_bf16 v[116:119], v[136:139], v[164:167], v[116:119]
ds_read_b128 v[192:195], v5 offset:49664
v_mfma_f32_16x16x32_bf16 v[120:123], a[120:123], v[152:155], v[120:123]
ds_read_b128 v[196:199], v5 offset:49920
v_mfma_f32_16x16x32_bf16 v[124:127], a[120:123], v[156:159], v[124:127]
v_mfma_f32_16x16x32_bf16 v[128:131], a[120:123], v[160:163], v[128:131]
v_mfma_f32_16x16x32_bf16 v[132:135], a[120:123], v[164:167], v[132:135]
s_waitcnt lgkmcnt(5)
v_mfma_f32_16x16x32_bf16 v[104:107], v[140:143], v[168:171], v[104:107]
ds_read_b128 v[136:139], v0 offset:13312
ds_read_b128 v[152:155], v6 offset:49152
global_load_dwordx4 v[236:239], v2, s[92:93] offset:1024
v_mfma_f32_16x16x32_bf16 v[108:111], v[140:143], v[172:175], v[108:111]
ds_read_b128 v[156:159], v6 offset:49408
v_mfma_f32_16x16x32_bf16 v[112:115], v[140:143], v[176:179], v[112:115]
ds_read_b128 v[160:163], v6 offset:49664
v_mfma_f32_16x16x32_bf16 v[116:119], v[140:143], v[180:183], v[116:119]
ds_read_b128 v[164:167], v6 offset:49920
s_waitcnt vmcnt(7)
s_barrier
s_waitcnt lgkmcnt(5)
v_mfma_f32_16x16x32_bf16 v[104:107], v[144:147], v[184:187], v[104:107]
ds_read_b128 v[140:143], v0 offset:14336
ds_read_b128 v[168:171], v7 offset:0
s_sub_u32 s92, s92, 24576
s_subb_u32 s93, s93, 0
global_load_dwordx4 v[240:243], v2, s[92:93] offset:2048
v_mfma_f32_16x16x32_bf16 v[108:111], v[144:147], v[188:191], v[108:111]
ds_read_b128 v[172:175], v7 offset:256
v_mfma_f32_16x16x32_bf16 v[112:115], v[144:147], v[192:195], v[112:115]
ds_read_b128 v[176:179], v7 offset:512
v_mfma_f32_16x16x32_bf16 v[116:119], v[144:147], v[196:199], v[116:119]
ds_read_b128 v[180:183], v7 offset:768
s_waitcnt lgkmcnt(5)
v_mfma_f32_16x16x32_bf16 v[104:107], v[136:139], v[152:155], v[104:107]
ds_read_b128 v[144:147], v0 offset:15360
ds_read_b128 v[184:187], v8 offset:0
global_load_dwordx4 v[244:247], v2, s[92:93] offset:3072
v_mfma_f32_16x16x32_bf16 v[108:111], v[136:139], v[156:159], v[108:111]
ds_read_b128 v[188:191], v8 offset:256
s_add_u32 s92, s92, 4096
s_addc_u32 s93, s93, 0
global_load_dwordx4 v[248:251], v2, s[92:93] offset:0
v_mfma_f32_16x16x32_bf16 v[112:115], v[136:139], v[160:163], v[112:115]
ds_read_b128 v[192:195], v8 offset:512
v_mfma_f32_16x16x32_bf16 v[116:119], v[136:139], v[164:167], v[116:119]
ds_read_b128 v[196:199], v8 offset:768
s_waitcnt lgkmcnt(5)
v_mfma_f32_16x16x32_bf16 v[104:107], v[140:143], v[168:171], v[104:107]
ds_read_b128 v[136:139], v0 offset:16384
global_load_dwordx4 v[252:255], v2, s[92:93] offset:1024
v_mfma_f32_16x16x32_bf16 v[108:111], v[140:143], v[172:175], v[108:111]
ds_read_b128 v[152:155], v9 offset:0
v_mfma_f32_16x16x32_bf16 v[112:115], v[140:143], v[176:179], v[112:115]
ds_read_b128 v[156:159], v9 offset:256
v_mfma_f32_16x16x32_bf16 v[116:119], v[140:143], v[180:183], v[116:119]
ds_read_b128 v[160:163], v9 offset:512
v_mfma_f32_16x16x32_bf16 v[120:123], a[124:127], v[168:171], v[120:123]
ds_read_b128 v[164:167], v9 offset:768
v_mfma_f32_16x16x32_bf16 v[124:127], a[124:127], v[172:175], v[124:127]
v_mfma_f32_16x16x32_bf16 v[128:131], a[124:127], v[176:179], v[128:131]
v_mfma_f32_16x16x32_bf16 v[132:135], a[124:127], v[180:183], v[132:135]
s_waitcnt lgkmcnt(5)
v_mfma_f32_16x16x32_bf16 v[104:107], v[144:147], v[184:187], v[104:107]
ds_read_b128 v[140:143], v0 offset:17408
ds_read_b128 v[168:171], v10 offset:0
v_mfma_f32_16x16x32_bf16 v[108:111], v[144:147], v[188:191], v[108:111]
ds_read_b128 v[172:175], v10 offset:256
v_mfma_f32_16x16x32_bf16 v[112:115], v[144:147], v[192:195], v[112:115]
ds_read_b128 v[176:179], v10 offset:512
v_mfma_f32_16x16x32_bf16 v[116:119], v[144:147], v[196:199], v[116:119]
ds_read_b128 v[180:183], v10 offset:768
s_waitcnt lgkmcnt(5)
v_mfma_f32_16x16x32_bf16 v[104:107], v[136:139], v[152:155], v[104:107]
ds_write_b128 v23, v[120:123] offset:0
ds_write_b128 v23, v[124:127] offset:1024
v_mfma_f32_16x16x32_bf16 v[108:111], v[136:139], v[156:159], v[108:111]
ds_write_b128 v23, v[128:131] offset:2048
ds_write_b128 v23, v[132:135] offset:3072
v_mfma_f32_16x16x32_bf16 v[112:115], v[136:139], v[160:163], v[112:115]
v_mfma_f32_16x16x32_bf16 v[116:119], v[136:139], v[164:167], v[116:119]
s_waitcnt lgkmcnt(4)
v_mfma_f32_16x16x32_bf16 v[104:107], v[140:143], v[168:171], v[104:107]
v_mfma_f32_16x16x32_bf16 v[108:111], v[140:143], v[172:175], v[108:111]
v_mfma_f32_16x16x32_bf16 v[112:115], v[140:143], v[176:179], v[112:115]
v_mfma_f32_16x16x32_bf16 v[116:119], v[140:143], v[180:183], v[116:119]
s_waitcnt lgkmcnt(0)
s_barrier
ds_read_b128 v[152:155], v24 offset:0
ds_read_b128 v[156:159], v24 offset:4096
ds_read_b128 v[160:163], v24 offset:8192
ds_read_b128 v[164:167], v24 offset:12288
v_cvt_pk_bf16_f32 v52, v104, v105
v_cvt_pk_bf16_f32 v53, v106, v107
s_cmp_lg_u32 s23, 0
s_cbranch_scc1 slow_141
global_store_dwordx2 v11, v[52:53], s[16:17] offset:0
back_142:
v_cvt_pk_bf16_f32 v54, v108, v109
v_cvt_pk_bf16_f32 v55, v110, v111
s_cbranch_scc1 slow_143
global_store_dwordx2 v11, v[54:55], s[16:17] offset:256
back_144:
v_cvt_pk_bf16_f32 v56, v112, v113
v_cvt_pk_bf16_f32 v57, v114, v115
s_cbranch_scc1 slow_145
global_store_dwordx2 v11, v[56:57], s[16:17] offset:512
back_146:
v_cvt_pk_bf16_f32 v58, v116, v117
v_cvt_pk_bf16_f32 v59, v118, v119
s_cbranch_scc1 slow_147
global_store_dwordx2 v11, v[58:59], s[16:17] offset:768
back_148:
s_waitcnt lgkmcnt(0)
v_pk_add_f32 v[152:153], v[152:153], v[156:157]
v_pk_add_f32 v[160:161], v[160:161], v[164:165]
v_pk_add_f32 v[154:155], v[154:155], v[158:159]
v_pk_add_f32 v[162:163], v[162:163], v[166:167]
v_pk_add_f32 v[152:153], v[152:153], v[80:81]
v_pk_add_f32 v[154:155], v[154:155], v[82:83]
v_pk_add_f32 v[120:121], v[152:153], v[160:161]
v_pk_add_f32 v[122:123], v[154:155], v[162:163]
v_cvt_pk_bf16_f32 v60, v120, v121
v_cvt_pk_bf16_f32 v61, v122, v123
s_cbranch_scc1 slow_149
global_store_dwordx2 v12, v[60:61], s[16:17] offset:0
back_150:
v_pk_add_f32 v[152:153], v[104:105], v[106:107]
v_pk_mul_f32 v[154:155], v[104:105], v[104:105]
v_pk_add_f32 v[156:157], v[108:109], v[110:111]
v_pk_mul_f32 v[158:159], v[108:109], v[108:109]
v_pk_add_f32 v[160:161], v[112:113], v[114:115]
v_pk_mul_f32 v[162:163], v[112:113], v[112:113]
v_pk_add_f32 v[164:165], v[116:117], v[118:119]
v_pk_mul_f32 v[166:167], v[116:117], v[116:117]
v_pk_add_f32 v[168:169], v[120:121], v[122:123]
v_pk_mul_f32 v[170:171], v[120:121], v[120:121]
v_pk_fma_f32 v[154:155], v[106:107], v[106:107], v[154:155]
v_add_f32 v152, v152, v153
v_pk_fma_f32 v[158:159], v[110:111], v[110:111], v[158:159]
v_add_f32 v156, v156, v157
v_pk_fma_f32 v[162:163], v[114:115], v[114:115], v[162:163]
v_add_f32 v160, v160, v161
v_pk_fma_f32 v[166:167], v[118:119], v[118:119], v[166:167]
v_add_f32 v164, v164, v165
v_pk_fma_f32 v[170:171], v[122:123], v[122:123], v[170:171]
v_add_f32 v168, v168, v169
v_add_f32 v153, v154, v155
v_add_f32 v157, v158, v159
v_add_f32 v161, v162, v163
v_add_f32 v165, v166, v167
v_add_f32 v169, v170, v171
v_fmac_f32 v152, s60, v168
v_fmac_f32 v153, s60, v169
v_fmac_f32 v156, s61, v168
v_fmac_f32 v157, s61, v169
v_fmac_f32 v160, s62, v168
v_fmac_f32 v161, s62, v169
v_fmac_f32 v164, s63, v168
v_fmac_f32 v165, s63, v169
v_permlane32_swap_b32 v152, v160
v_permlane32_swap_b32 v156, v164
v_permlane32_swap_b32 v153, v161
v_permlane32_swap_b32 v157, v165
v_pk_add_f32 v[152:153], v[152:153], v[160:161]
v_pk_add_f32 v[156:157], v[156:157], v[164:165]
s_nop 1
v_permlane16_swap_b32 v152, v156
v_permlane16_swap_b32 v153, v157
v_pk_add_f32 v[152:153], v[152:153], v[156:157]
ds_write_b64 v20, v[152:153]
s_waitcnt lgkmcnt(0)
s_barrier
ds_read_b64 v[184:185], v19 offset:0
ds_read_b64 v[186:187], v19 offset:512
ds_read_b64 v[188:189], v19 offset:1024
ds_read_b64 v[190:191], v19 offset:1536
s_add_u32 s74, s28, 262144
s_add_u32 s65, s75, 21
v_mov_b32 v193, s65
v_mov_b32 v195, s65
s_waitcnt lgkmcnt(0)
v_pk_add_f32 v[184:185], v[184:185], v[186:187]
v_pk_add_f32 v[188:189], v[188:189], v[190:191]
v_add_f32 v192, v184, v188
v_add_f32 v194, v185, v189
s_cmp_lg_u32 s23, 0
s_cbranch_scc1 slow_151
buffer_store_dwordx4 v[192:195], v220, s[16:19], s74 offen
back_152:
s_add_u32 s26, s75, 9
v_mov_b32 v63, s26
s_waitcnt vmcnt(1) lgkmcnt(0)
s_barrier
s_cmp_lg_u32 s23, 0
s_cbranch_scc1 slow_153
buffer_store_dword v63, v17, s[16:19], s27 offen
back_154:
s_add_u32 s73, s38, 65536
s_add_u32 s73, s73, s24
s_add_u32 s90, s16, s73
s_addc_u32 s91, s17, 0
s_mov_b32 m0, s38
s_mov_b32 s36, 0
s_add_u32 s26, s75, 9
poll_155:
global_load_dword v63, v16, s[16:17] sc1
global_load_dwordx4 v[184:187], v18, s[8:9] offset:0 sc1
global_load_dwordx4 v[188:191], v18, s[8:9] offset:1024 sc1
s_add_u32 s36, s36, 1
s_cmp_gt_u32 s36, 0x200000
s_cbranch_scc1 k2_bail
s_waitcnt vmcnt(2)
v_subrev_u32 v63, s26, v63
v_cmp_lt_u32 vcc, 15, v63
s_cbranch_vccnz poll_155
global_load_lds_dwordx4 v2, s[90:91] offset:0 sc1
global_load_lds_dwordx4 v2, s[90:91] offset:1024 sc1
global_load_lds_dwordx4 v2, s[90:91] offset:2048 sc1
global_load_lds_dwordx4 v2, s[90:91] offset:3072 sc1
s_waitcnt vmcnt(4)
v_xor_b32 v192, v185, v187
v_xor_b32 v193, v189, v191
v_xor_b32 v194, s65, v185
v_xor_b32 v195, s65, v189
v_or3_b32 v192, v192, v193, v194
s_sub_u32 s90, s90, 16384
s_subb_u32 s91, s91, 0
s_add_u32 m0, m0, 16384
s_nop 0
global_load_lds_dwordx4 v2, s[90:91] offset:0 sc1
v_or_b32 v192, v192, v195
v_cmp_ne_u32 vcc, 0, v192
s_cbranch_vccnz retry_156
got_157:
v_add_f32 v184, v184, v188
v_add_f32 v185, v186, v190
v_mov_b32 v186, v184
global_load_lds_dwordx4 v2, s[90:91] offset:1024 sc1
v_mov_b32 v187, v185
v_permlane32_swap_b32 v184, v186
s_nop 0
v_permlane32_swap_b32 v185, v187
v_pk_add_f32 v[184:185], v[184:185], v[186:187]
v_mov_b32 v186, v184
v_mov_b32 v187, v185
global_load_lds_dwordx4 v2, s[90:91] offset:2048 sc1
v_permlane16_swap_b32 v184, v186
v_permlane16_swap_b32 v185, v187
v_pk_add_f32 v[184:185], v[184:185], v[186:187]
v_mul_f32 v184, 0x3acccccd, v184
v_mul_f32 v185, 0x3acccccd, v185
v_fma_f32 v188, -v184, v184, v185
global_load_lds_dwordx4 v2, s[90:91] offset:3072 sc1
v_max_f32 v188, 0, v188
v_add_f32 v189, 0x3727c5ac, v188
v_rsq_f32 v188, v189
s_nop 0
v_mul_f32 v185, v189, v188
v_mul_f32 v186, 0xc0135761, v188
v_mul_f32 v187, 0xbdd2d3e8, v188
v_mul_f32 v188, v188, v188
v_mul_f32 v187, v187, v188
ds_write_b128 v21, v[184:187]
s_waitcnt vmcnt(4) lgkmcnt(0)
s_barrier
ds_read_b128 v[152:155], v3 offset:0
ds_read_b128 v[156:159], v3 offset:256
ds_read_b128 v[160:163], v3 offset:512
ds_read_b128 v[164:167], v3 offset:768
ds_read_b128 v[168:171], v4 offset:0
ds_read_b128 v[172:175], v4 offset:256
ds_read_b128 v[176:179], v4 offset:512
ds_read_b128 v[180:183], v4 offset:768
s_waitcnt lgkmcnt(4)
v_mfma_f32_16x16x32_bf16 v[104:107], a[128:131], v[152:155], 0
ds_read_b128 v[184:187], v5 offset:0
v_mfma_f32_16x16x32_bf16 v[108:111], a[128:131], v[156:159], 0
ds_read_b128 v[188:191], v5 offset:256
s_sub_u32 s90, s90, 16384
s_subb_u32 s91, s91, 0
s_add_u32 m0, m0, 16384
s_nop 0
global_load_lds_dwordx4 v2, s[90:91] offset:0 sc1
v_mfma_f32_16x16x32_bf16 v[112:115], a[128:131], v[160:163], 0
ds_read_b128 v[192:195], v5 offset:512
v_mfma_f32_16x16x32_bf16 v[116:119], a[128:131], v[164:167], 0
ds_read_b128 v[196:199], v5 offset:768
global_load_lds_dwordx4 v2, s[90:91] offset:1024 sc1
v_mfma_f32_16x16x32_bf16 v[120:123], a[132:135], v[152:155], 0
v_mfma_f32_16x16x32_bf16 v[124:127], a[132:135], v[156:159], 0
v_mfma_f32_16x16x32_bf16 v[128:131], a[132:135], v[160:163], 0
v_mfma_f32_16x16x32_bf16 v[132:135], a[132:135], v[164:167], 0
v_mfma_f32_16x16x32_bf16 v[136:139], a[136:139], v[152:155], 0
v_mfma_f32_16x16x32_bf16 v[140:143], a[136:139], v[156:159], 0
v_mfma_f32_16x16x32_bf16 v[144:147], a[136:139], v[160:163], 0
v_mfma_f32_16x16x32_bf16 v[148:151], a[136:139], v[164:167], 0
s_waitcnt lgkmcnt(4)
v_mfma_f32_16x16x32_bf16 v[104:107], a[140:143], v[168:171], v[104:107]
ds_read_b128 v[152:155], v6 offset:0
v_mfma_f32_16x16x32_bf16 v[108:111], a[140:143], v[172:175], v[108:111]
ds_read_b128 v[156:159], v6 offset:256
global_load_lds_dwordx4 v2, s[90:91] offset:2048 sc1
v_mfma_f32_16x16x32_bf16 v[112:115], a[140:143], v[176:179], v[112:115]
ds_read_b128 v[160:163], v6 offset:512
v_mfma_f32_16x16x32_bf16 v[116:119], a[140:143], v[180:183], v[116:119]
ds_read_b128 v[164:167], v6 offset:768
global_load_lds_dwordx4 v2, s[90:91] offset:3072 sc1
v_mfma_f32_16x16x32_bf16 v[120:123], a[144:147], v[168:171], v[120:123]
v_mfma_f32_16x16x32_bf16 v[124:127], a[144:147], v[172:175], v[124:127]
v_mfma_f32_16x16x32_bf16 v[128:131], a[144:147], v[176:179], v[128:131]
v_mfma_f32_16x16x32_bf16 v[132:135], a[144:147], v[180:183], v[132:135]
v_mfma_f32_16x16x32_bf16 v[136:139], a[148:151], v[168:171], v[136:139]
v_mfma_f32_16x16x32_bf16 v[140:143], a[148:151], v[172:175], v[140:143]
v_mfma_f32_16x16x32_bf16 v[144:147], a[148:151], v[176:179], v[144:147]
v_mfma_f32_16x16x32_bf16 v[148:151], a[148:151], v[180:183], v[148:151]
s_waitcnt vmcnt(4)
s_barrier
s_waitcnt lgkmcnt(4)
v_mfma_f32_16x16x32_bf16 v[104:107], a[152:155], v[184:187], v[104:107]
ds_read_b128 v[168:171], v3 offset:16384
v_mfma_f32_16x16x32_bf16 v[108:111], a[152:155], v[188:191], v[108:111]
ds_read_b128 v[172:175], v3 offset:16640
s_sub_u32 s90, s90, 16384
s_subb_u32 s91, s91, 0
s_add_u32 m0, m0, 16384
s_nop 0
global_load_lds_dwordx4 v2, s[90:91] offset:0 sc1
v_mfma_f32_16x16x32_bf16 v[112:115], a[152:155], v[192:195], v[112:115]
ds_read_b128 v[176:179], v3 offset:16896
v_mfma_f32_16x16x32_bf16 v[116:119], a[152:155], v[196:199], v[116:119]
ds_read_b128 v[180:183], v3 offset:17152
global_load_lds_dwordx4 v2, s[90:91] offset:1024 sc1
v_mfma_f32_16x16x32_bf16 v[120:123], a[156:159], v[184:187], v[120:123]
v_mfma_f32_16x16x32_bf16 v[124:127], a[156:159], v[188:191], v[124:127]
v_mfma_f32_16x16x32_bf16 v[128:131], a[156:159], v[192:195], v[128:131]
v_mfma_f32_16x16x32_bf16 v[132:135], a[156:159], v[196:199], v[132:135]
v_mfma_f32_16x16x32_bf16 v[136:139], a[160:163], v[184:187], v[136:139]
v_mfma_f32_16x16x32_bf16 v[140:143], a[160:163], v[188:191], v[140:143]
v_mfma_f32_16x16x32_bf16 v[144:147], a[160:163], v[192:195], v[144:147]
v_mfma_f32_16x16x32_bf16 v[148:151], a[160:163], v[196:199], v[148:151]
s_waitcnt lgkmcnt(4)
v_mfma_f32_16x16x32_bf16 v[104:107], a[164:167], v[152:155], v[104:107]
ds_read_b128 v[184:187], v4 offset:16384
v_mfma_f32_16x16x32_bf16 v[108:111], a[164:167], v[156:159], v[108:111]
ds_read_b128 v[188:191], v4 offset:16640
global_load_lds_dwordx4 v2, s[90:91] offset:2048 sc1
v_mfma_f32_16x16x32_bf16 v[112:115], a[164:167], v[160:163], v[112:115]
ds_read_b128 v[192:195], v4 offset:16896
v_mfma_f32_16x16x32_bf16 v[116:119], a[164:167], v[164:167], v[116:119]
ds_read_b128 v[196:199], v4 offset:17152
global_load_lds_dwordx4 v2, s[90:91] offset:3072 sc1
v_mfma_f32_16x16x32_bf16 v[120:123], a[168:171], v[152:155], v[120:123]
v_mfma_f32_16x16x32_bf16 v[124:127], a[168:171], v[156:159], v[124:127]
v_mfma_f32_16x16x32_bf16 v[128:131], a[168:171], v[160:163], v[128:131]
v_mfma_f32_16x16x32_bf16 v[132:135], a[168:171], v[164:167], v[132:135]
v_mfma_f32_16x16x32_bf16 v[136:139], a[172:175], v[152:155], v[136:139]
v_mfma_f32_16x16x32_bf16 v[140:143], a[172:175], v[156:159], v[140:143]
v_mfma_f32_16x16x32_bf16 v[144:147], a[172:175], v[160:163], v[144:147]
v_mfma_f32_16x16x32_bf16 v[148:151], a[172:175], v[164:167], v[148:151]
s_waitcnt lgkmcnt(4)
v_mfma_f32_16x16x32_bf16 v[104:107], a[176:179], v[168:171], v[104:107]
ds_read_b128 v[152:155], v5 offset:16384
v_mfma_f32_16x16x32_bf16 v[108:111], a[176:179], v[172:175], v[108:111]
ds_read_b128 v[156:159], v5 offset:16640
s_sub_u32 s90, s90, 16384
s_subb_u32 s91, s91, 0
s_add_u32 m0, m0, 16384
s_nop 0
global_load_lds_dwordx4 v2, s[90:91] offset:0 sc1
v_mfma_f32_16x16x32_bf16 v[112:115], a[176:179], v[176:179], v[112:115]
ds_read_b128 v[160:163], v5 offset:16896
v_mfma_f32_16x16x32_bf16 v[116:119], a[176:179], v[180:183], v[116:119]
ds_read_b128 v[164:167], v5 offset:17152
global_load_lds_dwordx4 v2, s[90:91] offset:1024 sc1
v_mfma_f32_16x16x32_bf16 v[120:123], a[180:183], v[168:171], v[120:123]
v_mfma_f32_16x16x32_bf16 v[124:127], a[180:183], v[172:175], v[124:127]
v_mfma_f32_16x16x32_bf16 v[128:131], a[180:183], v[176:179], v[128:131]
v_mfma_f32_16x16x32_bf16 v[132:135], a[180:183], v[180:183], v[132:135]
v_mfma_f32_16x16x32_bf16 v[136:139], a[184:187], v[168:171], v[136:139]
v_mfma_f32_16x16x32_bf16 v[140:143], a[184:187], v[172:175], v[140:143]
v_mfma_f32_16x16x32_bf16 v[144:147], a[184:187], v[176:179], v[144:147]
v_mfma_f32_16x16x32_bf16 v[148:151], a[184:187], v[180:183], v[148:151]
s_waitcnt lgkmcnt(4)
v_mfma_f32_16x16x32_bf16 v[104:107], a[188:191], v[184:187], v[104:107]
ds_read_b128 v[168:171], v6 offset:16384
global_load_dwordx4 a[128:131], v2, s[92:93] offset:2048
v_mfma_f32_16x16x32_bf16 v[108:111], a[188:191], v[188:191], v[108:111]
ds_read_b128 v[172:175], v6 offset:16640
global_load_lds_dwordx4 v2, s[90:91] offset:2048 sc1
v_mfma_f32_16x16x32_bf16 v[112:115], a[188:191], v[192:195], v[112:115]
ds_read_b128 v[176:179], v6 offset:16896
global_load_dwordx4 a[132:135], v2, s[92:93] offset:3072
v_mfma_f32_16x16x32_bf16 v[116:119], a[188:191], v[196:199], v[116:119]
ds_read_b128 v[180:183], v6 offset:17152
global_load_lds_dwordx4 v2, s[90:91] offset:3072 sc1
v_mfma_f32_16x16x32_bf16 v[120:123], a[192:195], v[184:187], v[120:123]
v_mfma_f32_16x16x32_bf16 v[124:127], a[192:195], v[188:191], v[124:127]
v_mfma_f32_16x16x32_bf16 v[128:131], a[192:195], v[192:195], v[128:131]
v_mfma_f32_16x16x32_bf16 v[132:135], a[192:195], v[196:199], v[132:135]
v_mfma_f32_16x16x32_bf16 v[136:139], a[196:199], v[184:187], v[136:139]
v_mfma_f32_16x16x32_bf16 v[140:143], a[196:199], v[188:191], v[140:143]
v_mfma_f32_16x16x32_bf16 v[144:147], a[196:199], v[192:195], v[144:147]
v_mfma_f32_16x16x32_bf16 v[148:151], a[196:199], v[196:199], v[148:151]
s_waitcnt vmcnt(10)
s_barrier
s_waitcnt lgkmcnt(4)
v_mfma_f32_16x16x32_bf16 v[104:107], a[200:203], v[152:155], v[104:107]
ds_read_b128 v[184:187], v3 offset:32768
s_add_u32 s92, s92, 4096
s_addc_u32 s93, s93, 0
global_load_dwordx4 a[136:139], v2, s[92:93] offset:0
v_mfma_f32_16x16x32_bf16 v[108:111], a[200:203], v[156:159], v[108:111]
ds_read_b128 v[188:191], v3 offset:33024
global_load_dwordx4 a[140:143], v2, s[92:93] offset:1024
v_mfma_f32_16x16x32_bf16 v[112:115], a[200:203], v[160:163], v[112:115]
ds_read_b128 v[192:195], v3 offset:33280
v_mfma_f32_16x16x32_bf16 v[116:119], a[200:203], v[164:167], v[116:119]
ds_read_b128 v[196:199], v3 offset:33536
v_mfma_f32_16x16x32_bf16 v[120:123], a[204:207], v[152:155], v[120:123]
v_mfma_f32_16x16x32_bf16 v[124:127], a[204:207], v[156:159], v[124:127]
v_mfma_f32_16x16x32_bf16 v[128:131], a[204:207], v[160:163], v[128:131]
v_mfma_f32_16x16x32_bf16 v[132:135], a[204:207], v[164:167], v[132:135]
v_mfma_f32_16x16x32_bf16 v[136:139], a[208:211], v[152:155], v[136:139]
v_mfma_f32_16x16x32_bf16 v[140:143], a[208:211], v[156:159], v[140:143]
v_mfma_f32_16x16x32_bf16 v[144:147], a[208:211], v[160:163], v[144:147]
v_mfma_f32_16x16x32_bf16 v[148:151], a[208:211], v[164:167], v[148:151]
s_waitcnt lgkmcnt(4)
v_mfma_f32_16x16x32_bf16 v[104:107], a[212:215], v[168:171], v[104:107]
ds_read_b128 v[152:155], v4 offset:32768
global_load_dwordx4 a[144:147], v2, s[92:93] offset:2048
v_mfma_f32_16x16x32_bf16 v[108:111], a[212:215], v[172:175], v[108:111]
ds_read_b128 v[156:159], v4 offset:33024
global_load_dwordx4 a[148:151], v2, s[92:93] offset:3072
v_mfma_f32_16x16x32_bf16 v[112:115], a[212:215], v[176:179], v[112:115]
ds_read_b128 v[160:163], v4 offset:33280
v_mfma_f32_16x16x32_bf16 v[116:119], a[212:215], v[180:183], v[116:119]
ds_read_b128 v[164:167], v4 offset:33536
v_mfma_f32_16x16x32_bf16 v[120:123], a[216:219], v[168:171], v[120:123]
v_mfma_f32_16x16x32_bf16 v[124:127], a[216:219], v[172:175], v[124:127]
v_mfma_f32_16x16x32_bf16 v[128:131], a[216:219], v[176:179], v[128:131]
v_mfma_f32_16x16x32_bf16 v[132:135], a[216:219], v[180:183], v[132:135]
v_mfma_f32_16x16x32_bf16 v[136:139], a[220:223], v[168:171], v[136:139]
v_mfma_f32_16x16x32_bf16 v[140:143], a[220:223], v[172:175], v[140:143]
v_mfma_f32_16x16x32_bf16 v[144:147], a[220:223], v[176:179], v[144:147]
v_mfma_f32_16x16x32_bf16 v[148:151], a[220:223], v[180:183], v[148:151]
s_waitcnt lgkmcnt(4)
v_mfma_f32_16x16x32_bf16 v[104:107], a[224:227], v[184:187], v[104:107]
ds_read_b128 v[168:171], v5 offset:32768
s_add_u32 s92, s92, 4096
s_addc_u32 s93, s93, 0
global_load_dwordx4 a[152:155], v2, s[92:93] offset:0
v_mfma_f32_16x16x32_bf16 v[108:111], a[224:227], v[188:191], v[108:111]
ds_read_b128 v[172:175], v5 offset:33024
global_load_dwordx4 a[156:159], v2, s[92:93] offset:1024
v_mfma_f32_16x16x32_bf16 v[112:115], a[224:227], v[192:195], v[112:115]
ds_read_b128 v[176:179], v5 offset:33280
v_mfma_f32_16x16x32_bf16 v[116:119], a[224:227], v[196:199], v[116:119]
ds_read_b128 v[180:183], v5 offset:33536
v_mfma_f32_16x16x32_bf16 v[120:123], a[228:231], v[184:187], v[120:123]
v_mfma_f32_16x16x32_bf16 v[124:127], a[228:231], v[188:191], v[124:127]
v_mfma_f32_16x16x32_bf16 v[128:131], a[228:231], v[192:195], v[128:131]
v_mfma_f32_16x16x32_bf16 v[132:135], a[228:231], v[196:199], v[132:135]
v_mfma_f32_16x16x32_bf16 v[136:139], a[232:235], v[184:187], v[136:139]
v_mfma_f32_16x16x32_bf16 v[140:143], a[232:235], v[188:191], v[140:143]
v_mfma_f32_16x16x32_bf16 v[144:147], a[232:235], v[192:195], v[144:147]
v_mfma_f32_16x16x32_bf16 v[148:151], a[232:235], v[196:199], v[148:151]
s_waitcnt lgkmcnt(4)
v_mfma_f32_16x16x32_bf16 v[104:107], a[236:239], v[152:155], v[104:107]
ds_read_b128 v[184:187], v6 offset:32768
s_sub_u32 s92, s92, 24576
s_subb_u32 s93, s93, 0
global_load_dwordx4 a[160:163], v2, s[92:93] offset:2048
v_mfma_f32_16x16x32_bf16 v[108:111], a[236:239], v[156:159], v[108:111]
ds_read_b128 v[188:191], v6 offset:33024
global_load_dwordx4 a[164:167], v2, s[92:93] offset:3072
v_mfma_f32_16x16x32_bf16 v[112:115], a[236:239], v[160:163], v[112:115]
ds_read_b128 v[192:195], v6 offset:33280
v_mfma_f32_16x16x32_bf16 v[116:119], a[236:239], v[164:167], v[116:119]
ds_read_b128 v[196:199], v6 offset:33536
v_mfma_f32_16x16x32_bf16 v[120:123], a[240:243], v[152:155], v[120:123]
v_mfma_f32_16x16x32_bf16 v[124:127], a[240:243], v[156:159], v[124:127]
v_mfma_f32_16x16x32_bf16 v[128:131], a[240:243], v[160:163], v[128:131]
v_mfma_f32_16x16x32_bf16 v[132:135], a[240:243], v[164:167], v[132:135]
v_mfma_f32_16x16x32_bf16 v[136:139], a[244:247], v[152:155], v[136:139]
v_mfma_f32_16x16x32_bf16 v[140:143], a[244:247], v[156:159], v[140:143]
v_mfma_f32_16x16x32_bf16 v[144:147], a[244:247], v[160:163], v[144:147]
v_mfma_f32_16x16x32_bf16 v[148:151], a[244:247], v[164:167], v[148:151]
s_waitcnt vmcnt(14)
s_barrier
s_waitcnt lgkmcnt(4)
v_mfma_f32_16x16x32_bf16 v[104:107], a[248:251], v[168:171], v[104:107]
ds_read_b128 v[152:155], v3 offset:49152
s_add_u32 s92, s92, 4096
s_addc_u32 s93, s93, 0
global_load_dwordx4 a[168:171], v2, s[92:93] offset:0
v_mfma_f32_16x16x32_bf16 v[108:111], a[248:251], v[172:175], v[108:111]
ds_read_b128 v[156:159], v3 offset:49408
global_load_dwordx4 a[172:175], v2, s[92:93] offset:1024
v_mfma_f32_16x16x32_bf16 v[112:115], a[248:251], v[176:179], v[112:115]
ds_read_b128 v[160:163], v3 offset:49664
v_mfma_f32_16x16x32_bf16 v[116:119], a[248:251], v[180:183], v[116:119]
ds_read_b128 v[164:167], v3 offset:49920
v_mfma_f32_16x16x32_bf16 v[120:123], a[252:255], v[168:171], v[120:123]
v_mfma_f32_16x16x32_bf16 v[124:127], a[252:255], v[172:175], v[124:127]
v_mfma_f32_16x16x32_bf16 v[128:131], a[252:255], v[176:179], v[128:131]
v_mfma_f32_16x16x32_bf16 v[132:135], a[252:255], v[180:183], v[132:135]
v_mfma_f32_16x16x32_bf16 v[136:139], v[224:227], v[168:171], v[136:139]
v_mfma_f32_16x16x32_bf16 v[140:143], v[224:227], v[172:175], v[140:143]
v_mfma_f32_16x16x32_bf16 v[144:147], v[224:227], v[176:179], v[144:147]
v_mfma_f32_16x16x32_bf16 v[148:151], v[224:227], v[180:183], v[148:151]
s_waitcnt lgkmcnt(4)
v_mfma_f32_16x16x32_bf16 v[104:107], v[228:231], v[184:187], v[104:107]
ds_read_b128 v[168:171], v4 offset:49152
global_load_dwordx4 a[176:179], v2, s[92:93] offset:2048
v_mfma_f32_16x16x32_bf16 v[108:111], v[228:231], v[188:191], v[108:111]
ds_read_b128 v[172:175], v4 offset:49408
global_load_dwordx4 a[180:183], v2, s[92:93] offset:3072
v_mfma_f32_16x16x32_bf16 v[112:115], v[228:231], v[192:195], v[112:115]
ds_read_b128 v[176:179], v4 offset:49664
v_mfma_f32_16x16x32_bf16 v[116:119], v[228:231], v[196:199], v[116:119]
ds_read_b128 v[180:183], v4 offset:49920
v_mfma_f32_16x16x32_bf16 v[120:123], v[232:235], v[184:187], v[120:123]
v_mfma_f32_16x16x32_bf16 v[124:127], v[232:235], v[188:191], v[124:127]
v_mfma_f32_16x16x32_bf16 v[128:131], v[232:235], v[192:195], v[128:131]
v_mfma_f32_16x16x32_bf16 v[132:135], v[232:235], v[196:199], v[132:135]
v_mfma_f32_16x16x32_bf16 v[136:139], v[236:239], v[184:187], v[136:139]
v_mfma_f32_16x16x32_bf16 v[140:143], v[236:239], v[188:191], v[140:143]
v_mfma_f32_16x16x32_bf16 v[144:147], v[236:239], v[192:195], v[144:147]
v_mfma_f32_16x16x32_bf16 v[148:151], v[236:239], v[196:199], v[148:151]
s_waitcnt lgkmcnt(4)
v_mfma_f32_16x16x32_bf16 v[104:107], v[240:243], v[152:155], v[104:107]
ds_read_b128 v[184:187], v5 offset:49152
s_lshl_b32 s26, s22, 13
v_mfma_f32_16x16x32_bf16 v[108:111], v[240:243], v[156:159], v[108:111]
ds_read_b128 v[188:191], v5 offset:49408
s_lshl_b32 s31, s20, 11
v_mfma_f32_16x16x32_bf16 v[112:115], v[240:243], v[160:163], v[112:115]
ds_read_b128 v[192:195], v5 offset:49664
s_add_u32 s26, s26, s31
v_mfma_f32_16x16x32_bf16 v[116:119], v[240:243], v[164:167], v[116:119]
ds_read_b128 v[196:199], v5 offset:49920
s_add_u32 s26, s26, s24
v_mfma_f32_16x16x32_bf16 v[120:123], v[244:247], v[152:155], v[120:123]
s_add_u32 s26, s26, 81920
v_mfma_f32_16x16x32_bf16 v[124:127], v[244:247], v[156:159], v[124:127]
buffer_load_dword v62, v29, s[16:19], s26 offen sc1
v_mfma_f32_16x16x32_bf16 v[128:131], v[244:247], v[160:163], v[128:131]
s_add_u32 s92, s92, 4096
s_addc_u32 s93, s93, 0
global_load_dwordx4 a[184:187], v2, s[92:93] offset:0
v_mfma_f32_16x16x32_bf16 v[132:135], v[244:247], v[164:167], v[132:135]
global_load_dwordx4 a[188:191], v2, s[92:93] offset:1024
v_mfma_f32_16x16x32_bf16 v[136:139], v[248:251], v[152:155], v[136:139]
v_mfma_f32_16x16x32_bf16 v[140:143], v[248:251], v[156:159], v[140:143]
v_mfma_f32_16x16x32_bf16 v[144:147], v[248:251], v[160:163], v[144:147]
v_mfma_f32_16x16x32_bf16 v[148:151], v[248:251], v[164:167], v[148:151]
s_waitcnt lgkmcnt(4)
v_mfma_f32_16x16x32_bf16 v[104:107], v[252:255], v[168:171], v[104:107]
ds_read_b128 v[152:155], v6 offset:49152
global_load_dwordx4 a[192:195], v2, s[92:93] offset:2048
v_mfma_f32_16x16x32_bf16 v[108:111], v[252:255], v[172:175], v[108:111]
ds_read_b128 v[156:159], v6 offset:49408
global_load_dwordx4 a[196:199], v2, s[92:93] offset:3072
v_mfma_f32_16x16x32_bf16 v[112:115], v[252:255], v[176:179], v[112:115]
ds_read_b128 v[160:163], v6 offset:49664
s_add_u32 s92, s92, 4096
s_addc_u32 s93, s93, 0
global_load_dwordx4 a[200:203], v2, s[92:93] offset:0
v_mfma_f32_16x16x32_bf16 v[116:119], v[252:255], v[180:183], v[116:119]
ds_read_b128 v[164:167], v6 offset:49920
s_waitcnt vmcnt(21)
v_mfma_f32_16x16x32_bf16 v[120:123], a[128:131], v[168:171], v[120:123]
v_mfma_f32_16x16x32_bf16 v[124:127], a[128:131], v[172:175], v[124:127]
v_mfma_f32_16x16x32_bf16 v[128:131], a[128:131], v[176:179], v[128:131]
v_mfma_f32_16x16x32_bf16 v[132:135], a[128:131], v[180:183], v[132:135]
s_waitcnt vmcnt(19)
v_mfma_f32_16x16x32_bf16 v[136:139], a[132:135], v[168:171], v[136:139]
v_mfma_f32_16x16x32_bf16 v[140:143], a[132:135], v[172:175], v[140:143]
v_mfma_f32_16x16x32_bf16 v[144:147], a[132:135], v[176:179], v[144:147]
v_mfma_f32_16x16x32_bf16 v[148:151], a[132:135], v[180:183], v[148:151]
s_waitcnt vmcnt(18)
s_barrier
s_waitcnt vmcnt(17) lgkmcnt(4)
v_mfma_f32_16x16x32_bf16 v[104:107], a[136:139], v[184:187], v[104:107]
ds_read_b128 v[168:171], v7 offset:0
global_load_dwordx4 a[204:207], v2, s[92:93] offset:1024
v_mfma_f32_16x16x32_bf16 v[108:111], a[136:139], v[188:191], v[108:111]
ds_read_b128 v[172:175], v7 offset:256
s_add_u32 s92, s92, 106496
s_addc_u32 s93, s93, 0
global_load_dwordx4 a[208:211], v2, s[92:93] offset:1024
v_mfma_f32_16x16x32_bf16 v[112:115], a[136:139], v[192:195], v[112:115]
ds_read_b128 v[176:179], v7 offset:512
global_load_dwordx4 a[212:215], v2, s[92:93] offset:2048
v_mfma_f32_16x16x32_bf16 v[116:119], a[136:139], v[196:199], v[116:119]
ds_read_b128 v[180:183], v7 offset:768
s_waitcnt vmcnt(19)
v_mfma_f32_16x16x32_bf16 v[120:123], a[140:143], v[184:187], v[120:123]
v_mfma_f32_16x16x32_bf16 v[124:127], a[140:143], v[188:191], v[124:127]
v_mfma_f32_16x16x32_bf16 v[128:131], a[140:143], v[192:195], v[128:131]
v_mfma_f32_16x16x32_bf16 v[132:135], a[140:143], v[196:199], v[132:135]
s_waitcnt vmcnt(18)
v_mfma_f32_16x16x32_bf16 v[136:139], a[144:147], v[184:187], v[136:139]
v_mfma_f32_16x16x32_bf16 v[140:143], a[144:147], v[188:191], v[140:143]
v_mfma_f32_16x16x32_bf16 v[144:147], a[144:147], v[192:195], v[144:147]
v_mfma_f32_16x16x32_bf16 v[148:151], a[144:147], v[196:199], v[148:151]
s_waitcnt vmcnt(17) lgkmcnt(4)
v_mfma_f32_16x16x32_bf16 v[104:107], a[148:151], v[152:155], v[104:107]
ds_read_b128 v[184:187], v8 offset:0
global_load_dwordx4 a[216:219], v2, s[92:93] offset:3072
v_mfma_f32_16x16x32_bf16 v[108:111], a[148:151], v[156:159], v[108:111]
ds_read_b128 v[188:191], v8 offset:256
s_add_u32 s92, s92, 4096
s_addc_u32 s93, s93, 0
global_load_dwordx4 a[220:223], v2, s[92:93] offset:0
v_mfma_f32_16x16x32_bf16 v[112:115], a[148:151], v[160:163], v[112:115]
ds_read_b128 v[192:195], v8 offset:512
global_load_dwordx4 a[224:227], v2, s[92:93] offset:1024
v_mfma_f32_16x16x32_bf16 v[116:119], a[148:151], v[164:167], v[116:119]
ds_read_b128 v[196:199], v8 offset:768
s_waitcnt vmcnt(19)
v_mfma_f32_16x16x32_bf16 v[120:123], a[152:155], v[152:155], v[120:123]
v_mfma_f32_16x16x32_bf16 v[124:127], a[152:155], v[156:159], v[124:127]
v_mfma_f32_16x16x32_bf16 v[128:131], a[152:155], v[160:163], v[128:131]
v_mfma_f32_16x16x32_bf16 v[132:135], a[152:155], v[164:167], v[132:135]
s_waitcnt vmcnt(18)
v_mfma_f32_16x16x32_bf16 v[136:139], a[156:159], v[152:155], v[136:139]
v_mfma_f32_16x16x32_bf16 v[140:143], a[156:159], v[156:159], v[140:143]
v_mfma_f32_16x16x32_bf16 v[144:147], a[156:159], v[160:163], v[144:147]
v_mfma_f32_16x16x32_bf16 v[148:151], a[156:159], v[164:167], v[148:151]
s_waitcnt vmcnt(17) lgkmcnt(4)
v_mfma_f32_16x16x32_bf16 v[104:107], a[160:163], v[168:171], v[104:107]
ds_read_b128 v[152:155], v9 offset:0
s_sub_u32 s92, s92, 8192
s_subb_u32 s93, s93, 0
global_load_dwordx4 a[228:231], v2, s[92:93] offset:0
v_mfma_f32_16x16x32_bf16 v[108:111], a[160:163], v[172:175], v[108:111]
ds_read_b128 v[156:159], v9 offset:256
ds_read_b128 v[200:203], v22 offset:0
v_mfma_f32_16x16x32_bf16 v[112:115], a[160:163], v[176:179], v[112:115]
ds_read_b128 v[160:163], v9 offset:512
ds_read_b128 v[204:207], v22 offset:256
v_mfma_f32_16x16x32_bf16 v[116:119], a[160:163], v[180:183], v[116:119]
ds_read_b128 v[164:167], v9 offset:768
ds_read_b128 v[208:211], v22 offset:512
s_waitcnt vmcnt(17)
v_mfma_f32_16x16x32_bf16 v[120:123], a[164:167], v[168:171], v[120:123]
ds_read_b128 v[212:215], v22 offset:768
v_mfma_f32_16x16x32_bf16 v[124:127], a[164:167], v[172:175], v[124:127]
global_load_dwordx4 a[232:235], v2, s[92:93] offset:1024
v_mfma_f32_16x16x32_bf16 v[128:131], a[164:167], v[176:179], v[128:131]
global_load_dwordx4 a[236:239], v2, s[92:93] offset:2048
v_mfma_f32_16x16x32_bf16 v[132:135], a[164:167], v[180:183], v[132:135]
s_waitcnt vmcnt(18)
v_mfma_f32_16x16x32_bf16 v[136:139], a[168:171], v[168:171], v[136:139]
v_mfma_f32_16x16x32_bf16 v[140:143], a[168:171], v[172:175], v[140:143]
v_mfma_f32_16x16x32_bf16 v[144:147], a[168:171], v[176:179], v[144:147]
v_mfma_f32_16x16x32_bf16 v[148:151], a[168:171], v[180:183], v[148:151]
s_waitcnt vmcnt(17) lgkmcnt(8)
v_mfma_f32_16x16x32_bf16 v[104:107], a[172:175], v[184:187], v[104:107]
ds_read_b128 v[168:171], v10 offset:0
global_load_dwordx4 a[240:243], v2, s[92:93] offset:3072
v_mfma_f32_16x16x32_bf16 v[108:111], a[172:175], v[188:191], v[108:111]
ds_read_b128 v[172:175], v10 offset:256
s_add_u32 s92, s92, 4096
s_addc_u32 s93, s93, 0
global_load_dwordx4 a[244:247], v2, s[92:93] offset:0
v_mfma_f32_16x16x32_bf16 v[112:115], a[172:175], v[192:195], v[112:115]
ds_read_b128 v[176:179], v10 offset:512
s_sub_u32 s92, s92, 12288
s_subb_u32 s93, s93, 0
global_load_dwordx4 a[248:251], v2, s[92:93] offset:3072
v_mfma_f32_16x16x32_bf16 v[116:119], a[172:175], v[196:199], v[116:119]
ds_read_b128 v[180:183], v10 offset:768
s_waitcnt vmcnt(19)
v_mfma_f32_16x16x32_bf16 v[120:123], a[176:179], v[184:187], v[120:123]
v_mfma_f32_16x16x32_bf16 v[124:127], a[176:179], v[188:191], v[124:127]
v_mfma_f32_16x16x32_bf16 v[128:131], a[176:179], v[192:195], v[128:131]
v_mfma_f32_16x16x32_bf16 v[132:135], a[176:179], v[196:199], v[132:135]
s_waitcnt vmcnt(18)
v_mfma_f32_16x16x32_bf16 v[136:139], a[180:183], v[184:187], v[136:139]
v_mfma_f32_16x16x32_bf16 v[140:143], a[180:183], v[188:191], v[140:143]
v_mfma_f32_16x16x32_bf16 v[144:147], a[180:183], v[192:195], v[144:147]
v_mfma_f32_16x16x32_bf16 v[148:151], a[180:183], v[196:199], v[148:151]
s_waitcnt vmcnt(16) lgkmcnt(6)
v_mfma_f32_16x16x32_bf16 v[104:107], a[184:187], v[152:155], v[104:107]
s_add_u32 s92, s92, 4096
s_addc_u32 s93, s93, 0
global_load_dwordx4 a[252:255], v2, s[92:93] offset:0
v_mfma_f32_16x16x32_bf16 v[108:111], a[184:187], v[156:159], v[108:111]
global_load_dwordx4 v[224:227], v2, s[92:93] offset:1024
v_mfma_f32_16x16x32_bf16 v[112:115], a[184:187], v[160:163], v[112:115]
global_load_dwordx4 v[228:231], v2, s[92:93] offset:2048
v_mfma_f32_16x16x32_bf16 v[116:119], a[184:187], v[164:167], v[116:119]
s_waitcnt vmcnt(18)
v_mfma_f32_16x16x32_bf16 v[120:123], a[188:191], v[152:155], v[120:123]
v_mfma_f32_16x16x32_bf16 v[124:127], a[188:191], v[156:159], v[124:127]
v_mfma_f32_16x16x32_bf16 v[128:131], a[188:191], v[160:163], v[128:131]
v_mfma_f32_16x16x32_bf16 v[132:135], a[188:191], v[164:167], v[132:135]
s_waitcnt vmcnt(17)
v_mfma_f32_16x16x32_bf16 v[136:139], a[192:195], v[152:155], v[136:139]
v_mfma_f32_16x16x32_bf16 v[140:143], a[192:195], v[156:159], v[140:143]
v_mfma_f32_16x16x32_bf16 v[144:147], a[192:195], v[160:163], v[144:147]
v_mfma_f32_16x16x32_bf16 v[148:151], a[192:195], v[164:167], v[148:151]
s_waitcnt vmcnt(16) lgkmcnt(0)
v_mfma_f32_16x16x32_bf16 v[104:107], a[196:199], v[168:171], v[104:107]
global_load_dwordx4 v[232:235], v2, s[92:93] offset:3072
v_mfma_f32_16x16x32_bf16 v[108:111], a[196:199], v[172:175], v[108:111]
s_sub_u32 s92, s92, 8192
s_subb_u32 s93, s93, 0
global_load_dwordx4 v[236:239], v2, s[92:93] offset:2048
v_mfma_f32_16x16x32_bf16 v[112:115], a[196:199], v[176:179], v[112:115]
global_load_dwordx4 v[240:243], v2, s[92:93] offset:3072
v_mfma_f32_16x16x32_bf16 v[116:119], a[196:199], v[180:183], v[116:119]
s_waitcnt vmcnt(18)
v_mfma_f32_16x16x32_bf16 v[120:123], a[200:203], v[168:171], v[120:123]
v_mfma_f32_16x16x32_bf16 v[124:127], a[200:203], v[172:175], v[124:127]
v_mfma_f32_16x16x32_bf16 v[128:131], a[200:203], v[176:179], v[128:131]
v_mfma_f32_16x16x32_bf16 v[132:135], a[200:203], v[180:183], v[132:135]
s_waitcnt vmcnt(17)
v_mfma_f32_16x16x32_bf16 v[136:139], a[204:207], v[168:171], v[136:139]
v_mfma_f32_16x16x32_bf16 v[140:143], a[204:207], v[172:175], v[140:143]
v_mfma_f32_16x16x32_bf16 v[144:147], a[204:207], v[176:179], v[144:147]
v_mfma_f32_16x16x32_bf16 v[148:151], a[204:207], v[180:183], v[148:151]
s_waitcnt lgkmcnt(0)
s_add_u32 s92, s92, 4096
s_addc_u32 s93, s93, 0
global_load_dwordx4 v[244:247], v2, s[92:93] offset:0
v_pk_fma_f32 v[104:105], v[92:93], v[200:201], v[104:105] op_sel_hi:[1,0,1] neg_lo:[0,1,0] neg_hi:[0,1,0]
v_pk_fma_f32 v[106:107], v[94:95], v[200:201], v[106:107] op_sel_hi:[1,0,1] neg_lo:[0,1,0] neg_hi:[0,1,0]
v_pk_mul_f32 v[172:173], v[104:105], v[104:105]
v_pk_mul_f32 v[174:175], v[106:107], v[106:107]
v_pk_fma_f32 v[172:173], v[172:173], v[202:203], v[202:203] op_sel:[0,1,0] op_sel_hi:[1,1,0]
v_pk_fma_f32 v[174:175], v[174:175], v[202:203], v[202:203] op_sel:[0,1,0] op_sel_hi:[1,1,0]
v_pk_mul_f32 v[172:173], v[172:173], v[104:105]
v_pk_mul_f32 v[174:175], v[174:175], v[106:107]
v_exp_f32 v172, v172
v_exp_f32 v173, v173
v_exp_f32 v174, v174
v_exp_f32 v175, v175
v_pk_fma_f32 v[172:173], v[172:173], v[200:201], v[200:201] op_sel:[0,1,1] op_sel_hi:[1,1,1]
v_pk_fma_f32 v[174:175], v[174:175], v[200:201], v[200:201] op_sel:[0,1,1] op_sel_hi:[1,1,1]
v_rcp_f32 v172, v172
v_rcp_f32 v173, v173
v_rcp_f32 v174, v174
v_rcp_f32 v175, v175
v_pk_mul_f32 v[104:105], v[104:105], v[172:173]
v_pk_mul_f32 v[106:107], v[106:107], v[174:175]
v_cvt_pk_bf16_f32 v176, v104, v105
v_cvt_pk_bf16_f32 v177, v106, v107
s_cmp_lg_u32 s23, 0
s_cbranch_scc1 slow_158
global_store_dwordx2 v13, v[176:177], s[16:17] offset:0
back_159:
global_load_dwordx4 v[248:251], v2, s[92:93] offset:1024
v_pk_fma_f32 v[108:109], v[92:93], v[204:205], v[108:109] op_sel_hi:[1,0,1] neg_lo:[0,1,0] neg_hi:[0,1,0]
v_pk_fma_f32 v[110:111], v[94:95], v[204:205], v[110:111] op_sel_hi:[1,0,1] neg_lo:[0,1,0] neg_hi:[0,1,0]
v_pk_mul_f32 v[172:173], v[108:109], v[108:109]
v_pk_mul_f32 v[174:175], v[110:111], v[110:111]
v_pk_fma_f32 v[172:173], v[172:173], v[206:207], v[206:207] op_sel:[0,1,0] op_sel_hi:[1,1,0]
v_pk_fma_f32 v[174:175], v[174:175], v[206:207], v[206:207] op_sel:[0,1,0] op_sel_hi:[1,1,0]
v_pk_mul_f32 v[172:173], v[172:173], v[108:109]
v_pk_mul_f32 v[174:175], v[174:175], v[110:111]
v_exp_f32 v172, v172
v_exp_f32 v173, v173
v_exp_f32 v174, v174
v_exp_f32 v175, v175
v_pk_fma_f32 v[172:173], v[172:173], v[204:205], v[204:205] op_sel:[0,1,1] op_sel_hi:[1,1,1]
v_pk_fma_f32 v[174:175], v[174:175], v[204:205], v[204:205] op_sel:[0,1,1] op_sel_hi:[1,1,1]
v_rcp_f32 v172, v172
v_rcp_f32 v173, v173
v_rcp_f32 v174, v174
v_rcp_f32 v175, v175
v_pk_mul_f32 v[108:109], v[108:109], v[172:173]
v_pk_mul_f32 v[110:111], v[110:111], v[174:175]
v_cvt_pk_bf16_f32 v178, v108, v109
v_cvt_pk_bf16_f32 v179, v110, v111
s_cbranch_scc1 slow_160
global_store_dwordx2 v13, v[178:179], s[16:17] offset:256
back_161:
global_load_dwordx4 v[252:255], v2, s[92:93] offset:2048
v_pk_fma_f32 v[112:113], v[92:93], v[208:209], v[112:113] op_sel_hi:[1,0,1] neg_lo:[0,1,0] neg_hi:[0,1,0]
v_pk_fma_f32 v[114:115], v[94:95], v[208:209], v[114:115] op_sel_hi:[1,0,1] neg_lo:[0,1,0] neg_hi:[0,1,0]
v_pk_mul_f32 v[172:173], v[112:113], v[112:113]
v_pk_mul_f32 v[174:175], v[114:115], v[114:115]
v_pk_fma_f32 v[172:173], v[172:173], v[210:211], v[210:211] op_sel:[0,1,0] op_sel_hi:[1,1,0]
v_pk_fma_f32 v[174:175], v[174:175], v[210:211], v[210:211] op_sel:[0,1,0] op_sel_hi:[1,1,0]
v_pk_mul_f32 v[172:173], v[172:173], v[112:113]
v_pk_mul_f32 v[174:175], v[174:175], v[114:115]
v_exp_f32 v172, v172
v_exp_f32 v173, v173
v_exp_f32 v174, v174
v_exp_f32 v175, v175
v_pk_fma_f32 v[172:173], v[172:173], v[208:209], v[208:209] op_sel:[0,1,1] op_sel_hi:[1,1,1]
v_pk_fma_f32 v[174:175], v[174:175], v[208:209], v[208:209] op_sel:[0,1,1] op_sel_hi:[1,1,1]
v_rcp_f32 v172, v172
v_rcp_f32 v173, v173
v_rcp_f32 v174, v174
v_rcp_f32 v175, v175
v_pk_mul_f32 v[112:113], v[112:113], v[172:173]
v_pk_mul_f32 v[114:115], v[114:115], v[174:175]
v_cvt_pk_bf16_f32 v180, v112, v113
v_cvt_pk_bf16_f32 v181, v114, v115
s_cbranch_scc1 slow_162
global_store_dwordx2 v13, v[180:181], s[16:17] offset:512
back_163:
s_sub_u32 s92, s92, 8192
s_subb_u32 s93, s93, 0
global_load_dwordx4 a[128:131], v2, s[92:93] offset:1024
v_pk_fma_f32 v[116:117], v[92:93], v[212:213], v[116:117] op_sel_hi:[1,0,1] neg_lo:[0,1,0] neg_hi:[0,1,0]
v_pk_fma_f32 v[118:119], v[94:95], v[212:213], v[118:119] op_sel_hi:[1,0,1] neg_lo:[0,1,0] neg_hi:[0,1,0]
v_pk_mul_f32 v[172:173], v[116:117], v[116:117]
v_pk_mul_f32 v[174:175], v[118:119], v[118:119]
v_pk_fma_f32 v[172:173], v[172:173], v[214:215], v[214:215] op_sel:[0,1,0] op_sel_hi:[1,1,0]
v_pk_fma_f32 v[174:175], v[174:175], v[214:215], v[214:215] op_sel:[0,1,0] op_sel_hi:[1,1,0]
v_pk_mul_f32 v[172:173], v[172:173], v[116:117]
v_pk_mul_f32 v[174:175], v[174:175], v[118:119]
v_exp_f32 v172, v172
v_exp_f32 v173, v173
v_exp_f32 v174, v174
v_exp_f32 v175, v175
v_pk_fma_f32 v[172:173], v[172:173], v[212:213], v[212:213] op_sel:[0,1,1] op_sel_hi:[1,1,1]
v_pk_fma_f32 v[174:175], v[174:175], v[212:213], v[212:213] op_sel:[0,1,1] op_sel_hi:[1,1,1]
v_rcp_f32 v172, v172
v_rcp_f32 v173, v173
v_rcp_f32 v174, v174
v_rcp_f32 v175, v175
v_pk_mul_f32 v[116:117], v[116:117], v[172:173]
v_pk_mul_f32 v[118:119], v[118:119], v[174:175]
v_cvt_pk_bf16_f32 v182, v116, v117
v_cvt_pk_bf16_f32 v183, v118, v119
s_cmp_lg_u32 s23, 0
s_cbranch_scc1 slow_164
global_store_dwordx2 v13, v[182:183], s[16:17] offset:768
back_165:
global_load_dwordx4 a[132:135], v2, s[92:93] offset:2048
v_pk_fma_f32 v[120:121], v[96:97], v[200:201], v[120:121] op_sel_hi:[1,0,1] neg_lo:[0,1,0] neg_hi:[0,1,0]
v_pk_fma_f32 v[122:123], v[98:99], v[200:201], v[122:123] op_sel_hi:[1,0,1] neg_lo:[0,1,0] neg_hi:[0,1,0]
v_pk_mul_f32 v[172:173], v[120:121], v[120:121]
v_pk_mul_f32 v[174:175], v[122:123], v[122:123]
v_pk_fma_f32 v[172:173], v[172:173], v[202:203], v[202:203] op_sel:[0,1,0] op_sel_hi:[1,1,0]
v_pk_fma_f32 v[174:175], v[174:175], v[202:203], v[202:203] op_sel:[0,1,0] op_sel_hi:[1,1,0]
v_pk_mul_f32 v[172:173], v[172:173], v[120:121]
v_pk_mul_f32 v[174:175], v[174:175], v[122:123]
v_exp_f32 v172, v172
v_exp_f32 v173, v173
v_exp_f32 v174, v174
v_exp_f32 v175, v175
v_pk_fma_f32 v[172:173], v[172:173], v[200:201], v[200:201] op_sel:[0,1,1] op_sel_hi:[1,1,1]
v_pk_fma_f32 v[174:175], v[174:175], v[200:201], v[200:201] op_sel:[0,1,1] op_sel_hi:[1,1,1]
v_rcp_f32 v172, v172
v_rcp_f32 v173, v173
v_rcp_f32 v174, v174
v_rcp_f32 v175, v175
v_pk_mul_f32 v[120:121], v[120:121], v[172:173]
v_pk_mul_f32 v[122:123], v[122:123], v[174:175]
v_cvt_pk_bf16_f32 v184, v120, v121
v_cvt_pk_bf16_f32 v185, v122, v123
s_cbranch_scc1 slow_166
global_store_dwordx2 v13, v[184:185], s[84:85] offset:0
back_167:
global_load_dwordx4 a[136:139], v2, s[92:93] offset:3072
v_pk_fma_f32 v[124:125], v[96:97], v[204:205], v[124:125] op_sel_hi:[1,0,1] neg_lo:[0,1,0] neg_hi:[0,1,0]
v_pk_fma_f32 v[126:127], v[98:99], v[204:205], v[126:127] op_sel_hi:[1,0,1] neg_lo:[0,1,0] neg_hi:[0,1,0]
v_pk_mul_f32 v[172:173], v[124:125], v[124:125]
v_pk_mul_f32 v[174:175], v[126:127], v[126:127]
v_pk_fma_f32 v[172:173], v[172:173], v[206:207], v[206:207] op_sel:[0,1,0] op_sel_hi:[1,1,0]
v_pk_fma_f32 v[174:175], v[174:175], v[206:207], v[206:207] op_sel:[0,1,0] op_sel_hi:[1,1,0]
v_pk_mul_f32 v[172:173], v[172:173], v[124:125]
v_pk_mul_f32 v[174:175], v[174:175], v[126:127]
v_exp_f32 v172, v172
v_exp_f32 v173, v173
v_exp_f32 v174, v174
v_exp_f32 v175, v175
v_pk_fma_f32 v[172:173], v[172:173], v[204:205], v[204:205] op_sel:[0,1,1] op_sel_hi:[1,1,1]
v_pk_fma_f32 v[174:175], v[174:175], v[204:205], v[204:205] op_sel:[0,1,1] op_sel_hi:[1,1,1]
v_rcp_f32 v172, v172
v_rcp_f32 v173, v173
v_rcp_f32 v174, v174
v_rcp_f32 v175, v175
v_pk_mul_f32 v[124:125], v[124:125], v[172:173]
v_pk_mul_f32 v[126:127], v[126:127], v[174:175]
v_cvt_pk_bf16_f32 v186, v124, v125
v_cvt_pk_bf16_f32 v187, v126, v127
s_cbranch_scc1 slow_168
global_store_dwordx2 v13, v[186:187], s[84:85] offset:256
back_169:
s_add_u32 s92, s92, 4096
s_addc_u32 s93, s93, 0
global_load_dwordx4 a[140:143], v2, s[92:93] offset:0
v_pk_fma_f32 v[128:129], v[96:97], v[208:209], v[128:129] op_sel_hi:[1,0,1] neg_lo:[0,1,0] neg_hi:[0,1,0]
v_pk_fma_f32 v[130:131], v[98:99], v[208:209], v[130:131] op_sel_hi:[1,0,1] neg_lo:[0,1,0] neg_hi:[0,1,0]
v_pk_mul_f32 v[172:173], v[128:129], v[128:129]
v_pk_mul_f32 v[174:175], v[130:131], v[130:131]
v_pk_fma_f32 v[172:173], v[172:173], v[210:211], v[210:211] op_sel:[0,1,0] op_sel_hi:[1,1,0]
v_pk_fma_f32 v[174:175], v[174:175], v[210:211], v[210:211] op_sel:[0,1,0] op_sel_hi:[1,1,0]
v_pk_mul_f32 v[172:173], v[172:173], v[128:129]
v_pk_mul_f32 v[174:175], v[174:175], v[130:131]
v_exp_f32 v172, v172
v_exp_f32 v173, v173
v_exp_f32 v174, v174
v_exp_f32 v175, v175
v_pk_fma_f32 v[172:173], v[172:173], v[208:209], v[208:209] op_sel:[0,1,1] op_sel_hi:[1,1,1]
v_pk_fma_f32 v[174:175], v[174:175], v[208:209], v[208:209] op_sel:[0,1,1] op_sel_hi:[1,1,1]
v_rcp_f32 v172, v172
v_rcp_f32 v173, v173
v_rcp_f32 v174, v174
v_rcp_f32 v175, v175
v_pk_mul_f32 v[128:129], v[128:129], v[172:173]
v_pk_mul_f32 v[130:131], v[130:131], v[174:175]
v_cvt_pk_bf16_f32 v188, v128, v129
v_cvt_pk_bf16_f32 v189, v130, v131
s_cmp_lg_u32 s23, 0
s_cbranch_scc1 slow_170
global_store_dwordx2 v13, v[188:189], s[84:85] offset:512
back_171:
global_load_dwordx4 a[144:147], v2, s[92:93] offset:1024
v_pk_fma_f32 v[132:133], v[96:97], v[212:213], v[132:133] op_sel_hi:[1,0,1] neg_lo:[0,1,0] neg_hi:[0,1,0]
v_pk_fma_f32 v[134:135], v[98:99], v[212:213], v[134:135] op_sel_hi:[1,0,1] neg_lo:[0,1,0] neg_hi:[0,1,0]
v_pk_mul_f32 v[172:173], v[132:133], v[132:133]
v_pk_mul_f32 v[174:175], v[134:135], v[134:135]
v_pk_fma_f32 v[172:173], v[172:173], v[214:215], v[214:215] op_sel:[0,1,0] op_sel_hi:[1,1,0]
v_pk_fma_f32 v[174:175], v[174:175], v[214:215], v[214:215] op_sel:[0,1,0] op_sel_hi:[1,1,0]
v_pk_mul_f32 v[172:173], v[172:173], v[132:133]
v_pk_mul_f32 v[174:175], v[174:175], v[134:135]
v_exp_f32 v172, v172
v_exp_f32 v173, v173
v_exp_f32 v174, v174
v_exp_f32 v175, v175
v_pk_fma_f32 v[172:173], v[172:173], v[212:213], v[212:213] op_sel:[0,1,1] op_sel_hi:[1,1,1]
v_pk_fma_f32 v[174:175], v[174:175], v[212:213], v[212:213] op_sel:[0,1,1] op_sel_hi:[1,1,1]
v_rcp_f32 v172, v172
v_rcp_f32 v173, v173
v_rcp_f32 v174, v174
v_rcp_f32 v175, v175
v_pk_mul_f32 v[132:133], v[132:133], v[172:173]
v_pk_mul_f32 v[134:135], v[134:135], v[174:175]
v_cvt_pk_bf16_f32 v190, v132, v133
v_cvt_pk_bf16_f32 v191, v134, v135
s_cbranch_scc1 slow_172
global_store_dwordx2 v13, v[190:191], s[84:85] offset:768
back_173:
s_sub_u32 s92, s92, 8192
s_subb_u32 s93, s93, 0
global_load_dwordx4 a[148:151], v2, s[92:93] offset:0
v_pk_fma_f32 v[136:137], v[100:101], v[200:201], v[136:137] op_sel_hi:[1,0,1] neg_lo:[0,1,0] neg_hi:[0,1,0]
v_pk_fma_f32 v[138:139], v[102:103], v[200:201], v[138:139] op_sel_hi:[1,0,1] neg_lo:[0,1,0] neg_hi:[0,1,0]
v_pk_mul_f32 v[172:173], v[136:137], v[136:137]
v_pk_mul_f32 v[174:175], v[138:139], v[138:139]
v_pk_fma_f32 v[172:173], v[172:173], v[202:203], v[202:203] op_sel:[0,1,0] op_sel_hi:[1,1,0]
v_pk_fma_f32 v[174:175], v[174:175], v[202:203], v[202:203] op_sel:[0,1,0] op_sel_hi:[1,1,0]
v_pk_mul_f32 v[172:173], v[172:173], v[136:137]
v_pk_mul_f32 v[174:175], v[174:175], v[138:139]
v_exp_f32 v172, v172
v_exp_f32 v173, v173
v_exp_f32 v174, v174
v_exp_f32 v175, v175
v_pk_fma_f32 v[172:173], v[172:173], v[200:201], v[200:201] op_sel:[0,1,1] op_sel_hi:[1,1,1]
v_pk_fma_f32 v[174:175], v[174:175], v[200:201], v[200:201] op_sel:[0,1,1] op_sel_hi:[1,1,1]
v_rcp_f32 v172, v172
v_rcp_f32 v173, v173
v_rcp_f32 v174, v174
v_rcp_f32 v175, v175
v_pk_mul_f32 v[136:137], v[136:137], v[172:173]
v_pk_mul_f32 v[138:139], v[138:139], v[174:175]
v_cvt_pk_bf16_f32 v192, v136, v137
v_cvt_pk_bf16_f32 v193, v138, v139
s_cmp_lg_u32 s23, 0
s_cbranch_scc1 slow_174
global_store_dwordx2 v13, v[192:193], s[10:11] offset:0
back_175:
global_load_dwordx4 a[152:155], v2, s[92:93] offset:1024
v_pk_fma_f32 v[140:141], v[100:101], v[204:205], v[140:141] op_sel_hi:[1,0,1] neg_lo:[0,1,0] neg_hi:[0,1,0]
v_pk_fma_f32 v[142:143], v[102:103], v[204:205], v[142:143] op_sel_hi:[1,0,1] neg_lo:[0,1,0] neg_hi:[0,1,0]
v_pk_mul_f32 v[172:173], v[140:141], v[140:141]
v_pk_mul_f32 v[174:175], v[142:143], v[142:143]
v_pk_fma_f32 v[172:173], v[172:173], v[206:207], v[206:207] op_sel:[0,1,0] op_sel_hi:[1,1,0]
v_pk_fma_f32 v[174:175], v[174:175], v[206:207], v[206:207] op_sel:[0,1,0] op_sel_hi:[1,1,0]
v_pk_mul_f32 v[172:173], v[172:173], v[140:141]
v_pk_mul_f32 v[174:175], v[174:175], v[142:143]
v_exp_f32 v172, v172
v_exp_f32 v173, v173
v_exp_f32 v174, v174
v_exp_f32 v175, v175
v_pk_fma_f32 v[172:173], v[172:173], v[204:205], v[204:205] op_sel:[0,1,1] op_sel_hi:[1,1,1]
v_pk_fma_f32 v[174:175], v[174:175], v[204:205], v[204:205] op_sel:[0,1,1] op_sel_hi:[1,1,1]
v_rcp_f32 v172, v172
v_rcp_f32 v173, v173
v_rcp_f32 v174, v174
v_rcp_f32 v175, v175
v_pk_mul_f32 v[140:141], v[140:141], v[172:173]
v_pk_mul_f32 v[142:143], v[142:143], v[174:175]
v_cvt_pk_bf16_f32 v194, v140, v141
v_cvt_pk_bf16_f32 v195, v142, v143
s_cbranch_scc1 slow_176
global_store_dwordx2 v13, v[194:195], s[10:11] offset:256
back_177:
global_load_dwordx4 a[156:159], v2, s[92:93] offset:2048
v_pk_fma_f32 v[144:145], v[100:101], v[208:209], v[144:145] op_sel_hi:[1,0,1] neg_lo:[0,1,0] neg_hi:[0,1,0]
v_pk_fma_f32 v[146:147], v[102:103], v[208:209], v[146:147] op_sel_hi:[1,0,1] neg_lo:[0,1,0] neg_hi:[0,1,0]
v_pk_mul_f32 v[172:173], v[144:145], v[144:145]
v_pk_mul_f32 v[174:175], v[146:147], v[146:147]
v_pk_fma_f32 v[172:173], v[172:173], v[210:211], v[210:211] op_sel:[0,1,0] op_sel_hi:[1,1,0]
v_pk_fma_f32 v[174:175], v[174:175], v[210:211], v[210:211] op_sel:[0,1,0] op_sel_hi:[1,1,0]
v_pk_mul_f32 v[172:173], v[172:173], v[144:145]
v_pk_mul_f32 v[174:175], v[174:175], v[146:147]
v_exp_f32 v172, v172
v_exp_f32 v173, v173
v_exp_f32 v174, v174
v_exp_f32 v175, v175
v_pk_fma_f32 v[172:173], v[172:173], v[208:209], v[208:209] op_sel:[0,1,1] op_sel_hi:[1,1,1]
v_pk_fma_f32 v[174:175], v[174:175], v[208:209], v[208:209] op_sel:[0,1,1] op_sel_hi:[1,1,1]
v_rcp_f32 v172, v172
v_rcp_f32 v173, v173
v_rcp_f32 v174, v174
v_rcp_f32 v175, v175
v_pk_mul_f32 v[144:145], v[144:145], v[172:173]
v_pk_mul_f32 v[146:147], v[146:147], v[174:175]
v_cvt_pk_bf16_f32 v196, v144, v145
v_cvt_pk_bf16_f32 v197, v146, v147
s_cbranch_scc1 slow_178
global_store_dwordx2 v13, v[196:197], s[10:11] offset:512
back_179:
global_load_dwordx4 a[160:163], v2, s[92:93] offset:3072
v_pk_fma_f32 v[148:149], v[100:101], v[212:213], v[148:149] op_sel_hi:[1,0,1] neg_lo:[0,1,0] neg_hi:[0,1,0]
v_pk_fma_f32 v[150:151], v[102:103], v[212:213], v[150:151] op_sel_hi:[1,0,1] neg_lo:[0,1,0] neg_hi:[0,1,0]
v_pk_mul_f32 v[172:173], v[148:149], v[148:149]
v_pk_mul_f32 v[174:175], v[150:151], v[150:151]
v_pk_fma_f32 v[172:173], v[172:173], v[214:215], v[214:215] op_sel:[0,1,0] op_sel_hi:[1,1,0]
v_pk_fma_f32 v[174:175], v[174:175], v[214:215], v[214:215] op_sel:[0,1,0] op_sel_hi:[1,1,0]
v_pk_mul_f32 v[172:173], v[172:173], v[148:149]
v_pk_mul_f32 v[174:175], v[174:175], v[150:151]
v_exp_f32 v172, v172
v_exp_f32 v173, v173
v_exp_f32 v174, v174
v_exp_f32 v175, v175
v_pk_fma_f32 v[172:173], v[172:173], v[212:213], v[212:213] op_sel:[0,1,1] op_sel_hi:[1,1,1]
v_pk_fma_f32 v[174:175], v[174:175], v[212:213], v[212:213] op_sel:[0,1,1] op_sel_hi:[1,1,1]
v_rcp_f32 v172, v172
v_rcp_f32 v173, v173
v_rcp_f32 v174, v174
v_rcp_f32 v175, v175
v_pk_mul_f32 v[148:149], v[148:149], v[172:173]
v_pk_mul_f32 v[150:151], v[150:151], v[174:175]
v_cvt_pk_bf16_f32 v198, v148, v149
v_cvt_pk_bf16_f32 v199, v150, v151
s_cbranch_scc1 slow_180
global_store_dwordx2 v13, v[198:199], s[10:11] offset:768
back_181:
s_add_u32 s92, s92, 4096
s_addc_u32 s93, s93, 0
global_load_dwordx4 a[164:167], v2, s[92:93] offset:0
s_sub_u32 s92, s92, 12288
s_subb_u32 s93, s93, 0
global_load_dwordx4 a[168:171], v2, s[92:93] offset:3072
s_add_u32 s92, s92, 4096
s_addc_u32 s93, s93, 0
global_load_dwordx4 a[172:175], v2, s[92:93] offset:0
global_load_dwordx4 a[176:179], v2, s[92:93] offset:1024
v_lshlrev_b32 v64, 16, v42
v_and_b32 v65, s64, v42
v_lshlrev_b32 v66, 16, v43
v_and_b32 v67, s64, v43
v_lshlrev_b32 v68, 16, v44
v_and_b32 v69, s64, v44
v_lshlrev_b32 v70, 16, v45
v_and_b32 v71, s64, v45
v_lshlrev_b32 v72, 16, v46
v_and_b32 v73, s64, v46
v_lshlrev_b32 v74, 16, v47
v_and_b32 v75, s64, v47
v_lshlrev_b32 v76, 16, v48
v_and_b32 v77, s64, v48
v_lshlrev_b32 v78, 16, v49
v_and_b32 v79, s64, v49
v_lshlrev_b32 v80, 16, v50
v_and_b32 v81, s64, v50
v_lshlrev_b32 v82, 16, v51
v_and_b32 v83, s64, v51
v_lshlrev_b32 v152, 16, v52
v_and_b32 v153, s64, v52
v_lshlrev_b32 v154, 16, v53
v_and_b32 v155, s64, v53
v_lshlrev_b32 v156, 16, v54
v_and_b32 v157, s64, v54
v_lshlrev_b32 v158, 16, v55
v_and_b32 v159, s64, v55
v_lshlrev_b32 v160, 16, v56
v_and_b32 v161, s64, v56
v_lshlrev_b32 v162, 16, v57
v_and_b32 v163, s64, v57
v_lshlrev_b32 v164, 16, v58
v_and_b32 v165, s64, v58
v_lshlrev_b32 v166, 16, v59
v_and_b32 v167, s64, v59
v_lshlrev_b32 v168, 16, v60
v_and_b32 v169, s64, v60
v_lshlrev_b32 v170, 16, v61
v_and_b32 v171, s64, v61
v_pk_add_f32 v[64:65], v[64:65], v[152:153]
v_pk_add_f32 v[66:67], v[66:67], v[154:155]
v_pk_add_f32 v[68:69], v[68:69], v[156:157]
v_pk_add_f32 v[70:71], v[70:71], v[158:159]
v_pk_add_f32 v[72:73], v[72:73], v[160:161]
v_pk_add_f32 v[74:75], v[74:75], v[162:163]
v_pk_add_f32 v[76:77], v[76:77], v[164:165]
v_pk_add_f32 v[78:79], v[78:79], v[166:167]
v_pk_add_f32 v[80:81], v[80:81], v[168:169]
v_pk_add_f32 v[82:83], v[82:83], v[170:171]
s_add_u32 s26, s75, 12
v_mov_b32 v63, s26
s_waitcnt vmcnt(4) lgkmcnt(0)
s_barrier
s_cmp_lg_u32 s23, 0
s_cbranch_scc1 slow_182
buffer_store_dword v63, v17, s[16:19], s27 offen
back_183:
s_add_u32 s73, s38, 262144
s_add_u32 s73, s73, s24
s_add_u32 s90, s16, s73
s_addc_u32 s91, s17, 0
s_mov_b32 m0, s38
s_mov_b32 s36, 0
s_add_u32 s26, s75, 12
poll_184:
global_load_dword v63, v16, s[16:17] sc1
s_add_u32 s36, s36, 1
s_cmp_gt_u32 s36, 0x200000
s_cbranch_scc1 k2_bail
s_waitcnt vmcnt(0)
v_subrev_u32 v63, s26, v63
v_cmp_lt_u32 vcc, 15, v63
s_cbranch_vccnz poll_184
global_load_lds_dwordx4 v2, s[90:91] offset:0 sc1
global_load_lds_dwordx4 v2, s[90:91] offset:1024 sc1
global_load_lds_dwordx4 v2, s[90:91] offset:2048 sc1
global_load_lds_dwordx4 v2, s[90:91] offset:3072 sc1
s_sub_u32 s90, s90, 16384
s_subb_u32 s91, s91, 0
s_add_u32 m0, m0, 16384
s_nop 0
global_load_lds_dwordx4 v2, s[90:91] offset:0 sc1
global_load_lds_dwordx4 v2, s[90:91] offset:1024 sc1
global_load_lds_dwordx4 v2, s[90:91] offset:2048 sc1
global_load_lds_dwordx4 v2, s[90:91] offset:3072 sc1
s_waitcnt vmcnt(4) lgkmcnt(0)
s_barrier
ds_read_b128 v[152:155], v3 offset:0
ds_read_b128 v[156:159], v3 offset:256
ds_read_b128 v[160:163], v3 offset:512
ds_read_b128 v[164:167], v3 offset:768
ds_read_b128 v[168:171], v4 offset:0
ds_read_b128 v[172:175], v4 offset:256
ds_read_b128 v[176:179], v4 offset:512
ds_read_b128 v[180:183], v4 offset:768
s_waitcnt lgkmcnt(4)
v_mfma_f32_16x16x32_bf16 v[104:107], a[208:211], v[152:155], v[64:67]
ds_read_b128 v[184:187], v5 offset:0
v_mfma_f32_16x16x32_bf16 v[108:111], a[208:211], v[156:159], v[68:71]
ds_read_b128 v[188:191], v5 offset:256
s_sub_u32 s90, s90, 16384
s_subb_u32 s91, s91, 0
s_add_u32 m0, m0, 16384
s_nop 0
global_load_lds_dwordx4 v2, s[90:91] offset:0 sc1
v_mfma_f32_16x16x32_bf16 v[112:115], a[208:211], v[160:163], v[72:75]
ds_read_b128 v[192:195], v5 offset:512
v_mfma_f32_16x16x32_bf16 v[116:119], a[208:211], v[164:167], v[76:79]
ds_read_b128 v[196:199], v5 offset:768
global_load_lds_dwordx4 v2, s[90:91] offset:1024 sc1
v_mfma_f32_16x16x32_bf16 v[120:123], a[212:215], v[152:155], 0
v_mfma_f32_16x16x32_bf16 v[124:127], a[212:215], v[156:159], 0
v_mfma_f32_16x16x32_bf16 v[128:131], a[212:215], v[160:163], 0
v_mfma_f32_16x16x32_bf16 v[132:135], a[212:215], v[164:167], 0
s_waitcnt lgkmcnt(4)
v_mfma_f32_16x16x32_bf16 v[104:107], a[216:219], v[168:171], v[104:107]
ds_read_b128 v[152:155], v6 offset:0
v_mfma_f32_16x16x32_bf16 v[108:111], a[216:219], v[172:175], v[108:111]
ds_read_b128 v[156:159], v6 offset:256
global_load_lds_dwordx4 v2, s[90:91] offset:2048 sc1
v_mfma_f32_16x16x32_bf16 v[112:115], a[216:219], v[176:179], v[112:115]
ds_read_b128 v[160:163], v6 offset:512
v_mfma_f32_16x16x32_bf16 v[116:119], a[216:219], v[180:183], v[116:119]
ds_read_b128 v[164:167], v6 offset:768
global_load_lds_dwordx4 v2, s[90:91] offset:3072 sc1
s_waitcnt vmcnt(4)
s_barrier
s_waitcnt lgkmcnt(4)
v_mfma_f32_16x16x32_bf16 v[104:107], a[220:223], v[184:187], v[104:107]
ds_read_b128 v[168:171], v3 offset:16384
v_mfma_f32_16x16x32_bf16 v[108:111], a[220:223], v[188:191], v[108:111]
ds_read_b128 v[172:175], v3 offset:16640
s_sub_u32 s90, s90, 16384
s_subb_u32 s91, s91, 0
s_add_u32 m0, m0, 16384
s_nop 0
global_load_lds_dwordx4 v2, s[90:91] offset:0 sc1
v_mfma_f32_16x16x32_bf16 v[112:115], a[220:223], v[192:195], v[112:115]
ds_read_b128 v[176:179], v3 offset:16896
v_mfma_f32_16x16x32_bf16 v[116:119], a[220:223], v[196:199], v[116:119]
ds_read_b128 v[180:183], v3 offset:17152
global_load_lds_dwordx4 v2, s[90:91] offset:1024 sc1
s_waitcnt lgkmcnt(4)
v_mfma_f32_16x16x32_bf16 v[104:107], a[224:227], v[152:155], v[104:107]
ds_read_b128 v[184:187], v4 offset:16384
v_mfma_f32_16x16x32_bf16 v[108:111], a[224:227], v[156:159], v[108:111]
ds_read_b128 v[188:191], v4 offset:16640
global_load_lds_dwordx4 v2, s[90:91] offset:2048 sc1
v_mfma_f32_16x16x32_bf16 v[112:115], a[224:227], v[160:163], v[112:115]
ds_read_b128 v[192:195], v4 offset:16896
v_mfma_f32_16x16x32_bf16 v[116:119], a[224:227], v[164:167], v[116:119]
ds_read_b128 v[196:199], v4 offset:17152
global_load_lds_dwordx4 v2, s[90:91] offset:3072 sc1
s_waitcnt lgkmcnt(4)
v_mfma_f32_16x16x32_bf16 v[104:107], a[228:231], v[168:171], v[104:107]
ds_read_b128 v[152:155], v5 offset:16384
v_mfma_f32_16x16x32_bf16 v[108:111], a[228:231], v[172:175], v[108:111]
ds_read_b128 v[156:159], v5 offset:16640
s_sub_u32 s90, s90, 16384
s_subb_u32 s91, s91, 0
s_add_u32 m0, m0, 16384
s_nop 0
global_load_lds_dwordx4 v2, s[90:91] offset:0 sc1
v_mfma_f32_16x16x32_bf16 v[112:115], a[228:231], v[176:179], v[112:115]
ds_read_b128 v[160:163], v5 offset:16896
v_mfma_f32_16x16x32_bf16 v[116:119], a[228:231], v[180:183], v[116:119]
ds_read_b128 v[164:167], v5 offset:17152
global_load_lds_dwordx4 v2, s[90:91] offset:1024 sc1
v_mfma_f32_16x16x32_bf16 v[120:123], a[232:235], v[168:171], v[120:123]
v_mfma_f32_16x16x32_bf16 v[124:127], a[232:235], v[172:175], v[124:127]
v_mfma_f32_16x16x32_bf16 v[128:131], a[232:235], v[176:179], v[128:131]
v_mfma_f32_16x16x32_bf16 v[132:135], a[232:235], v[180:183], v[132:135]
s_waitcnt lgkmcnt(4)
v_mfma_f32_16x16x32_bf16 v[104:107], a[236:239], v[184:187], v[104:107]
ds_read_b128 v[168:171], v6 offset:16384
v_mfma_f32_16x16x32_bf16 v[108:111], a[236:239], v[188:191], v[108:111]
ds_read_b128 v[172:175], v6 offset:16640
global_load_lds_dwordx4 v2, s[90:91] offset:2048 sc1
v_mfma_f32_16x16x32_bf16 v[112:115], a[236:239], v[192:195], v[112:115]
ds_read_b128 v[176:179], v6 offset:16896
v_mfma_f32_16x16x32_bf16 v[116:119], a[236:239], v[196:199], v[116:119]
ds_read_b128 v[180:183], v6 offset:17152
global_load_lds_dwordx4 v2, s[90:91] offset:3072 sc1
s_waitcnt vmcnt(8)
s_barrier
s_waitcnt lgkmcnt(4)
v_mfma_f32_16x16x32_bf16 v[104:107], a[240:243], v[152:155], v[104:107]
ds_read_b128 v[184:187], v3 offset:32768
v_mfma_f32_16x16x32_bf16 v[108:111], a[240:243], v[156:159], v[108:111]
ds_read_b128 v[188:191], v3 offset:33024
s_sub_u32 s90, s90, 16384
s_subb_u32 s91, s91, 0
s_mov_b32 m0, s38
s_nop 0
global_load_lds_dwordx4 v2, s[90:91] offset:0 sc1
v_mfma_f32_16x16x32_bf16 v[112:115], a[240:243], v[160:163], v[112:115]
ds_read_b128 v[192:195], v3 offset:33280
v_mfma_f32_16x16x32_bf16 v[116:119], a[240:243], v[164:167], v[116:119]
ds_read_b128 v[196:199], v3 offset:33536
global_load_lds_dwordx4 v2, s[90:91] offset:1024 sc1
s_waitcnt lgkmcnt(4)
v_mfma_f32_16x16x32_bf16 v[104:107], a[244:247], v[168:171], v[104:107]
ds_read_b128 v[152:155], v4 offset:32768
v_mfma_f32_16x16x32_bf16 v[108:111], a[244:247], v[172:175], v[108:111]
ds_read_b128 v[156:159], v4 offset:33024
global_load_lds_dwordx4 v2, s[90:91] offset:2048 sc1
v_mfma_f32_16x16x32_bf16 v[112:115], a[244:247], v[176:179], v[112:115]
ds_read_b128 v[160:163], v4 offset:33280
v_mfma_f32_16x16x32_bf16 v[116:119], a[244:247], v[180:183], v[116:119]
ds_read_b128 v[164:167], v4 offset:33536
global_load_lds_dwordx4 v2, s[90:91] offset:3072 sc1
s_waitcnt lgkmcnt(4)
v_mfma_f32_16x16x32_bf16 v[104:107], a[248:251], v[184:187], v[104:107]
ds_read_b128 v[168:171], v5 offset:32768
v_mfma_f32_16x16x32_bf16 v[108:111], a[248:251], v[188:191], v[108:111]
ds_read_b128 v[172:175], v5 offset:33024
v_mfma_f32_16x16x32_bf16 v[112:115], a[248:251], v[192:195], v[112:115]
ds_read_b128 v[176:179], v5 offset:33280
v_mfma_f32_16x16x32_bf16 v[116:119], a[248:251], v[196:199], v[116:119]
ds_read_b128 v[180:183], v5 offset:33536
v_mfma_f32_16x16x32_bf16 v[120:123], a[252:255], v[184:187], v[120:123]
v_mfma_f32_16x16x32_bf16 v[124:127], a[252:255], v[188:191], v[124:127]
v_mfma_f32_16x16x32_bf16 v[128:131], a[252:255], v[192:195], v[128:131]
v_mfma_f32_16x16x32_bf16 v[132:135], a[252:255], v[196:199], v[132:135]
s_waitcnt lgkmcnt(4)
v_mfma_f32_16x16x32_bf16 v[104:107], v[224:227], v[152:155], v[104:107]
ds_read_b128 v[184:187], v6 offset:32768
v_mfma_f32_16x16x32_bf16 v[108:111], v[224:227], v[156:159], v[108:111]
ds_read_b128 v[188:191], v6 offset:33024
v_mfma_f32_16x16x32_bf16 v[112:115], v[224:227], v[160:163], v[112:115]
ds_read_b128 v[192:195], v6 offset:33280
v_mfma_f32_16x16x32_bf16 v[116:119], v[224:227], v[164:167], v[116:119]
ds_read_b128 v[196:199], v6 offset:33536
s_waitcnt vmcnt(8)
s_barrier
s_waitcnt lgkmcnt(4)
v_mfma_f32_16x16x32_bf16 v[104:107], v[228:231], v[168:171], v[104:107]
ds_read_b128 v[152:155], v3 offset:49152
v_mfma_f32_16x16x32_bf16 v[108:111], v[228:231], v[172:175], v[108:111]
ds_read_b128 v[156:159], v3 offset:49408
s_sub_u32 s90, s90, 16384
s_subb_u32 s91, s91, 0
s_add_u32 m0, m0, 16384
s_nop 0
global_load_lds_dwordx4 v2, s[90:91] offset:0 sc1
v_mfma_f32_16x16x32_bf16 v[112:115], v[228:231], v[176:179], v[112:115]
ds_read_b128 v[160:163], v3 offset:49664
v_mfma_f32_16x16x32_bf16 v[116:119], v[228:231], v[180:183], v[116:119]
ds_read_b128 v[164:167], v3 offset:49920
s_waitcnt lgkmcnt(4)
v_mfma_f32_16x16x32_bf16 v[104:107], v[232:235], v[184:187], v[104:107]
ds_read_b128 v[168:171], v4 offset:49152
v_mfma_f32_16x16x32_bf16 v[108:111], v[232:235], v[188:191], v[108:111]
ds_read_b128 v[172:175], v4 offset:49408
global_load_lds_dwordx4 v2, s[90:91] offset:1024 sc1
v_mfma_f32_16x16x32_bf16 v[112:115], v[232:235], v[192:195], v[112:115]
ds_read_b128 v[176:179], v4 offset:49664
v_mfma_f32_16x16x32_bf16 v[116:119], v[232:235], v[196:199], v[116:119]
ds_read_b128 v[180:183], v4 offset:49920
s_waitcnt lgkmcnt(4)
v_mfma_f32_16x16x32_bf16 v[104:107], v[236:239], v[152:155], v[104:107]
ds_read_b128 v[184:187], v5 offset:49152
v_mfma_f32_16x16x32_bf16 v[108:111], v[236:239], v[156:159], v[108:111]
ds_read_b128 v[188:191], v5 offset:49408
global_load_lds_dwordx4 v2, s[90:91] offset:2048 sc1
v_mfma_f32_16x16x32_bf16 v[112:115], v[236:239], v[160:163], v[112:115]
ds_read_b128 v[192:195], v5 offset:49664
v_mfma_f32_16x16x32_bf16 v[116:119], v[236:239], v[164:167], v[116:119]
ds_read_b128 v[196:199], v5 offset:49920
v_mfma_f32_16x16x32_bf16 v[120:123], v[240:243], v[152:155], v[120:123]
v_mfma_f32_16x16x32_bf16 v[124:127], v[240:243], v[156:159], v[124:127]
v_mfma_f32_16x16x32_bf16 v[128:131], v[240:243], v[160:163], v[128:131]
v_mfma_f32_16x16x32_bf16 v[132:135], v[240:243], v[164:167], v[132:135]
s_waitcnt lgkmcnt(4)
v_mfma_f32_16x16x32_bf16 v[104:107], v[244:247], v[168:171], v[104:107]
ds_read_b128 v[152:155], v6 offset:49152
v_mfma_f32_16x16x32_bf16 v[108:111], v[244:247], v[172:175], v[108:111]
ds_read_b128 v[156:159], v6 offset:49408
global_load_lds_dwordx4 v2, s[90:91] offset:3072 sc1
v_mfma_f32_16x16x32_bf16 v[112:115], v[244:247], v[176:179], v[112:115]
ds_read_b128 v[160:163], v6 offset:49664
v_mfma_f32_16x16x32_bf16 v[116:119], v[244:247], v[180:183], v[116:119]
ds_read_b128 v[164:167], v6 offset:49920
s_waitcnt vmcnt(8)
s_barrier
s_waitcnt lgkmcnt(4)
v_mfma_f32_16x16x32_bf16 v[104:107], v[248:251], v[184:187], v[104:107]
ds_read_b128 v[168:171], v7 offset:0
v_mfma_f32_16x16x32_bf16 v[108:111], v[248:251], v[188:191], v[108:111]
ds_read_b128 v[172:175], v7 offset:256
s_sub_u32 s90, s90, 16384
s_subb_u32 s91, s91, 0
s_add_u32 m0, m0, 16384
s_nop 0
global_load_lds_dwordx4 v2, s[90:91] offset:0 sc1
v_mfma_f32_16x16x32_bf16 v[112:115], v[248:251], v[192:195], v[112:115]
ds_read_b128 v[176:179], v7 offset:512
v_mfma_f32_16x16x32_bf16 v[116:119], v[248:251], v[196:199], v[116:119]
ds_read_b128 v[180:183], v7 offset:768
s_waitcnt lgkmcnt(4)
v_mfma_f32_16x16x32_bf16 v[104:107], v[252:255], v[152:155], v[104:107]
ds_read_b128 v[184:187], v8 offset:0
v_mfma_f32_16x16x32_bf16 v[108:111], v[252:255], v[156:159], v[108:111]
ds_read_b128 v[188:191], v8 offset:256
global_load_lds_dwordx4 v2, s[90:91] offset:1024 sc1
v_mfma_f32_16x16x32_bf16 v[112:115], v[252:255], v[160:163], v[112:115]
ds_read_b128 v[192:195], v8 offset:512
v_mfma_f32_16x16x32_bf16 v[116:119], v[252:255], v[164:167], v[116:119]
ds_read_b128 v[196:199], v8 offset:768
s_waitcnt lgkmcnt(4)
v_mfma_f32_16x16x32_bf16 v[104:107], a[128:131], v[168:171], v[104:107]
ds_read_b128 v[152:155], v9 offset:0
v_mfma_f32_16x16x32_bf16 v[108:111], a[128:131], v[172:175], v[108:111]
ds_read_b128 v[156:159], v9 offset:256
global_load_lds_dwordx4 v2, s[90:91] offset:2048 sc1
v_mfma_f32_16x16x32_bf16 v[112:115], a[128:131], v[176:179], v[112:115]
ds_read_b128 v[160:163], v9 offset:512
v_mfma_f32_16x16x32_bf16 v[116:119], a[128:131], v[180:183], v[116:119]
ds_read_b128 v[164:167], v9 offset:768
v_mfma_f32_16x16x32_bf16 v[120:123], a[132:135], v[168:171], v[120:123]
v_mfma_f32_16x16x32_bf16 v[124:127], a[132:135], v[172:175], v[124:127]
v_mfma_f32_16x16x32_bf16 v[128:131], a[132:135], v[176:179], v[128:131]
v_mfma_f32_16x16x32_bf16 v[132:135], a[132:135], v[180:183], v[132:135]
s_waitcnt lgkmcnt(4)
v_mfma_f32_16x16x32_bf16 v[104:107], a[136:139], v[184:187], v[104:107]
ds_read_b128 v[168:171], v10 offset:0
v_mfma_f32_16x16x32_bf16 v[108:111], a[136:139], v[188:191], v[108:111]
ds_read_b128 v[172:175], v10 offset:256
global_load_lds_dwordx4 v2, s[90:91] offset:3072 sc1
v_mfma_f32_16x16x32_bf16 v[112:115], a[136:139], v[192:195], v[112:115]
ds_read_b128 v[176:179], v10 offset:512
v_mfma_f32_16x16x32_bf16 v[116:119], a[136:139], v[196:199], v[116:119]
ds_read_b128 v[180:183], v10 offset:768
s_waitcnt vmcnt(8)
s_barrier
s_waitcnt lgkmcnt(4)
v_mfma_f32_16x16x32_bf16 v[104:107], a[140:143], v[152:155], v[104:107]
ds_read_b128 v[184:187], v3 offset:0
v_mfma_f32_16x16x32_bf16 v[108:111], a[140:143], v[156:159], v[108:111]
ds_read_b128 v[188:191], v3 offset:256
s_sub_u32 s90, s90, 16384
s_subb_u32 s91, s91, 0
s_add_u32 m0, m0, 16384
s_nop 0
global_load_lds_dwordx4 v2, s[90:91] offset:0 sc1
v_mfma_f32_16x16x32_bf16 v[112:115], a[140:143], v[160:163], v[112:115]
ds_read_b128 v[192:195], v3 offset:512
v_mfma_f32_16x16x32_bf16 v[116:119], a[140:143], v[164:167], v[116:119]
ds_read_b128 v[196:199], v3 offset:768
s_waitcnt lgkmcnt(4)
v_mfma_f32_16x16x32_bf16 v[104:107], a[144:147], v[168:171], v[104:107]
ds_read_b128 v[152:155], v4 offset:0
global_load_dwordx4 a[180:183], v2, s[92:93] offset:2048
v_mfma_f32_16x16x32_bf16 v[108:111], a[144:147], v[172:175], v[108:111]
ds_read_b128 v[156:159], v4 offset:256
global_load_lds_dwordx4 v2, s[90:91] offset:1024 sc1
v_mfma_f32_16x16x32_bf16 v[112:115], a[144:147], v[176:179], v[112:115]
ds_read_b128 v[160:163], v4 offset:512
v_mfma_f32_16x16x32_bf16 v[116:119], a[144:147], v[180:183], v[116:119]
ds_read_b128 v[164:167], v4 offset:768
s_waitcnt lgkmcnt(4)
v_mfma_f32_16x16x32_bf16 v[104:107], a[148:151], v[184:187], v[104:107]
ds_read_b128 v[168:171], v5 offset:0
global_load_dwordx4 a[184:187], v2, s[92:93] offset:3072
v_mfma_f32_16x16x32_bf16 v[108:111], a[148:151], v[188:191], v[108:111]
ds_read_b128 v[172:175], v5 offset:256
global_load_lds_dwordx4 v2, s[90:91] offset:2048 sc1
v_mfma_f32_16x16x32_bf16 v[112:115], a[148:151], v[192:195], v[112:115]
ds_read_b128 v[176:179], v5 offset:512
v_mfma_f32_16x16x32_bf16 v[116:119], a[148:151], v[196:199], v[116:119]
ds_read_b128 v[180:183], v5 offset:768
v_mfma_f32_16x16x32_bf16 v[120:123], a[152:155], v[184:187], v[120:123]
v_mfma_f32_16x16x32_bf16 v[124:127], a[152:155], v[188:191], v[124:127]
v_mfma_f32_16x16x32_bf16 v[128:131], a[152:155], v[192:195], v[128:131]
v_mfma_f32_16x16x32_bf16 v[132:135], a[152:155], v[196:199], v[132:135]
s_waitcnt lgkmcnt(4)
v_mfma_f32_16x16x32_bf16 v[104:107], a[156:159], v[152:155], v[104:107]
ds_read_b128 v[184:187], v6 offset:0
s_sub_u32 s92, s92, 8192
s_subb_u32 s93, s93, 0
global_load_dwordx4 a[188:191], v2, s[92:93] offset:2048
v_mfma_f32_16x16x32_bf16 v[108:111], a[156:159], v[156:159], v[108:111]
ds_read_b128 v[188:191], v6 offset:256
global_load_lds_dwordx4 v2, s[90:91] offset:3072 sc1
v_mfma_f32_16x16x32_bf16 v[112:115], a[156:159], v[160:163], v[112:115]
ds_read_b128 v[192:195], v6 offset:512
global_load_dwordx4 a[192:195], v2, s[92:93] offset:3072
v_mfma_f32_16x16x32_bf16 v[116:119], a[156:159], v[164:167], v[116:119]
ds_read_b128 v[196:199], v6 offset:768
s_waitcnt vmcnt(12)
s_barrier
s_waitcnt lgkmcnt(4)
v_mfma_f32_16x16x32_bf16 v[104:107], a[160:163], v[168:171], v[104:107]
ds_read_b128 v[152:155], v3 offset:16384
s_add_u32 s92, s92, 4096
s_addc_u32 s93, s93, 0
global_load_dwordx4 a[196:199], v2, s[92:93] offset:0
v_mfma_f32_16x16x32_bf16 v[108:111], a[160:163], v[172:175], v[108:111]
ds_read_b128 v[156:159], v3 offset:16640
s_sub_u32 s90, s90, 16384
s_subb_u32 s91, s91, 0
s_add_u32 m0, m0, 16384
s_nop 0
global_load_lds_dwordx4 v2, s[90:91] offset:0 sc1
v_mfma_f32_16x16x32_bf16 v[112:115], a[160:163], v[176:179], v[112:115]
ds_read_b128 v[160:163], v3 offset:16896
v_mfma_f32_16x16x32_bf16 v[116:119], a[160:163], v[180:183], v[116:119]
ds_read_b128 v[164:167], v3 offset:17152
s_waitcnt lgkmcnt(4)
v_mfma_f32_16x16x32_bf16 v[104:107], a[164:167], v[184:187], v[104:107]
ds_read_b128 v[168:171], v4 offset:16384
global_load_dwordx4 a[200:203], v2, s[92:93] offset:1024
v_mfma_f32_16x16x32_bf16 v[108:111], a[164:167], v[188:191], v[108:111]
ds_read_b128 v[172:175], v4 offset:16640
global_load_lds_dwordx4 v2, s[90:91] offset:1024 sc1
v_mfma_f32_16x16x32_bf16 v[112:115], a[164:167], v[192:195], v[112:115]
ds_read_b128 v[176:179], v4 offset:16896
v_mfma_f32_16x16x32_bf16 v[116:119], a[164:167], v[196:199], v[116:119]
ds_read_b128 v[180:183], v4 offset:17152
s_waitcnt lgkmcnt(4)
v_mfma_f32_16x16x32_bf16 v[104:107], a[168:171], v[152:155], v[104:107]
ds_read_b128 v[184:187], v5 offset:16384
global_load_dwordx4 a[204:207], v2, s[92:93] offset:2048
v_mfma_f32_16x16x32_bf16 v[108:111], a[168:171], v[156:159], v[108:111]
ds_read_b128 v[188:191], v5 offset:16640
global_load_lds_dwordx4 v2, s[90:91] offset:2048 sc1
v_mfma_f32_16x16x32_bf16 v[112:115], a[168:171], v[160:163], v[112:115]
ds_read_b128 v[192:195], v5 offset:16896
v_mfma_f32_16x16x32_bf16 v[116:119], a[168:171], v[164:167], v[116:119]
ds_read_b128 v[196:199], v5 offset:17152
v_mfma_f32_16x16x32_bf16 v[120:123], a[172:175], v[152:155], v[120:123]
v_mfma_f32_16x16x32_bf16 v[124:127], a[172:175], v[156:159], v[124:127]
v_mfma_f32_16x16x32_bf16 v[128:131], a[172:175], v[160:163], v[128:131]
v_mfma_f32_16x16x32_bf16 v[132:135], a[172:175], v[164:167], v[132:135]
s_waitcnt lgkmcnt(4)
v_mfma_f32_16x16x32_bf16 v[104:107], a[176:179], v[168:171], v[104:107]
ds_read_b128 v[152:155], v6 offset:16384
s_sub_u32 s92, s92, 8192
s_subb_u32 s93, s93, 0
global_load_dwordx4 a[208:211], v2, s[92:93] offset:1024
v_mfma_f32_16x16x32_bf16 v[108:111], a[176:179], v[172:175], v[108:111]
ds_read_b128 v[156:159], v6 offset:16640
global_load_lds_dwordx4 v2, s[90:91] offset:3072 sc1
v_mfma_f32_16x16x32_bf16 v[112:115], a[176:179], v[176:179], v[112:115]
ds_read_b128 v[160:163], v6 offset:16896
global_load_dwordx4 a[212:215], v2, s[92:93] offset:2048
v_mfma_f32_16x16x32_bf16 v[116:119], a[176:179], v[180:183], v[116:119]
ds_read_b128 v[164:167], v6 offset:17152
s_waitcnt vmcnt(17)
s_barrier
s_waitcnt vmcnt(15) lgkmcnt(4)
v_mfma_f32_16x16x32_bf16 v[104:107], a[180:183], v[184:187], v[104:107]
ds_read_b128 v[168:171], v3 offset:32768
global_load_dwordx4 a[216:219], v2, s[92:93] offset:3072
v_mfma_f32_16x16x32_bf16 v[108:111], a[180:183], v[188:191], v[108:111]
ds_read_b128 v[172:175], v3 offset:33024
s_sub_u32 s90, s90, 16384
s_subb_u32 s91, s91, 0
s_mov_b32 m0, s38
s_nop 0
global_load_lds_dwordx4 v2, s[90:91] offset:0 sc1
v_mfma_f32_16x16x32_bf16 v[112:115], a[180:183], v[192:195], v[112:115]
ds_read_b128 v[176:179], v3 offset:33280
v_mfma_f32_16x16x32_bf16 v[116:119], a[180:183], v[196:199], v[116:119]
ds_read_b128 v[180:183], v3 offset:33536
s_waitcnt vmcnt(15) lgkmcnt(4)
v_mfma_f32_16x16x32_bf16 v[104:107], a[184:187], v[152:155], v[104:107]
ds_read_b128 v[184:187], v4 offset:32768
s_add_u32 s92, s92, 4096
s_addc_u32 s93, s93, 0
global_load_dwordx4 a[220:223], v2, s[92:93] offset:0
v_mfma_f32_16x16x32_bf16 v[108:111], a[184:187], v[156:159], v[108:111]
ds_read_b128 v[188:191], v4 offset:33024
global_load_lds_dwordx4 v2, s[90:91] offset:1024 sc1
v_mfma_f32_16x16x32_bf16 v[112:115], a[184:187], v[160:163], v[112:115]
ds_read_b128 v[192:195], v4 offset:33280
v_mfma_f32_16x16x32_bf16 v[116:119], a[184:187], v[164:167], v[116:119]
ds_read_b128 v[196:199], v4 offset:33536
s_waitcnt vmcnt(15) lgkmcnt(4)
v_mfma_f32_16x16x32_bf16 v[104:107], a[188:191], v[168:171], v[104:107]
ds_read_b128 v[152:155], v5 offset:32768
global_load_dwordx4 a[224:227], v2, s[92:93] offset:1024
v_mfma_f32_16x16x32_bf16 v[108:111], a[188:191], v[172:175], v[108:111]
ds_read_b128 v[156:159], v5 offset:33024
global_load_lds_dwordx4 v2, s[90:91] offset:2048 sc1
v_mfma_f32_16x16x32_bf16 v[112:115], a[188:191], v[176:179], v[112:115]
ds_read_b128 v[160:163], v5 offset:33280
v_mfma_f32_16x16x32_bf16 v[116:119], a[188:191], v[180:183], v[116:119]
ds_read_b128 v[164:167], v5 offset:33536
s_waitcnt vmcnt(15)
v_mfma_f32_16x16x32_bf16 v[120:123], a[192:195], v[168:171], v[120:123]
v_mfma_f32_16x16x32_bf16 v[124:127], a[192:195], v[172:175], v[124:127]
v_mfma_f32_16x16x32_bf16 v[128:131], a[192:195], v[176:179], v[128:131]
v_mfma_f32_16x16x32_bf16 v[132:135], a[192:195], v[180:183], v[132:135]
s_waitcnt vmcnt(14) lgkmcnt(4)
v_mfma_f32_16x16x32_bf16 v[104:107], a[196:199], v[184:187], v[104:107]
ds_read_b128 v[168:171], v6 offset:32768
s_sub_u32 s92, s92, 8192
s_subb_u32 s93, s93, 0
global_load_dwordx4 a[228:231], v2, s[92:93] offset:0
v_mfma_f32_16x16x32_bf16 v[108:111], a[196:199], v[188:191], v[108:111]
ds_read_b128 v[172:175], v6 offset:33024
global_load_lds_dwordx4 v2, s[90:91] offset:3072 sc1
v_mfma_f32_16x16x32_bf16 v[112:115], a[196:199], v[192:195], v[112:115]
ds_read_b128 v[176:179], v6 offset:33280
global_load_dwordx4 a[232:235], v2, s[92:93] offset:1024
v_mfma_f32_16x16x32_bf16 v[116:119], a[196:199], v[196:199], v[116:119]
ds_read_b128 v[180:183], v6 offset:33536
s_barrier
s_waitcnt vmcnt(15) lgkmcnt(4)
v_mfma_f32_16x16x32_bf16 v[104:107], a[200:203], v[152:155], v[104:107]
ds_read_b128 v[184:187], v3 offset:49152
global_load_dwordx4 a[236:239], v2, s[92:93] offset:2048
v_mfma_f32_16x16x32_bf16 v[108:111], a[200:203], v[156:159], v[108:111]
ds_read_b128 v[188:191], v3 offset:49408
s_sub_u32 s90, s90, 16384
s_subb_u32 s91, s91, 0
s_add_u32 m0, m0, 16384
s_nop 0
global_load_lds_dwordx4 v2, s[90:91] offset:0 sc1
v_mfma_f32_16x16x32_bf16 v[112:115], a[200:203], v[160:163], v[112:115]
ds_read_b128 v[192:195], v3 offset:49664
global_load_dwordx4 a[240:243], v2, s[92:93] offset:3072
v_mfma_f32_16x16x32_bf16 v[116:119], a[200:203], v[164:167], v[116:119]
ds_read_b128 v[196:199], v3 offset:49920
s_waitcnt vmcnt(16) lgkmcnt(4)
v_mfma_f32_16x16x32_bf16 v[104:107], a[204:207], v[168:171], v[104:107]
ds_read_b128 v[152:155], v4 offset:49152
s_add_u32 s92, s92, 4096
s_addc_u32 s93, s93, 0
global_load_dwordx4 a[244:247], v2, s[92:93] offset:0
v_mfma_f32_16x16x32_bf16 v[108:111], a[204:207], v[172:175], v[108:111]
ds_read_b128 v[156:159], v4 offset:49408
global_load_lds_dwordx4 v2, s[90:91] offset:1024 sc1
v_mfma_f32_16x16x32_bf16 v[112:115], a[204:207], v[176:179], v[112:115]
ds_read_b128 v[160:163], v4 offset:49664
v_mfma_f32_16x16x32_bf16 v[116:119], a[204:207], v[180:183], v[116:119]
ds_read_b128 v[164:167], v4 offset:49920
s_waitcnt vmcnt(16) lgkmcnt(4)
v_mfma_f32_16x16x32_bf16 v[104:107], a[208:211], v[184:187], v[104:107]
ds_read_b128 v[168:171], v5 offset:49152
s_sub_u32 s92, s92, 12288
s_subb_u32 s93, s93, 0
global_load_dwordx4 a[248:251], v2, s[92:93] offset:3072
v_mfma_f32_16x16x32_bf16 v[108:111], a[208:211], v[188:191], v[108:111]
ds_read_b128 v[172:175], v5 offset:49408
global_load_lds_dwordx4 v2, s[90:91] offset:2048 sc1
v_mfma_f32_16x16x32_bf16 v[112:115], a[208:211], v[192:195], v[112:115]
ds_read_b128 v[176:179], v5 offset:49664
v_mfma_f32_16x16x32_bf16 v[116:119], a[208:211], v[196:199], v[116:119]
ds_read_b128 v[180:183], v5 offset:49920
s_waitcnt vmcnt(16)
v_mfma_f32_16x16x32_bf16 v[120:123], a[212:215], v[184:187], v[120:123]
v_mfma_f32_16x16x32_bf16 v[124:127], a[212:215], v[188:191], v[124:127]
v_mfma_f32_16x16x32_bf16 v[128:131], a[212:215], v[192:195], v[128:131]
v_mfma_f32_16x16x32_bf16 v[132:135], a[212:215], v[196:199], v[132:135]
s_waitcnt vmcnt(15) lgkmcnt(4)
v_mfma_f32_16x16x32_bf16 v[104:107], a[216:219], v[152:155], v[104:107]
ds_read_b128 v[184:187], v6 offset:49152
s_add_u32 s92, s92, 4096
s_addc_u32 s93, s93, 0
global_load_dwordx4 a[252:255], v2, s[92:93] offset:0
v_mfma_f32_16x16x32_bf16 v[108:111], a[216:219], v[156:159], v[108:111]
ds_read_b128 v[188:191], v6 offset:49408
global_load_lds_dwordx4 v2, s[90:91] offset:3072 sc1
v_mfma_f32_16x16x32_bf16 v[112:115], a[216:219], v[160:163], v[112:115]
ds_read_b128 v[192:195], v6 offset:49664
global_load_dwordx4 v[224:227], v2, s[92:93] offset:1024
v_mfma_f32_16x16x32_bf16 v[116:119], a[216:219], v[164:167], v[116:119]
ds_read_b128 v[196:199], v6 offset:49920
s_barrier
s_waitcnt vmcnt(16) lgkmcnt(4)
v_mfma_f32_16x16x32_bf16 v[104:107], a[220:223], v[168:171], v[104:107]
ds_read_b128 v[152:155], v7 offset:0
global_load_dwordx4 v[228:231], v2, s[92:93] offset:2048
v_mfma_f32_16x16x32_bf16 v[108:111], a[220:223], v[172:175], v[108:111]
ds_read_b128 v[156:159], v7 offset:256
v_mfma_f32_16x16x32_bf16 v[112:115], a[220:223], v[176:179], v[112:115]
ds_read_b128 v[160:163], v7 offset:512
v_mfma_f32_16x16x32_bf16 v[116:119], a[220:223], v[180:183], v[116:119]
ds_read_b128 v[164:167], v7 offset:768
s_waitcnt vmcnt(15) lgkmcnt(4)
v_mfma_f32_16x16x32_bf16 v[104:107], a[224:227], v[184:187], v[104:107]
ds_read_b128 v[168:171], v8 offset:0
global_load_dwordx4 v[232:235], v2, s[92:93] offset:3072
v_mfma_f32_16x16x32_bf16 v[108:111], a[224:227], v[188:191], v[108:111]
ds_read_b128 v[172:175], v8 offset:256
v_mfma_f32_16x16x32_bf16 v[112:115], a[224:227], v[192:195], v[112:115]
ds_read_b128 v[176:179], v8 offset:512
v_mfma_f32_16x16x32_bf16 v[116:119], a[224:227], v[196:199], v[116:119]
ds_read_b128 v[180:183], v8 offset:768
s_waitcnt vmcnt(14) lgkmcnt(4)
v_mfma_f32_16x16x32_bf16 v[104:107], a[228:231], v[152:155], v[104:107]
ds_read_b128 v[184:187], v9 offset:0
s_sub_u32 s92, s92, 8192
s_subb_u32 s93, s93, 0
global_load_dwordx4 v[236:239], v2, s[92:93] offset:2048
v_mfma_f32_16x16x32_bf16 v[108:111], a[228:231], v[156:159], v[108:111]
ds_read_b128 v[188:191], v9 offset:256
v_mfma_f32_16x16x32_bf16 v[112:115], a[228:231], v[160:163], v[112:115]
ds_read_b128 v[192:195], v9 offset:512
v_mfma_f32_16x16x32_bf16 v[116:119], a[228:231], v[164:167], v[116:119]
ds_read_b128 v[196:199], v9 offset:768
s_waitcnt vmcnt(13)
v_mfma_f32_16x16x32_bf16 v[120:123], a[232:235], v[152:155], v[120:123]
v_mfma_f32_16x16x32_bf16 v[124:127], a[232:235], v[156:159], v[124:127]
v_mfma_f32_16x16x32_bf16 v[128:131], a[232:235], v[160:163], v[128:131]
v_mfma_f32_16x16x32_bf16 v[132:135], a[232:235], v[164:167], v[132:135]
s_waitcnt vmcnt(12) lgkmcnt(4)
v_mfma_f32_16x16x32_bf16 v[104:107], a[236:239], v[168:171], v[104:107]
ds_read_b128 v[152:155], v10 offset:0
global_load_dwordx4 v[240:243], v2, s[92:93] offset:3072
v_mfma_f32_16x16x32_bf16 v[108:111], a[236:239], v[172:175], v[108:111]
ds_read_b128 v[156:159], v10 offset:256
s_add_u32 s92, s92, 4096
s_addc_u32 s93, s93, 0
global_load_dwordx4 v[244:247], v2, s[92:93] offset:0
v_mfma_f32_16x16x32_bf16 v[112:115], a[236:239], v[176:179], v[112:115]
ds_read_b128 v[160:163], v10 offset:512
v_mfma_f32_16x16x32_bf16 v[116:119], a[236:239], v[180:183], v[116:119]
ds_read_b128 v[164:167], v10 offset:768
s_barrier
s_waitcnt vmcnt(12) lgkmcnt(4)
v_mfma_f32_16x16x32_bf16 v[104:107], a[240:243], v[184:187], v[104:107]
ds_read_b128 v[168:171], v3 offset:0
global_load_dwordx4 v[248:251], v2, s[92:93] offset:1024
v_mfma_f32_16x16x32_bf16 v[108:111], a[240:243], v[188:191], v[108:111]
ds_read_b128 v[172:175], v3 offset:256
v_mfma_f32_16x16x32_bf16 v[112:115], a[240:243], v[192:195], v[112:115]
ds_read_b128 v[176:179], v3 offset:512
v_mfma_f32_16x16x32_bf16 v[116:119], a[240:243], v[196:199], v[116:119]
ds_read_b128 v[180:183], v3 offset:768
s_waitcnt vmcnt(12) lgkmcnt(4)
v_mfma_f32_16x16x32_bf16 v[104:107], a[244:247], v[152:155], v[104:107]
ds_read_b128 v[184:187], v4 offset:0
global_load_dwordx4 v[252:255], v2, s[92:93] offset:2048
v_mfma_f32_16x16x32_bf16 v[108:111], a[244:247], v[156:159], v[108:111]
ds_read_b128 v[188:191], v4 offset:256
v_mfma_f32_16x16x32_bf16 v[112:115], a[244:247], v[160:163], v[112:115]
ds_read_b128 v[192:195], v4 offset:512
v_mfma_f32_16x16x32_bf16 v[116:119], a[244:247], v[164:167], v[116:119]
ds_read_b128 v[196:199], v4 offset:768
s_waitcnt vmcnt(11) lgkmcnt(4)
v_mfma_f32_16x16x32_bf16 v[104:107], a[248:251], v[168:171], v[104:107]
ds_read_b128 v[152:155], v5 offset:0
v_mfma_f32_16x16x32_bf16 v[108:111], a[248:251], v[172:175], v[108:111]
ds_read_b128 v[156:159], v5 offset:256
v_mfma_f32_16x16x32_bf16 v[112:115], a[248:251], v[176:179], v[112:115]
ds_read_b128 v[160:163], v5 offset:512
v_mfma_f32_16x16x32_bf16 v[116:119], a[248:251], v[180:183], v[116:119]
ds_read_b128 v[164:167], v5 offset:768
s_waitcnt vmcnt(9)
v_mfma_f32_16x16x32_bf16 v[120:123], a[252:255], v[168:171], v[120:123]
v_mfma_f32_16x16x32_bf16 v[124:127], a[252:255], v[172:175], v[124:127]
v_mfma_f32_16x16x32_bf16 v[128:131], a[252:255], v[176:179], v[128:131]
v_mfma_f32_16x16x32_bf16 v[132:135], a[252:255], v[180:183], v[132:135]
s_waitcnt vmcnt(7) lgkmcnt(4)
v_mfma_f32_16x16x32_bf16 v[104:107], v[224:227], v[184:187], v[104:107]
ds_read_b128 v[168:171], v6 offset:0
v_mfma_f32_16x16x32_bf16 v[108:111], v[224:227], v[188:191], v[108:111]
ds_read_b128 v[172:175], v6 offset:256
v_mfma_f32_16x16x32_bf16 v[112:115], v[224:227], v[192:195], v[112:115]
ds_read_b128 v[176:179], v6 offset:512
v_mfma_f32_16x16x32_bf16 v[116:119], v[224:227], v[196:199], v[116:119]
ds_read_b128 v[180:183], v6 offset:768
s_barrier
s_waitcnt vmcnt(6) lgkmcnt(4)
v_mfma_f32_16x16x32_bf16 v[104:107], v[228:231], v[152:155], v[104:107]
ds_read_b128 v[184:187], v3 offset:16384
v_mfma_f32_16x16x32_bf16 v[108:111], v[228:231], v[156:159], v[108:111]
ds_read_b128 v[188:191], v3 offset:16640
v_mfma_f32_16x16x32_bf16 v[112:115], v[228:231], v[160:163], v[112:115]
ds_read_b128 v[192:195], v3 offset:16896
v_mfma_f32_16x16x32_bf16 v[116:119], v[228:231], v[164:167], v[116:119]
ds_read_b128 v[196:199], v3 offset:17152
s_waitcnt vmcnt(5) lgkmcnt(4)
v_mfma_f32_16x16x32_bf16 v[104:107], v[232:235], v[168:171], v[104:107]
ds_read_b128 v[152:155], v4 offset:16384
v_mfma_f32_16x16x32_bf16 v[108:111], v[232:235], v[172:175], v[108:111]
ds_read_b128 v[156:159], v4 offset:16640
v_mfma_f32_16x16x32_bf16 v[112:115], v[232:235], v[176:179], v[112:115]
ds_read_b128 v[160:163], v4 offset:16896
v_mfma_f32_16x16x32_bf16 v[116:119], v[232:235], v[180:183], v[116:119]
ds_read_b128 v[164:167], v4 offset:17152
s_waitcnt vmcnt(4) lgkmcnt(4)
v_mfma_f32_16x16x32_bf16 v[104:107], v[236:239], v[184:187], v[104:107]
ds_read_b128 v[168:171], v5 offset:16384
v_mfma_f32_16x16x32_bf16 v[108:111], v[236:239], v[188:191], v[108:111]
ds_read_b128 v[172:175], v5 offset:16640
v_mfma_f32_16x16x32_bf16 v[112:115], v[236:239], v[192:195], v[112:115]
ds_read_b128 v[176:179], v5 offset:16896
v_mfma_f32_16x16x32_bf16 v[116:119], v[236:239], v[196:199], v[116:119]
ds_read_b128 v[180:183], v5 offset:17152
s_waitcnt vmcnt(3)
v_mfma_f32_16x16x32_bf16 v[120:123], v[240:243], v[184:187], v[120:123]
v_mfma_f32_16x16x32_bf16 v[124:127], v[240:243], v[188:191], v[124:127]
v_mfma_f32_16x16x32_bf16 v[128:131], v[240:243], v[192:195], v[128:131]
v_mfma_f32_16x16x32_bf16 v[132:135], v[240:243], v[196:199], v[132:135]
s_waitcnt vmcnt(2) lgkmcnt(4)
v_mfma_f32_16x16x32_bf16 v[104:107], v[244:247], v[152:155], v[104:107]
ds_read_b128 v[184:187], v6 offset:16384
v_mfma_f32_16x16x32_bf16 v[108:111], v[244:247], v[156:159], v[108:111]
ds_read_b128 v[188:191], v6 offset:16640
v_mfma_f32_16x16x32_bf16 v[112:115], v[244:247], v[160:163], v[112:115]
ds_read_b128 v[192:195], v6 offset:16896
v_mfma_f32_16x16x32_bf16 v[116:119], v[244:247], v[164:167], v[116:119]
ds_read_b128 v[196:199], v6 offset:17152
s_waitcnt vmcnt(1) lgkmcnt(4)
v_mfma_f32_16x16x32_bf16 v[104:107], v[248:251], v[168:171], v[104:107]
ds_write_b128 v23, v[120:123] offset:0
ds_write_b128 v23, v[124:127] offset:1024
v_mfma_f32_16x16x32_bf16 v[108:111], v[248:251], v[172:175], v[108:111]
ds_write_b128 v23, v[128:131] offset:2048
ds_write_b128 v23, v[132:135] offset:3072
v_mfma_f32_16x16x32_bf16 v[112:115], v[248:251], v[176:179], v[112:115]
v_mfma_f32_16x16x32_bf16 v[116:119], v[248:251], v[180:183], v[116:119]
s_waitcnt vmcnt(0) lgkmcnt(4)
v_mfma_f32_16x16x32_bf16 v[104:107], v[252:255], v[184:187], v[104:107]
v_mfma_f32_16x16x32_bf16 v[108:111], v[252:255], v[188:191], v[108:111]
v_mfma_f32_16x16x32_bf16 v[112:115], v[252:255], v[192:195], v[112:115]
v_mfma_f32_16x16x32_bf16 v[116:119], v[252:255], v[196:199], v[116:119]
s_waitcnt lgkmcnt(0)
s_barrier
ds_read_b128 v[152:155], v24 offset:0
ds_read_b128 v[156:159], v24 offset:4096
ds_read_b128 v[160:163], v24 offset:8192
ds_read_b128 v[164:167], v24 offset:12288
v_cvt_pk_bf16_f32 v184, v104, v105
v_cvt_pk_bf16_f32 v185, v106, v107
buffer_store_dwordx2 v[184:185], v14, s[12:15], 0 offen
v_cvt_pk_bf16_f32 v186, v108, v109
v_cvt_pk_bf16_f32 v187, v110, v111
buffer_store_dwordx2 v[186:187], v14, s[12:15], s32 offen
v_cvt_pk_bf16_f32 v188, v112, v113
v_cvt_pk_bf16_f32 v189, v114, v115
buffer_store_dwordx2 v[188:189], v14, s[12:15], s33 offen
v_cvt_pk_bf16_f32 v190, v116, v117
v_cvt_pk_bf16_f32 v191, v118, v119
buffer_store_dwordx2 v[190:191], v14, s[12:15], s34 offen
s_waitcnt lgkmcnt(0)
v_pk_add_f32 v[152:153], v[152:153], v[156:157]
v_pk_add_f32 v[160:161], v[160:161], v[164:165]
v_pk_add_f32 v[154:155], v[154:155], v[158:159]
v_pk_add_f32 v[162:163], v[162:163], v[166:167]
v_pk_add_f32 v[152:153], v[152:153], v[80:81]
v_pk_add_f32 v[154:155], v[154:155], v[82:83]
v_pk_add_f32 v[120:121], v[152:153], v[160:161]
v_pk_add_f32 v[122:123], v[154:155], v[162:163]
v_cvt_pk_bf16_f32 v192, v120, v121
v_cvt_pk_bf16_f32 v193, v122, v123
buffer_store_dwordx2 v[192:193], v15, s[12:15], 0 offen
s_cmp_lg_u32 s2, 0
s_cbranch_scc1 nep_185
v_mov_b32 v52, 10887168
v_mov_b32 v53, s75
buffer_store_dword v53, v52, s[16:19], 0 offen
nep_185:
k2_exit:
s_endpgm
k2_bail:
s_endpgm
tp_2f:
s_lshl_b32 s85, s4, 9
s_add_u32 s85, s85, 12091392
s_cmp_lg_u32 s36, 48
s_cbranch_scc1 tp_2g
buffer_store_dwordx4 v[200:203], v219, s[16:19], s76 offen sc1
buffer_store_dwordx4 v[204:207], v219, s[16:19], s77 offen sc1
buffer_store_dwordx4 v[208:211], v219, s[16:19], s78 offen sc1
buffer_store_dwordx4 v[212:215], v219, s[16:19], s79 offen sc1
s_lshl_b32 s26, s5, 2
s_add_u32 s26, s26, s20
s_lshl_b32 s26, s26, 2
v_mov_b32 v50, s26
v_mov_b32 v51, s31
s_waitcnt vmcnt(0)
buffer_store_dword v51, v50, s[16:19], s85 offen sc1
tp_2g:
v_lshlrev_b32 v50, 3, v1
buffer_load_dwordx2 v[50:51], v50, s[16:19], s85 offen sc1
s_waitcnt vmcnt(0)
v_cmp_ne_u32 vcc, s31, v50
s_cbranch_vccnz tp_2
v_cmp_ne_u32 vcc, s31, v51
s_cbranch_vccnz tp_2
s_branch tp_3
slow_16:
buffer_store_dwordx4 v[160:163], v220, s[16:19], s74 offen sc1
s_branch back_17
slow_21:
buffer_store_dwordx4 v[160:163], v220, s[16:19], s74 offen sc1
s_branch back_22
retry_23:
s_mov_b32 s36, 0
retry_23_l:
global_load_dwordx4 v[184:187], v18, s[16:17] offset:0 sc1
global_load_dwordx4 v[188:191], v18, s[16:17] offset:1024 sc1
s_add_u32 s36, s36, 1
s_cmp_gt_u32 s36, 0x200000
s_cbranch_scc1 k2_bail
s_waitcnt vmcnt(0)
v_xor_b32 v192, v185, v187
v_xor_b32 v193, v189, v191
v_xor_b32 v194, s65, v185
v_xor_b32 v195, s65, v189
v_or3_b32 v192, v192, v193, v194
v_or_b32 v192, v192, v195
v_cmp_ne_u32 vcc, 0, v192
s_cbranch_vccnz retry_23_l
s_branch got_24
ypoll_25:
s_mov_b32 s36, 0
ypoll_25l:
buffer_load_dwordx4 v[152:155], v238, s[16:19], s80 offen sc1
buffer_load_dwordx4 v[156:159], v238, s[16:19], s81 offen sc1
buffer_load_dwordx4 v[160:163], v238, s[16:19], s82 offen sc1
buffer_load_dwordx4 v[164:167], v238, s[16:19], s83 offen sc1
buffer_load_dwordx4 v[168:171], v239, s[16:19], s84 offen sc1
s_add_u32 s36, s36, 1
s_cmp_gt_u32 s36, 0x200000
s_cbranch_scc1 k2_bail
s_waitcnt vmcnt(0)
v_xor_b32 v172, s87, v153
v_xor_b32 v173, s87, v155
v_xor_b32 v174, s87, v157
v_xor_b32 v175, s87, v159
v_xor_b32 v176, s87, v161
v_xor_b32 v177, s87, v163
v_xor_b32 v178, s87, v165
v_xor_b32 v179, s87, v167
v_xor_b32 v180, s87, v169
v_xor_b32 v181, s87, v171
v_or3_b32 v172, v172, v173, v174
v_or3_b32 v175, v175, v176, v177
v_or3_b32 v178, v178, v179, v180
v_or3_b32 v172, v172, v175, v178
v_or_b32 v172, v172, v181
v_cmp_ne_u32 vcc, 0, v172
s_cbranch_vccnz ypoll_25l
s_branch ypoll_25d
slow_26:
global_store_dwordx2 v11, v[42:43], s[16:17] offset:0 sc1
s_branch back_27
slow_28:
global_store_dwordx2 v11, v[44:45], s[16:17] offset:256 sc1
s_branch back_29
slow_30:
global_store_dwordx2 v11, v[46:47], s[16:17] offset:512 sc1
s_branch back_31
slow_32:
global_store_dwordx2 v11, v[48:49], s[16:17] offset:768 sc1
s_branch back_33
slow_34:
global_store_dwordx2 v12, v[50:51], s[16:17] offset:0 sc1
s_branch back_35
slow_36:
buffer_store_dwordx4 v[192:195], v220, s[16:19], s74 offen sc1
s_branch back_37
slow_38:
buffer_store_dword v63, v17, s[16:19], s27 offen sc1
s_branch back_39
retry_42:
s_mov_b32 s36, 0
retry_42_l:
global_load_dwordx4 v[184:187], v18, s[8:9] offset:0 sc1
global_load_dwordx4 v[188:191], v18, s[8:9] offset:1024 sc1
s_add_u32 s36, s36, 1
s_cmp_gt_u32 s36, 0x200000
s_cbranch_scc1 k2_bail
s_waitcnt vmcnt(0)
v_xor_b32 v192, v185, v187
v_xor_b32 v193, v189, v191
v_xor_b32 v194, s65, v185
v_xor_b32 v195, s65, v189
v_or3_b32 v192, v192, v193, v194
v_or_b32 v192, v192, v195
v_cmp_ne_u32 vcc, 0, v192
s_cbranch_vccnz retry_42_l
s_branch got_43
slow_44:
global_store_dwordx2 v11, v[136:137], s[82:83] offset:0 sc1
s_branch back_45
slow_46:
global_store_dwordx2 v11, v[142:143], s[82:83] offset:768 sc1
s_branch back_47
slow_48:
global_store_dwordx2 v12, v[144:145], s[82:83] offset:0 sc1
s_branch back_49
slow_50:
global_store_dwordx2 v11, v[138:139], s[82:83] offset:256 sc1
s_branch back_51
slow_52:
global_store_dwordx2 v11, v[140:141], s[82:83] offset:512 sc1
s_branch back_53
slow_54:
buffer_store_dword v63, v17, s[16:19], s27 offen sc1
s_branch back_55
hretry_57:
s_mov_b32 s36, 0
hretry_57_l:
buffer_load_dwordx4 v[184:187], v25, s[16:19], s72 offen sc1
buffer_load_dwordx4 v[188:191], v221, s[16:19], s72 offen sc1
s_add_u32 s36, s36, 1
s_cmp_gt_u32 s36, 0x200000
s_cbranch_scc1 k2_bail
s_waitcnt vmcnt(0)
v_xor_b32 v192, v185, v187
v_xor_b32 v193, s65, v185
v_or_b32 v192, v192, v193
v_xor_b32 v193, v189, v191
v_xor_b32 v194, s65, v189
v_or_b32 v193, v193, v194
v_cmp_ne_u32 vcc, 0, v192
v_cmp_ne_u32 s[98:99], 0, v193
s_and_b64 vcc, vcc, s[56:57]
s_and_b64 s[98:99], s[98:99], s[58:59]
s_or_b64 vcc, vcc, s[98:99]
s_cbranch_vccnz hretry_57_l
s_branch hgot_58
wlate_59:
s_mov_b32 s36, 0
wlate_59l:
buffer_load_dword v60, v31, s[16:19], s95 offen sc1
buffer_load_dword v61, v234, s[16:19], s95 offen sc1
s_add_u32 s36, s36, 1
s_cmp_gt_u32 s36, 0x200000
s_cbranch_scc1 k2_bail
s_waitcnt vmcnt(0)
v_subrev_u32 v60, s94, v60
v_subrev_u32 v61, s94, v61
v_or_b32 v60, v60, v61
v_cmp_lt_u32 vcc, 15, v60
s_cbranch_vccnz wlate_59l
s_branch wok_60
slow_61:
global_store_dwordx2 v11, v[52:53], s[16:17] offset:0 sc1
s_branch back_62
slow_63:
global_store_dwordx2 v11, v[54:55], s[16:17] offset:256 sc1
s_branch back_64
slow_65:
global_store_dwordx2 v11, v[56:57], s[16:17] offset:512 sc1
s_branch back_66
slow_67:
global_store_dwordx2 v11, v[58:59], s[16:17] offset:768 sc1
s_branch back_68
slow_69:
global_store_dwordx2 v12, v[60:61], s[16:17] offset:0 sc1
s_branch back_70
slow_71:
buffer_store_dwordx4 v[192:195], v220, s[16:19], s74 offen sc1
s_branch back_72
slow_73:
buffer_store_dword v63, v17, s[16:19], s27 offen sc1
s_branch back_74
retry_76:
s_mov_b32 s36, 0
retry_76_l:
global_load_dwordx4 v[184:187], v18, s[16:17] offset:0 sc1
global_load_dwordx4 v[188:191], v18, s[16:17] offset:1024 sc1
s_add_u32 s36, s36, 1
s_cmp_gt_u32 s36, 0x200000
s_cbranch_scc1 k2_bail
s_waitcnt vmcnt(0)
v_xor_b32 v192, v185, v187
v_xor_b32 v193, v189, v191
v_xor_b32 v194, s65, v185
v_xor_b32 v195, s65, v189
v_or3_b32 v192, v192, v193, v194
v_or_b32 v192, v192, v195
v_cmp_ne_u32 vcc, 0, v192
s_cbranch_vccnz retry_76_l
s_branch got_77
slow_78:
global_store_dwordx2 v13, v[176:177], s[16:17] offset:0 sc1
s_branch back_79
slow_80:
global_store_dwordx2 v13, v[178:179], s[16:17] offset:256 sc1
s_branch back_81
slow_82:
global_store_dwordx2 v13, v[180:181], s[16:17] offset:512 sc1
s_branch back_83
slow_84:
global_store_dwordx2 v13, v[182:183], s[16:17] offset:768 sc1
s_branch back_85
slow_86:
global_store_dwordx2 v13, v[184:185], s[84:85] offset:0 sc1
s_branch back_87
slow_88:
global_store_dwordx2 v13, v[186:187], s[84:85] offset:256 sc1
s_branch back_89
slow_90:
global_store_dwordx2 v13, v[188:189], s[84:85] offset:512 sc1
s_branch back_91
slow_92:
global_store_dwordx2 v13, v[190:191], s[84:85] offset:768 sc1
s_branch back_93
slow_94:
global_store_dwordx2 v13, v[192:193], s[10:11] offset:0 sc1
s_branch back_95
slow_96:
global_store_dwordx2 v13, v[194:195], s[10:11] offset:256 sc1
s_branch back_97
slow_98:
global_store_dwordx2 v13, v[196:197], s[10:11] offset:512 sc1
s_branch back_99
slow_100:
global_store_dwordx2 v13, v[198:199], s[10:11] offset:768 sc1
s_branch back_101
slow_102:
buffer_store_dword v63, v17, s[16:19], s27 offen sc1
s_branch back_103
slow_105:
buffer_store_dwordx4 v[192:195], v220, s[16:19], s74 offen sc1
s_branch back_106
retry_107:
s_mov_b32 s36, 0
retry_107_l:
global_load_dwordx4 v[184:187], v18, s[8:9] offset:0 sc1
global_load_dwordx4 v[188:191], v18, s[8:9] offset:1024 sc1
s_add_u32 s36, s36, 1
s_cmp_gt_u32 s36, 0x200000
s_cbranch_scc1 k2_bail
s_waitcnt vmcnt(0)
v_xor_b32 v192, v185, v187
v_xor_b32 v193, v189, v191
v_xor_b32 v194, s65, v185
v_xor_b32 v195, s65, v189
v_or3_b32 v192, v192, v193, v194
v_or_b32 v192, v192, v195
v_cmp_ne_u32 vcc, 0, v192
s_cbranch_vccnz retry_107_l
s_branch got_108
slow_109:
global_store_dwordx2 v11, v[42:43], s[16:17] offset:0 sc1
s_branch back_110
slow_111:
global_store_dwordx2 v11, v[44:45], s[16:17] offset:256 sc1
s_branch back_112
slow_113:
global_store_dwordx2 v11, v[46:47], s[16:17] offset:512 sc1
s_branch back_114
slow_115:
global_store_dwordx2 v11, v[48:49], s[16:17] offset:768 sc1
s_branch back_116
slow_117:
global_store_dwordx2 v12, v[50:51], s[16:17] offset:0 sc1
s_branch back_118
slow_119:
buffer_store_dwordx4 v[192:195], v220, s[16:19], s74 offen sc1
s_branch back_120
slow_121:
buffer_store_dword v63, v17, s[16:19], s27 offen sc1
s_branch back_122
retry_124:
s_mov_b32 s36, 0
retry_124_l:
global_load_dwordx4 v[184:187], v18, s[16:17] offset:0 sc1
global_load_dwordx4 v[188:191], v18, s[16:17] offset:1024 sc1
s_add_u32 s36, s36, 1
s_cmp_gt_u32 s36, 0x200000
s_cbranch_scc1 k2_bail
s_waitcnt vmcnt(0)
v_xor_b32 v192, v185, v187
v_xor_b32 v193, v189, v191
v_xor_b32 v194, s65, v185
v_xor_b32 v195, s65, v189
v_or3_b32 v192, v192, v193, v194
v_or_b32 v192, v192, v195
v_cmp_ne_u32 vcc, 0, v192
s_cbranch_vccnz retry_124_l
s_branch got_125
slow_126:
global_store_dwordx2 v11, v[136:137], s[82:83] offset:0 sc1
s_branch back_127
slow_128:
global_store_dwordx2 v11, v[142:143], s[82:83] offset:768 sc1
s_branch back_129
slow_130:
global_store_dwordx2 v12, v[144:145], s[82:83] offset:0 sc1
s_branch back_131
slow_132:
global_store_dwordx2 v11, v[138:139], s[82:83] offset:256 sc1
s_branch back_133
slow_134:
global_store_dwordx2 v11, v[140:141], s[82:83] offset:512 sc1
s_branch back_135
slow_136:
buffer_store_dword v63, v17, s[16:19], s27 offen sc1
s_branch back_137
hretry_139:
s_mov_b32 s36, 0
hretry_139_l:
buffer_load_dwordx4 v[184:187], v25, s[16:19], s72 offen sc1
buffer_load_dwordx4 v[188:191], v221, s[16:19], s72 offen sc1
s_add_u32 s36, s36, 1
s_cmp_gt_u32 s36, 0x200000
s_cbranch_scc1 k2_bail
s_waitcnt vmcnt(0)
v_xor_b32 v192, v185, v187
v_xor_b32 v193, s65, v185
v_or_b32 v192, v192, v193
v_xor_b32 v193, v189, v191
v_xor_b32 v194, s65, v189
v_or_b32 v193, v193, v194
v_cmp_ne_u32 vcc, 0, v192
v_cmp_ne_u32 s[98:99], 0, v193
s_and_b64 vcc, vcc, s[56:57]
s_and_b64 s[98:99], s[98:99], s[58:59]
s_or_b64 vcc, vcc, s[98:99]
s_cbranch_vccnz hretry_139_l
s_branch hgot_140
slow_141:
global_store_dwordx2 v11, v[52:53], s[16:17] offset:0 sc1
s_branch back_142
slow_143:
global_store_dwordx2 v11, v[54:55], s[16:17] offset:256 sc1
s_branch back_144
slow_145:
global_store_dwordx2 v11, v[56:57], s[16:17] offset:512 sc1
s_branch back_146
slow_147:
global_store_dwordx2 v11, v[58:59], s[16:17] offset:768 sc1
s_branch back_148
slow_149:
global_store_dwordx2 v12, v[60:61], s[16:17] offset:0 sc1
s_branch back_150
slow_151:
buffer_store_dwordx4 v[192:195], v220, s[16:19], s74 offen sc1
s_branch back_152
slow_153:
buffer_store_dword v63, v17, s[16:19], s27 offen sc1
s_branch back_154
retry_156:
s_mov_b32 s36, 0
retry_156_l:
global_load_dwordx4 v[184:187], v18, s[8:9] offset:0 sc1
global_load_dwordx4 v[188:191], v18, s[8:9] offset:1024 sc1
s_add_u32 s36, s36, 1
s_cmp_gt_u32 s36, 0x200000
s_cbranch_scc1 k2_bail
s_waitcnt vmcnt(0)
v_xor_b32 v192, v185, v187
v_xor_b32 v193, v189, v191
v_xor_b32 v194, s65, v185
v_xor_b32 v195, s65, v189
v_or3_b32 v192, v192, v193, v194
v_or_b32 v192, v192, v195
v_cmp_ne_u32 vcc, 0, v192
s_cbranch_vccnz retry_156_l
s_branch got_157
slow_158:
global_store_dwordx2 v13, v[176:177], s[16:17] offset:0 sc1
s_branch back_159
slow_160:
global_store_dwordx2 v13, v[178:179], s[16:17] offset:256 sc1
s_branch back_161
slow_162:
global_store_dwordx2 v13, v[180:181], s[16:17] offset:512 sc1
s_branch back_163
slow_164:
global_store_dwordx2 v13, v[182:183], s[16:17] offset:768 sc1
s_branch back_165
slow_166:
global_store_dwordx2 v13, v[184:185], s[84:85] offset:0 sc1
s_branch back_167
slow_168:
global_store_dwordx2 v13, v[186:187], s[84:85] offset:256 sc1
s_branch back_169
slow_170:
global_store_dwordx2 v13, v[188:189], s[84:85] offset:512 sc1
s_branch back_171
slow_172:
global_store_dwordx2 v13, v[190:191], s[84:85] offset:768 sc1
s_branch back_173
slow_174:
global_store_dwordx2 v13, v[192:193], s[10:11] offset:0 sc1
s_branch back_175
slow_176:
global_store_dwordx2 v13, v[194:195], s[10:11] offset:256 sc1
s_branch back_177
slow_178:
global_store_dwordx2 v13, v[196:197], s[10:11] offset:512 sc1
s_branch back_179
slow_180:
global_store_dwordx2 v13, v[198:199], s[10:11] offset:768 sc1
s_branch back_181
slow_182:
buffer_store_dword v63, v17, s[16:19], s27 offen sc1
s_branch back_183
interleave_layers__ssm_conv_h3__mixer_s_mlp__prompt_kernel_end:
.section .rodata,"a"
.p2align 6
.amdhsa_kernel interleave_layers__ssm_conv_h3__mixer_s_mlp__prompt_kernel
  .amdhsa_next_free_vgpr 512
  .amdhsa_next_free_sgpr 102
  .amdhsa_accum_offset 256
  .amdhsa_group_segment_fixed_size 0
  .amdhsa_kernarg_size 112
  .amdhsa_user_sgpr_count 2
  .amdhsa_user_sgpr_kernarg_segment_ptr 1
  .amdhsa_system_sgpr_workgroup_id_x 1
.end_amdhsa_kernel
```
